```python
import torch

def _softmax(x, axis=-1):
    return torch.softmax(x, dim=axis)
def _gelu(x):
    return torch.nn.functional.gelu(x, approximate="tanh")
def _silu(x):
    return torch.nn.functional.silu(x)
def _sigmoid(x):
    return torch.sigmoid(x)
def _layernorm(x, axis=-1, eps=1e-5):
    m = x.mean(dim=axis, keepdim=True)
    v = x.var(dim=axis, keepdim=True, unbiased=False)
    return (x - m) / torch.sqrt(v + eps)
def _scatter_add(tgt, idx, src, axis=0):
    return tgt.clone().index_add_(axis, idx, src)
def _segment_sum(src, seg, n):
    out = torch.zeros((n,) + src.shape[1:], dtype=src.dtype)
    return out.index_add_(0, seg, src)
def _pad(x, pw):
    flat = tuple(v for pair in reversed(pw) for v in pair)
    return torch.nn.functional.pad(x, flat)

kernel_name = 'interleave_layers__softmax_full_mha__dense_activation_squared_relu__prompt'

def setup_inputs():

    _w = (lambda a: (lambda t: t.to(torch.bfloat16) if t.is_floating_point() else t)(torch.as_tensor(a)))
    def _A_setup():
        B, S, D = 1, 2048, 448
        return {
            "x": _w((lambda *s: torch.randn(*s, dtype=torch.bfloat16) * 0.05)(B, S, D)),
            "wqkv": _w((lambda *s: torch.randn(*s, dtype=torch.bfloat16) * 0.05)(D, 3 * D)),
            "wo": _w((lambda *s: torch.randn(*s, dtype=torch.bfloat16) * 0.05)(D, D)),
        }
    _A_in = _A_setup()

    def _B_setup():
        B, S, D, F = 1, 2048, 448, 1792
        return {
            "x": _w((lambda *s: torch.randn(*s, dtype=torch.bfloat16) * 0.05)(B, S, D)),
            "w1": _w((lambda *s: torch.randn(*s, dtype=torch.bfloat16) * 0.05)(D, F)),
            "b1": _w((lambda *s: torch.randn(*s, dtype=torch.bfloat16) * 0.1)(F)),
            "w2": _w((lambda *s: torch.randn(*s, dtype=torch.bfloat16) * 0.05)(F, D)),
            "b2": _w((lambda *s: torch.randn(*s, dtype=torch.bfloat16) * 0.4)(D)),
        }
    _B_in = _B_setup()

    return {
        "A_x": _A_in["x"],
        "A_wqkv": _A_in["wqkv"],
        "A_wo": _A_in["wo"],
        "B_x": _B_in["x"],
        "B_w1": _B_in["w1"],
        "B_b1": _B_in["b1"],
        "B_w2": _B_in["w2"],
        "B_b2": _B_in["b2"],
    }

def reference(A_x, A_wqkv, A_wo, B_x, B_w1, B_b1, B_w2, B_b2):
    def _A_ref(x, wqkv, wo):
        B, S, D = x.shape
        H = 16; Dh = D // H
        qkv = (lambda x, *d: x.permute(*d))((x @ wqkv).reshape(B, S, 3, H, Dh), 2, 0, 3, 1, 4)
        q, k, v = qkv[0], qkv[1], qkv[2]
        scale = Dh ** -0.5
        scores = torch.einsum("bhqd,bhkd->bhqk", q, k) * scale
        p = _softmax(scores, axis=-1)
        o = torch.einsum("bhqk,bhkd->bhqd", p, v)
        return (lambda x, *d: x.permute(*d))(o, 0, 2, 1, 3).reshape(B, S, D) @ wo

    def _B_ref(x, w1, b1, w2, b2):
        h = torch.einsum("bsd,df->bsf", x, w1) + b1
        zero = torch.zeros_like(h)
        r = torch.where(h > zero, h, zero)
        h = r * r
        out = torch.einsum("bsf,fd->bsd", h, w2) + b2
        return out

    x = A_x
    x = x + _A_ref(_layernorm(x, axis=-1), A_wqkv, A_wo)
    x = x + _B_ref(_layernorm(x, axis=-1), B_w1, B_b1, B_w2, B_b2)
    x = x + _A_ref(_layernorm(x, axis=-1), A_wqkv, A_wo)
    x = x + _B_ref(_layernorm(x, axis=-1), B_w1, B_b1, B_w2, B_b2)
    return x
```

```asm
; @launch grid=(256,1,1) block=(256,1,1) lds=163840
.amdgcn_target "amdgcn-amd-amdhsa--gfx950"
.text
.globl interleave_layers__softmax_full_mha__dense_activation_squared_relu__prompt_kernel
.p2align 8
.type interleave_layers__softmax_full_mha__dense_activation_squared_relu__prompt_kernel,@function
interleave_layers__softmax_full_mha__dense_activation_squared_relu__prompt_kernel:
    s_cmp_ge_u32 s2, 256
    s_cbranch_scc1 L_end
    s_getpc_b64 s[10:11]
    v_lshrrev_b32 v1, 2, v0
    v_lshlrev_b32 v1, 7, v1
    global_load_dword v242, v1, s[10:11]
    s_load_dwordx2 s[12:13], s[0:1], 0
    s_load_dwordx2 s[16:17], s[0:1], 8
    s_load_dwordx2 s[4:5], s[0:1], 80
    s_load_dwordx2 s[20:21], s[0:1], 72
    s_load_dwordx2 s[48:49], s[0:1], 16
    s_load_dwordx4 s[52:55], s[0:1], 32
    s_load_dwordx4 s[56:59], s[0:1], 48
    v_lshrrev_b32 v2, 6, v0
    v_and_b32 v0, 63, v0
    s_and_b32 s34, s2, 7
    v_readfirstlane_b32 s8, v2
    s_lshr_b32 s3, s2, 3
    s_and_b32 s26, s3, 15
    s_lshr_b32 s9, s3, 4
    s_lshl_b32 s10, s34, 1
    s_add_u32 s27, s10, s9
    s_lshl_b32 s28, s27, 2
    s_add_u32 s28, s28, s8
    s_mov_b32 s14, 1835008
    s_mov_b32 s15, 0x20000
    s_mov_b32 s18, 1204224
    s_mov_b32 s19, 0x20000
    s_mov_b32 s6, 27774976
    s_mov_b32 s7, 0x20000
    v_lshrrev_b32 v15, 2, v0
    v_mul_u32_u24 v15, 2688, v15
    v_and_b32 v14, 3, v0
    v_lshl_add_u32 v15, v14, 4, v15
    s_mul_i32 s11, s8, 43008
    s_mul_i32 s9, s26, 56
    s_add_u32 s11, s11, s9
    s_add_u32 s9, s11, 896
    s_add_u32 s10, s11, 1792
    s_lshl_b32 s61, s8, 11
    s_lshl_b32 s62, s8, 10
    s_add_u32 s62, s62, 57344
    v_lshrrev_b32 v213, 3, v0
    v_mul_u32_u24 v14, 896, v213
    v_xor_b32 v213, v213, v0
    v_and_b32 v213, 7, v213
    v_lshl_add_u32 v14, v213, 4, v14
    s_mul_i32 s63, s28, 28672
    v_add_u32 v14, s63, v14
    s_mul_i32 s45, s8, 12288
    s_add_u32 s45, s45, 114688
    s_movk_i32 s42, 7168
    s_movk_i32 s43, 14336
    s_movk_i32 s44, 21504
    s_mov_b32 m0, s61
    s_waitcnt lgkmcnt(0)
    s_lshr_b32 s3, s2, 3
    s_lshl_b32 s3, s3, 2
    s_add_u32 s3, s3, s8
    s_mul_i32 s46, s3, 5376
    v_and_b32 v176, 15, v0
    v_min_u32 v176, 13, v176
    v_lshlrev_b32 v176, 7, v176
    v_bfe_u32 v177, v0, 4, 1
    v_mul_u32_u24 v177, 2688, v177
    v_add_u32 v177, v176, v177
    s_lshl_b32 s47, s34, 7
    s_add_u32 s47, s47, s3
    s_mul_i32 s47, s47, 1792
    buffer_load_dword v242, v177, s[16:19], s46 offen offset:896
    buffer_load_dword v242, v176, s[12:15], s47 offen
    buffer_load_dwordx4 v15, s[16:19], s9 offen lds
    s_add_u32 m0, s61, 1024
    s_nop 0
    buffer_load_dwordx4 v15, s[16:19], s10 offen lds
    s_add_u32 m0, s45, 0
    s_nop 0
    buffer_load_dwordx4 v14, s[12:15], 0 offen offset:0 lds
    s_add_u32 m0, s45, 1024
    s_nop 0
    buffer_load_dwordx4 v14, s[12:15], s42 offen offset:0 lds
    s_add_u32 m0, s45, 2048
    s_nop 0
    buffer_load_dwordx4 v14, s[12:15], s43 offen offset:0 lds
    s_add_u32 m0, s45, 3072
    s_nop 0
    buffer_load_dwordx4 v14, s[12:15], s44 offen offset:0 lds
    s_lshr_b32 s3, s2, 3
    s_lshr_b32 s63, s3, 3
    s_lshl_b32 s63, s63, 13
    s_and_b32 s3, s3, 7
    s_lshl_b32 s3, s3, 7
    s_add_u32 s63, s63, s3
    s_lshl_b32 s3, s34, 10
    s_add_u32 s63, s63, s3
    s_add_u32 s63, s63, 13545472
    v_mov_b32 v255, s63
    s_lshl_b32 s63, s2, 7
    s_add_u32 s3, s63, 13578112
    s_cmp_lt_u32 s2, 128
    s_cselect_b32 s3, s3, 2.0
    v_mov_b32 v240, s3
    v_cmp_gt_u32 vcc, 8, v0
    s_add_u32 s3, s63, 13594368
    s_cmp_lt_u32 s2, 188
    v_cndmask_b32 v255, v240, v255, vcc
    s_cselect_b32 s3, s3, 2.0
    v_mov_b32 v240, s3
    v_cmp_gt_u32 vcc, 16, v0
    v_mov_b32 v244, 0
    v_mov_b32 v245, 0
    v_cndmask_b32 v255, v240, v255, vcc
    v_mov_b32 v246, 0
    v_mov_b32 v247, 0
    v_lshl_add_u32 v255, v0, 4, v255
    s_cmp_eq_u32 s8, 0
    s_cselect_b32 s3, 0, 2.0
    s_mov_b64 exec, 0xffffff
    buffer_store_dwordx4 v[244:247], v255, s[4:7], s3 offen sc1
    s_mov_b64 exec, -1
    s_lshl_b32 s3, s2, 2
    s_add_u32 s3, s3, s8
    s_cmp_lt_u32 s3, 448
    s_cselect_b32 s92, s52, s56
    s_cselect_b32 s93, s53, s57
    s_cselect_b32 s63, 0, 448
    s_mov_b32 s94, 1605632
    s_cmp_lt_u32 s3, 896
    s_cselect_b32 s92, s92, s48
    s_cselect_b32 s93, s93, s49
    s_cselect_b32 s63, s63, 896
    s_cselect_b32 s94, s94, 401408
    s_mov_b32 s95, 0x20000
    s_sub_u32 s3, s3, s63
    s_mul_i32 s91, s3, 3584
    v_min_u32 v179, 27, v0
    v_lshlrev_b32 v179, 7, v179
    s_add_u32 s61, s61, 8192
    s_mov_b32 m0, s61
    s_add_u32 s9, s9, 172032
    buffer_load_dwordx4 v15, s[16:19], s9 offen lds
    s_add_u32 m0, s61, 1024
    s_add_u32 s10, s10, 172032
    buffer_load_dwordx4 v15, s[16:19], s10 offen lds
    v_lshlrev_b32 v1, 4, v0
    v_add_u32 v2, 0x10000, v1
    v_lshlrev_b32 v3, 2, v0
    s_mov_b32 s22, 256
    s_mov_b32 s23, 0x20000
    s_mov_b32 s24, 0
    s_mov_b32 s25, 100000
    s_getreg_b32 s35, hwreg(HW_REG_XCC_ID)
    s_and_b32 s35, s35, 15
    s_mov_b32 s36, 0
    s_mov_b32 s37, -1
    s_add_u32 m0, s45, 3968
    s_nop 0
    buffer_load_dwordx4 v14, s[12:15], 0 offen offset:128 lds
    s_add_u32 m0, s45, 4992
    s_nop 0
    buffer_load_dwordx4 v14, s[12:15], s42 offen offset:128 lds
    s_lshr_b32 s3, s2, 3
    s_cmp_lt_u32 s3, 28
    s_cselect_b32 s29, 1, 0
    s_mul_i32 s63, s3, 37
    s_lshr_b32 s63, s63, 8
    s_mul_i32 s60, s63, 7
    s_sub_u32 s60, s3, s60
    s_lshl_b32 s50, s34, 2
    s_add_u32 s63, s63, s50
    s_lshl_b32 s63, s63, 1
    s_lshr_b32 s50, s8, 1
    s_add_u32 s30, s63, s50
    s_lshl_b32 s60, s60, 1
    s_and_b32 s50, s8, 1
    s_add_u32 s31, s60, s50
    s_cmp_ge_u32 s3, 14
    s_cselect_b32 s63, 1, 0
    s_cselect_b32 s60, 14, 0
    s_sub_u32 s33, s3, s60
    s_lshl_b32 s50, s34, 1
    s_add_u32 s63, s63, s50
    s_lshl_b32 s63, s63, 2
    s_add_u32 s32, s63, s8
    s_add_u32 m0, s45, 6016
    s_nop 0
    buffer_load_dwordx4 v14, s[12:15], s43 offen offset:128 lds
    s_add_u32 m0, s45, 7040
    s_nop 0
    buffer_load_dwordx4 v14, s[12:15], s44 offen offset:128 lds
    s_xor_b32 s63, s8, 1
    s_mul_i32 s63, s63, 12288
    s_add_u32 s63, s63, 114688
    v_add_u32 v4, s63, v1
    s_xor_b32 s63, s8, 2
    s_mul_i32 s63, s63, 12288
    s_add_u32 s63, s63, 118784
    v_add_u32 v5, s63, v1
    s_xor_b32 s63, s8, 3
    s_mul_i32 s63, s63, 12288
    s_add_u32 s63, s63, 122880
    v_add_u32 v6, s63, v1
    s_mul_i32 s63, s8, 12288
    s_add_u32 s63, s63, 114688
    v_add_u32 v7, s63, v1
    s_add_u32 s47, s46, 688128
    buffer_load_dword v242, v177, s[16:19], s47 offen offset:896
    buffer_load_dword v242, v179, s[92:95], s91 offen
    v_lshrrev_b32 v240, 5, v0
    v_lshlrev_b32 v240, 3, v240
    s_lshl_b32 s60, s31, 6
    s_mov_b32 s96, s58
    s_mov_b32 s97, s59
    s_mov_b32 s98, 896
    s_mov_b32 s99, 0x20000
    buffer_load_dwordx2 a[248:249], v240, s[96:99], s60 offen offset:0
    buffer_load_dwordx2 a[250:251], v240, s[96:99], s60 offen offset:16
    buffer_load_dwordx2 a[252:253], v240, s[96:99], s60 offen offset:32
    buffer_load_dwordx2 a[254:255], v240, s[96:99], s60 offen offset:48
    s_mov_b32 s96, s54
    s_mov_b32 s97, s55
    s_mov_b32 s98, 3584
    s_sub_u32 s63, s2, 48
    s_lshl_b32 s63, s63, 6
    s_and_b32 s63, s63, 0xffff
    v_and_b32 v255, 31, v0
    v_lshlrev_b32 v255, 1, v255
    buffer_load_ushort a0, v255, s[96:99], s63 offen
    s_mov_b32 s54, 1073741824
    s_mov_b32 s55, 0
    s_mov_b32 s38, -1
    s_mov_b32 s40, 0
    s_mov_b32 s60, 16
    s_cmp_ge_u32 s2, 48
    s_cbranch_scc1 L_pk_2
    s_mov_b32 s96, s16
    s_mov_b32 s97, s17
    s_mov_b32 s98, 1204224
    s_mov_b32 s50, 2688
    s_lshr_b32 s63, s2, 4
    s_and_b32 s3, s2, 15
    s_mul_i32 s51, s63, 896
    s_mul_i32 s48, s3, 56
    s_add_u32 s51, s51, s48
    s_mul_i32 s48, s8, 301056
    s_add_u32 s51, s51, s48
    s_mul_i32 s52, s3, 89088
    s_add_u32 s52, s52, 8388608
    s_sub_u32 s48, s63, 1
    s_lshl_b32 s48, s48, 10
    s_cmp_eq_u32 s63, 0
    s_cselect_b32 s48, 59392, s48
    s_cselect_b32 s53, 1, 2
    s_lshl_b32 s53, s53, 10
    s_add_u32 s52, s52, s48
    s_mul_i32 s48, s53, 28
    s_add_u32 s54, s52, s48
    s_mul_i32 s48, s8, 7
    s_mul_i32 s48, s48, s53
    s_add_u32 s52, s52, s48
    s_mov_b32 s38, 0x0fffffff
    s_cmp_eq_u32 s63, 1
    s_cselect_b32 s40, 0x70000000, 0
    s_cmp_eq_u32 s63, 2
    s_cselect_b32 s40, 0x10000000, s40
    s_branch L_pk_1
L_pk_2:
    s_cmp_ge_u32 s2, 104
    s_cbranch_scc1 L_pk_3
    s_mov_b32 s96, s52
    s_mov_b32 s97, s53
    s_mov_b32 s98, 1605632
    s_mov_b32 s50, 3584
    s_sub_u32 s63, s2, 48
    s_lshl_b32 s51, s63, 6
    s_mul_i32 s48, s8, 401408
    s_add_u32 s51, s51, s48
    s_lshr_b32 s3, s63, 2
    s_mul_i32 s52, s3, 118784
    s_and_b32 s3, s63, 3
    s_lshl_b32 s3, s3, 10
    s_add_u32 s52, s52, s3
    s_add_u32 s52, s52, 10276864
    s_add_u32 s54, s52, 114688
    s_mul_i32 s48, s8, 28672
    s_add_u32 s52, s52, s48
    s_mov_b32 s53, 4096
    s_branch L_pk_1
L_pk_3:
    s_cmp_ge_u32 s2, 160
    s_cbranch_scc1 L_pk_4
    s_mov_b32 s96, s56
    s_mov_b32 s97, s57
    s_mov_b32 s98, 1605632
    s_mov_b32 s50, 896
    s_sub_u32 s63, s2, 104
    s_lshr_b32 s3, s63, 2
    s_and_b32 s63, s63, 3
    s_mul_i32 s63, s63, 28
    s_mul_i32 s48, s8, 7
    s_add_u32 s63, s63, s48
    s_mul_i32 s51, s63, 14336
    s_lshl_b32 s48, s3, 6
    s_add_u32 s51, s51, s48
    s_mul_i32 s52, s3, 112
    s_add_u32 s52, s52, s63
    s_lshl_b32 s52, s52, 10
    s_add_u32 s52, s52, 11939840
    s_mov_b32 s53, 1024
    s_branch L_pk_1
L_pk_4:
    s_mov_b32 s96, s48
    s_mov_b32 s97, s49
    s_cmp_ge_u32 s2, 188
    s_cselect_b32 s98, 0, 401408
    s_mov_b32 s50, 896
    s_sub_u32 s63, s2, 160
    s_lshr_b32 s3, s63, 1
    s_and_b32 s63, s63, 1
    s_lshl_b32 s63, s63, 2
    s_add_u32 s63, s63, s8
    s_mul_i32 s51, s63, 50176
    s_lshl_b32 s48, s3, 6
    s_add_u32 s51, s51, s48
    s_lshl_b32 s52, s3, 5
    s_lshl_b32 s48, s63, 2
    s_add_u32 s52, s52, s48
    s_lshl_b32 s52, s52, 10
    s_add_u32 s52, s52, 9818112
    s_mov_b32 s55, 1073741824
    s_mov_b32 s53, 1024
    s_mov_b32 s60, 12
L_pk_1:
    s_mov_b32 s39, s38
    s_cmp_eq_u32 s8, 0
    s_cselect_b32 s54, s54, 1073741824
    v_lshrrev_b32 v255, 2, v0
    v_mul_lo_u32 v240, v255, s50
    v_and_b32 v241, 3, v0
    v_lshl_add_u32 v240, v241, 4, v240
    v_cmp_gt_u32 vcc, s60, v255
    v_mov_b32 v241, 1073741824
    s_mul_i32 s59, s50, s60
    s_lshl_b32 s58, s50, 4
    v_cndmask_b32 v241, v241, v240, vcc
    v_lshrrev_b32 v213, 5, v0
    v_xor_b32 v244, v213, v0
    v_and_b32 v244, 7, v244
    v_lshlrev_b32 v244, 4, v244
    v_and_b32 v255, 31, v0
    v_lshl_add_u32 v244, v255, 7, v244
    v_add_u32 v244, s45, v244
    s_lshl_b32 s3, s8, 5
    v_xor_b32 v244, s3, v244
    v_xor_b32 v245, 32, v244
    v_xor_b32 v246, 64, v244
    v_xor_b32 v247, 0x60, v244
    v_bfe_u32 v255, v0, 2, 2
    v_lshlrev_b32 v213, 9, v213
    v_lshl_add_u32 v213, v255, 6, v213
    v_bfe_u32 v255, v0, 4, 1
    v_lshl_add_u32 v213, v255, 5, v213
    v_and_b32 v255, 3, v0
    v_lshl_add_u32 v213, v255, 3, v213
    s_lshl_b32 s3, s8, 11
    v_add_u32 v248, s3, v213
    v_xor_b32 v249, 0x800, v248
    v_xor_b32 v250, 0x1000, v248
    v_xor_b32 v251, 0x1800, v248
    v_add_u32 v252, s62, v213
    v_xor_b32 v253, 0x400, v252
    v_xor_b32 v254, 0x800, v252
    v_xor_b32 v243, 0xc00, v252
    v_and_b32 v255, 15, v0
    v_lshlrev_b32 v255, 6, v255
    s_add_u32 s3, s3, 56
    v_add_u32 v215, s3, v255
    v_mov_b32 v8, 0x3f803f80
    v_mov_b32 v10, 0
    v_mov_b32 v11, 0
    v_mov_b32 v12, 0
    v_mov_b32 v13, 0
    s_mul_i32 s63, s35, s35
    s_lshl_b32 s63, s63, 16
    s_lshl_b32 s3, s35, 8
    s_add_u32 s63, s63, s3
    s_add_u32 s63, s63, 1
    s_and_b32 s3, s2, 63
    s_lshl_b32 s3, s3, 2
    s_cmp_eq_u32 s8, 0
    s_cselect_b32 s3, s3, 0x1000
    v_mov_b32 v255, s63
    s_mov_b64 exec, 1
    s_waitcnt vmcnt(13)
    buffer_atomic_add v255, off, s[20:23], s3 sc1
    s_mov_b64 exec, -1
    s_lshr_b32 s3, s2, 3
    s_cmp_lt_u32 s3, 4
    s_cselect_b32 s63, s8, 0
    s_cmp_lg_u32 s63, 3
    s_cbranch_scc1 L_nocode_6
    s_getpc_b64 s[56:57]
    s_lshl_b32 s3, s3, 13
    v_lshlrev_b32 v178, 7, v0
    v_add_u32 v178, s3, v178
L_pc0:
    global_load_dword v242, v178, s[56:57]
L_nocode_6:
    ds_write_b16 v215, v8 offset:0
    ds_read_b128 v[16:19], v244 offset:0
    ds_read_b128 v[20:23], v245 offset:0
    ds_read_b128 v[24:27], v246 offset:0
    ds_read_b128 v[28:31], v247 offset:0
    s_waitcnt lgkmcnt(4)
    s_barrier
    ds_read_b64_tr_b16 v[176:177], v248 offset:0
    ds_read_b64_tr_b16 v[178:179], v248 offset:256
    ds_read_b64_tr_b16 v[180:181], v248 offset:1024
    ds_read_b64_tr_b16 v[182:183], v248 offset:1280
    ds_read_b64_tr_b16 v[184:185], v249 offset:0
    ds_read_b64_tr_b16 v[186:187], v249 offset:256
    ds_read_b64_tr_b16 v[188:189], v249 offset:1024
    ds_read_b64_tr_b16 v[190:191], v249 offset:1280
    s_waitcnt lgkmcnt(6)
    v_mfma_f32_32x32x16_bf16 v[128:143], v[176:179], v[16:19], 0
    s_add_u32 s61, s61, 8192
    s_mov_b32 m0, s61
    s_add_u32 s9, s9, 172032
    buffer_load_dwordx4 v15, s[16:19], s9 offen lds
    ds_read_b64_tr_b16 v[192:193], v250 offset:0
    ds_read_b64_tr_b16 v[194:195], v250 offset:256
    s_waitcnt lgkmcnt(6)
    v_mfma_f32_32x32x16_bf16 v[144:159], v[16:19], v[180:183], 0
    s_add_u32 m0, s61, 1024
    s_add_u32 s10, s10, 172032
    buffer_load_dwordx4 v15, s[16:19], s10 offen lds
    v_dot2_f32_bf16 v11, v176, v8, v11
    v_dot2_f32_bf16 v12, v180, v8, v12
    v_dot2_f32_bf16 v11, v177, v8, v11
    v_dot2_f32_bf16 v12, v181, v8, v12
    v_dot2_f32_bf16 v11, v178, v8, v11
    v_dot2_f32_bf16 v12, v182, v8, v12
    v_dot2_f32_bf16 v11, v179, v8, v11
    v_dot2_f32_bf16 v12, v183, v8, v12
    v_dot2_f32_bf16 v10, v16, v16, v10
    v_dot2_f32_bf16 v10, v17, v17, v10
    v_dot2_f32_bf16 v10, v18, v18, v10
    v_dot2_f32_bf16 v10, v19, v19, v10
    v_dot2_f32_bf16 v10, v20, v20, v10
    v_dot2_f32_bf16 v10, v21, v21, v10
    v_dot2_f32_bf16 v10, v22, v22, v10
    v_dot2_f32_bf16 v10, v23, v23, v10
    v_dot2_f32_bf16 v10, v24, v24, v10
    v_dot2_f32_bf16 v10, v25, v25, v10
    v_dot2_f32_bf16 v10, v26, v26, v10
    v_dot2_f32_bf16 v10, v27, v27, v10
    v_dot2_f32_bf16 v10, v28, v28, v10
    v_dot2_f32_bf16 v10, v29, v29, v10
    v_dot2_f32_bf16 v10, v30, v30, v10
    v_dot2_f32_bf16 v10, v31, v31, v10
    ds_read_b64_tr_b16 v[196:197], v250 offset:1024
    ds_read_b64_tr_b16 v[198:199], v250 offset:1280
    s_waitcnt vmcnt(10)
    ds_write_b16 v215, v8 offset:8192
    ds_read_b128 v[32:35], v244 offset:4096
    ds_read_b128 v[36:39], v245 offset:4096
    ds_read_b128 v[40:43], v246 offset:4096
    ds_read_b128 v[44:47], v247 offset:4096
    s_waitcnt lgkmcnt(11)
    v_mfma_f32_32x32x16_bf16 v[128:143], v[184:187], v[20:23], v[128:143]
    s_add_u32 m0, s45, 7936
    s_nop 0
    buffer_load_dwordx4 v14, s[12:15], 0 offen offset:256 lds
    s_add_u32 m0, s45, 8960
    s_nop 0
    buffer_load_dwordx4 v14, s[12:15], s42 offen offset:256 lds
    ds_read_b64_tr_b16 v[200:201], v251 offset:0
    ds_read_b64_tr_b16 v[202:203], v251 offset:256
    s_waitcnt lgkmcnt(11)
    v_mfma_f32_32x32x16_bf16 v[144:159], v[20:23], v[188:191], v[144:159]
    s_add_u32 m0, s45, 9984
    s_nop 0
    buffer_load_dwordx4 v14, s[12:15], s43 offen offset:256 lds
    s_add_u32 m0, s45, 11008
    s_nop 0
    buffer_load_dwordx4 v14, s[12:15], s44 offen offset:256 lds
    ds_read_b64_tr_b16 v[204:205], v251 offset:1024
    ds_read_b64_tr_b16 v[206:207], v251 offset:1280
    s_waitcnt lgkmcnt(8)
    s_barrier
    v_mfma_f32_32x32x16_bf16 v[128:143], v[192:195], v[24:27], v[128:143]
    s_add_u32 s61, s61, 8192
    s_mov_b32 m0, s61
    s_add_u32 s9, s9, 172032
    buffer_load_dwordx4 v15, s[16:19], s9 offen lds
    ds_read_b64_tr_b16 v[176:177], v248 offset:8192
    ds_read_b64_tr_b16 v[178:179], v248 offset:8448
    v_mfma_f32_32x32x16_bf16 v[144:159], v[24:27], v[196:199], v[144:159]
    s_add_u32 m0, s61, 1024
    s_add_u32 s10, s10, 172032
    buffer_load_dwordx4 v15, s[16:19], s10 offen lds
    ds_read_b64_tr_b16 v[180:181], v248 offset:9216
    ds_read_b64_tr_b16 v[182:183], v248 offset:9472
    s_waitcnt lgkmcnt(6)
    v_mfma_f32_32x32x16_bf16 v[128:143], v[200:203], v[28:31], v[128:143]
    s_add_u32 m0, s45, -384
    s_nop 0
    buffer_load_dwordx4 v14, s[12:15], 0 offen offset:384 lds
    ds_read_b64_tr_b16 v[184:185], v249 offset:8192
    ds_read_b64_tr_b16 v[186:187], v249 offset:8448
    s_waitcnt lgkmcnt(6)
    v_mfma_f32_32x32x16_bf16 v[144:159], v[28:31], v[204:207], v[144:159]
    s_add_u32 m0, s45, 640
    s_nop 0
    buffer_load_dwordx4 v14, s[12:15], s42 offen offset:384 lds
    s_add_u32 m0, s45, 1664
    s_nop 0
    buffer_load_dwordx4 v14, s[12:15], s43 offen offset:384 lds
    ds_read_b64_tr_b16 v[188:189], v249 offset:9216
    ds_read_b64_tr_b16 v[190:191], v249 offset:9472
    s_waitcnt lgkmcnt(6)
    v_mfma_f32_32x32x16_bf16 v[128:143], v[176:179], v[32:35], v[128:143]
    s_add_u32 m0, s45, 2688
    s_nop 0
    buffer_load_dwordx4 v14, s[12:15], s44 offen offset:384 lds
    ds_read_b64_tr_b16 v[192:193], v250 offset:8192
    ds_read_b64_tr_b16 v[194:195], v250 offset:8448
    s_waitcnt lgkmcnt(6)
    v_mfma_f32_32x32x16_bf16 v[144:159], v[32:35], v[180:183], v[144:159]
    v_dot2_f32_bf16 v11, v176, v8, v11
    v_dot2_f32_bf16 v12, v180, v8, v12
    v_dot2_f32_bf16 v11, v177, v8, v11
    v_dot2_f32_bf16 v12, v181, v8, v12
    v_dot2_f32_bf16 v11, v178, v8, v11
    v_dot2_f32_bf16 v12, v182, v8, v12
    v_dot2_f32_bf16 v11, v179, v8, v11
    v_dot2_f32_bf16 v12, v183, v8, v12
    v_dot2_f32_bf16 v10, v32, v32, v10
    v_dot2_f32_bf16 v10, v33, v33, v10
    v_dot2_f32_bf16 v10, v34, v34, v10
    v_dot2_f32_bf16 v10, v35, v35, v10
    v_dot2_f32_bf16 v10, v36, v36, v10
    v_dot2_f32_bf16 v10, v37, v37, v10
    v_dot2_f32_bf16 v10, v38, v38, v10
    v_dot2_f32_bf16 v10, v39, v39, v10
    v_dot2_f32_bf16 v10, v40, v40, v10
    v_dot2_f32_bf16 v10, v41, v41, v10
    v_dot2_f32_bf16 v10, v42, v42, v10
    v_dot2_f32_bf16 v10, v43, v43, v10
    v_dot2_f32_bf16 v10, v44, v44, v10
    v_dot2_f32_bf16 v10, v45, v45, v10
    v_dot2_f32_bf16 v10, v46, v46, v10
    v_dot2_f32_bf16 v10, v47, v47, v10
    ds_read_b64_tr_b16 v[196:197], v250 offset:9216
    ds_read_b64_tr_b16 v[198:199], v250 offset:9472
    s_waitcnt vmcnt(6)
    ds_write_b16 v215, v8 offset:16384
    ds_read_b128 v[48:51], v244 offset:8192
    ds_read_b128 v[52:55], v245 offset:8192
    ds_read_b128 v[56:59], v246 offset:8192
    ds_read_b128 v[60:63], v247 offset:8192
    s_waitcnt lgkmcnt(11)
    v_mfma_f32_32x32x16_bf16 v[128:143], v[184:187], v[36:39], v[128:143]
    ds_read_b64_tr_b16 v[200:201], v251 offset:8192
    ds_read_b64_tr_b16 v[202:203], v251 offset:8448
    s_waitcnt lgkmcnt(11)
    v_mfma_f32_32x32x16_bf16 v[144:159], v[36:39], v[188:191], v[144:159]
    ds_read_b64_tr_b16 v[204:205], v251 offset:9216
    ds_read_b64_tr_b16 v[206:207], v251 offset:9472
    s_waitcnt lgkmcnt(8)
    s_barrier
    v_mfma_f32_32x32x16_bf16 v[128:143], v[192:195], v[40:43], v[128:143]
    s_add_u32 s61, s61, 8192
    s_mov_b32 m0, s61
    s_add_u32 s9, s9, 172032
    buffer_load_dwordx4 v15, s[16:19], s9 offen lds
    ds_read_b64_tr_b16 v[176:177], v248 offset:16384
    ds_read_b64_tr_b16 v[178:179], v248 offset:16640
    v_mfma_f32_32x32x16_bf16 v[144:159], v[40:43], v[196:199], v[144:159]
    s_add_u32 m0, s61, 1024
    s_add_u32 s10, s10, 172032
    buffer_load_dwordx4 v15, s[16:19], s10 offen lds
    ds_read_b64_tr_b16 v[180:181], v248 offset:17408
    ds_read_b64_tr_b16 v[182:183], v248 offset:17664
    s_waitcnt lgkmcnt(6)
    v_mfma_f32_32x32x16_bf16 v[128:143], v[200:203], v[44:47], v[128:143]
    s_add_u32 m0, s45, 3584
    s_nop 0
    buffer_load_dwordx4 v14, s[12:15], 0 offen offset:512 lds
    ds_read_b64_tr_b16 v[184:185], v249 offset:16384
    ds_read_b64_tr_b16 v[186:187], v249 offset:16640
    s_waitcnt lgkmcnt(6)
    v_mfma_f32_32x32x16_bf16 v[144:159], v[44:47], v[204:207], v[144:159]
    s_add_u32 m0, s45, 4608
    s_nop 0
    buffer_load_dwordx4 v14, s[12:15], s42 offen offset:512 lds
    s_add_u32 m0, s45, 5632
    s_nop 0
    buffer_load_dwordx4 v14, s[12:15], s43 offen offset:512 lds
    ds_read_b64_tr_b16 v[188:189], v249 offset:17408
    ds_read_b64_tr_b16 v[190:191], v249 offset:17664
    s_waitcnt lgkmcnt(6)
    v_mfma_f32_32x32x16_bf16 v[128:143], v[176:179], v[48:51], v[128:143]
    s_add_u32 m0, s45, 6656
    s_nop 0
    buffer_load_dwordx4 v14, s[12:15], s44 offen offset:512 lds
    v_and_b32 v255, 7, v0
    v_min_u32 v255, 6, v255
    v_bfe_u32 v9, v0, 3, 2
    v_mul_u32_u24 v9, 2688, v9
    v_lshl_add_u32 v255, v255, 7, v9
    s_lshl_b32 s47, s46, 1
    buffer_load_dword v242, v255, s[16:19], s47 offen
    ds_read_b64_tr_b16 v[192:193], v250 offset:16384
    ds_read_b64_tr_b16 v[194:195], v250 offset:16640
    s_waitcnt lgkmcnt(6)
    v_mfma_f32_32x32x16_bf16 v[144:159], v[48:51], v[180:183], v[144:159]
    v_dot2_f32_bf16 v11, v176, v8, v11
    v_dot2_f32_bf16 v12, v180, v8, v12
    v_dot2_f32_bf16 v11, v177, v8, v11
    v_dot2_f32_bf16 v12, v181, v8, v12
    v_dot2_f32_bf16 v11, v178, v8, v11
    v_dot2_f32_bf16 v12, v182, v8, v12
    v_dot2_f32_bf16 v11, v179, v8, v11
    v_dot2_f32_bf16 v12, v183, v8, v12
    v_dot2_f32_bf16 v10, v48, v48, v10
    v_dot2_f32_bf16 v10, v49, v49, v10
    v_dot2_f32_bf16 v10, v50, v50, v10
    v_dot2_f32_bf16 v10, v51, v51, v10
    v_dot2_f32_bf16 v10, v52, v52, v10
    v_dot2_f32_bf16 v10, v53, v53, v10
    v_dot2_f32_bf16 v10, v54, v54, v10
    v_dot2_f32_bf16 v10, v55, v55, v10
    v_dot2_f32_bf16 v10, v56, v56, v10
    v_dot2_f32_bf16 v10, v57, v57, v10
    v_dot2_f32_bf16 v10, v58, v58, v10
    v_dot2_f32_bf16 v10, v59, v59, v10
    v_dot2_f32_bf16 v10, v60, v60, v10
    v_dot2_f32_bf16 v10, v61, v61, v10
    v_dot2_f32_bf16 v10, v62, v62, v10
    v_dot2_f32_bf16 v10, v63, v63, v10
    ds_read_b64_tr_b16 v[196:197], v250 offset:17408
    ds_read_b64_tr_b16 v[198:199], v250 offset:17664
    s_waitcnt vmcnt(7)
    ds_write_b16 v215, v8 offset:24576
    ds_read_b128 v[64:67], v244 offset:0
    ds_read_b128 v[68:71], v245 offset:0
    ds_read_b128 v[72:75], v246 offset:0
    ds_read_b128 v[76:79], v247 offset:0
    s_waitcnt lgkmcnt(11)
    v_mfma_f32_32x32x16_bf16 v[128:143], v[184:187], v[52:55], v[128:143]
    ds_read_b64_tr_b16 v[200:201], v251 offset:16384
    ds_read_b64_tr_b16 v[202:203], v251 offset:16640
    s_waitcnt lgkmcnt(11)
    v_mfma_f32_32x32x16_bf16 v[144:159], v[52:55], v[188:191], v[144:159]
    ds_read_b64_tr_b16 v[204:205], v251 offset:17408
    ds_read_b64_tr_b16 v[206:207], v251 offset:17664
    s_waitcnt lgkmcnt(8)
    s_barrier
    v_mfma_f32_32x32x16_bf16 v[128:143], v[192:195], v[56:59], v[128:143]
    s_add_u32 s61, s61, 8192
    s_mov_b32 m0, s61
    s_add_u32 s9, s9, 172032
    buffer_load_dwordx4 v15, s[16:19], s9 offen lds
    ds_read_b64_tr_b16 v[176:177], v248 offset:24576
    ds_read_b64_tr_b16 v[178:179], v248 offset:24832
    v_mfma_f32_32x32x16_bf16 v[144:159], v[56:59], v[196:199], v[144:159]
    s_add_u32 m0, s61, 1024
    s_add_u32 s10, s10, 172032
    buffer_load_dwordx4 v15, s[16:19], s10 offen lds
    ds_read_b64_tr_b16 v[180:181], v248 offset:25600
    ds_read_b64_tr_b16 v[182:183], v248 offset:25856
    s_waitcnt lgkmcnt(6)
    v_mfma_f32_32x32x16_bf16 v[128:143], v[200:203], v[60:63], v[128:143]
    s_add_u32 m0, s45, 7552
    s_nop 0
    buffer_load_dwordx4 v14, s[12:15], 0 offen offset:640 lds
    ds_read_b64_tr_b16 v[184:185], v249 offset:24576
    ds_read_b64_tr_b16 v[186:187], v249 offset:24832
    s_waitcnt lgkmcnt(6)
    v_mfma_f32_32x32x16_bf16 v[144:159], v[60:63], v[204:207], v[144:159]
    s_add_u32 m0, s45, 8576
    s_nop 0
    buffer_load_dwordx4 v14, s[12:15], s42 offen offset:640 lds
    s_add_u32 m0, s45, 9600
    s_nop 0
    buffer_load_dwordx4 v14, s[12:15], s43 offen offset:640 lds
    ds_read_b64_tr_b16 v[188:189], v249 offset:25600
    ds_read_b64_tr_b16 v[190:191], v249 offset:25856
    s_waitcnt lgkmcnt(6)
    v_mfma_f32_32x32x16_bf16 v[128:143], v[176:179], v[64:67], v[128:143]
    s_add_u32 m0, s45, 10624
    s_nop 0
    buffer_load_dwordx4 v14, s[12:15], s44 offen offset:640 lds
    ds_read_b64_tr_b16 v[192:193], v250 offset:24576
    ds_read_b64_tr_b16 v[194:195], v250 offset:24832
    s_waitcnt lgkmcnt(6)
    v_mfma_f32_32x32x16_bf16 v[144:159], v[64:67], v[180:183], v[144:159]
    v_dot2_f32_bf16 v11, v176, v8, v11
    v_dot2_f32_bf16 v12, v180, v8, v12
    v_dot2_f32_bf16 v11, v177, v8, v11
    v_dot2_f32_bf16 v12, v181, v8, v12
    v_dot2_f32_bf16 v11, v178, v8, v11
    v_dot2_f32_bf16 v12, v182, v8, v12
    v_dot2_f32_bf16 v11, v179, v8, v11
    v_dot2_f32_bf16 v12, v183, v8, v12
    v_dot2_f32_bf16 v10, v64, v64, v10
    v_dot2_f32_bf16 v10, v65, v65, v10
    v_dot2_f32_bf16 v10, v66, v66, v10
    v_dot2_f32_bf16 v10, v67, v67, v10
    v_dot2_f32_bf16 v10, v68, v68, v10
    v_dot2_f32_bf16 v10, v69, v69, v10
    v_dot2_f32_bf16 v10, v70, v70, v10
    v_dot2_f32_bf16 v10, v71, v71, v10
    v_dot2_f32_bf16 v10, v72, v72, v10
    v_dot2_f32_bf16 v10, v73, v73, v10
    v_dot2_f32_bf16 v10, v74, v74, v10
    v_dot2_f32_bf16 v10, v75, v75, v10
    v_dot2_f32_bf16 v10, v76, v76, v10
    v_dot2_f32_bf16 v10, v77, v77, v10
    v_dot2_f32_bf16 v10, v78, v78, v10
    v_dot2_f32_bf16 v10, v79, v79, v10
    ds_read_b64_tr_b16 v[196:197], v250 offset:25600
    ds_read_b64_tr_b16 v[198:199], v250 offset:25856
    s_waitcnt vmcnt(7)
    ds_write_b16 v215, v8 offset:32768
    ds_read_b128 v[80:83], v244 offset:4096
    ds_read_b128 v[84:87], v245 offset:4096
    ds_read_b128 v[88:91], v246 offset:4096
    ds_read_b128 v[92:95], v247 offset:4096
    s_waitcnt lgkmcnt(11)
    v_mfma_f32_32x32x16_bf16 v[128:143], v[184:187], v[68:71], v[128:143]
    ds_read_b64_tr_b16 v[200:201], v251 offset:24576
    ds_read_b64_tr_b16 v[202:203], v251 offset:24832
    s_waitcnt lgkmcnt(11)
    v_mfma_f32_32x32x16_bf16 v[144:159], v[68:71], v[188:191], v[144:159]
    ds_read_b64_tr_b16 v[204:205], v251 offset:25600
    ds_read_b64_tr_b16 v[206:207], v251 offset:25856
    s_waitcnt lgkmcnt(8)
    s_barrier
    v_mfma_f32_32x32x16_bf16 v[128:143], v[192:195], v[72:75], v[128:143]
    s_add_u32 s61, s61, 8192
    s_mov_b32 m0, s61
    s_add_u32 s9, s9, 172032
    buffer_load_dwordx4 v15, s[16:19], s9 offen lds
    ds_read_b64_tr_b16 v[176:177], v248 offset:32768
    ds_read_b64_tr_b16 v[178:179], v248 offset:33024
    v_mfma_f32_32x32x16_bf16 v[144:159], v[72:75], v[196:199], v[144:159]
    s_add_u32 m0, s61, 1024
    s_add_u32 s10, s10, 172032
    buffer_load_dwordx4 v15, s[16:19], s10 offen lds
    ds_read_b64_tr_b16 v[180:181], v248 offset:33792
    ds_read_b64_tr_b16 v[182:183], v248 offset:34048
    s_waitcnt lgkmcnt(6)
    v_mfma_f32_32x32x16_bf16 v[128:143], v[200:203], v[76:79], v[128:143]
    s_add_u32 m0, s45, -768
    s_nop 0
    buffer_load_dwordx4 v14, s[12:15], 0 offen offset:768 lds
    ds_read_b64_tr_b16 v[184:185], v249 offset:32768
    ds_read_b64_tr_b16 v[186:187], v249 offset:33024
    s_waitcnt lgkmcnt(6)
    v_mfma_f32_32x32x16_bf16 v[144:159], v[76:79], v[204:207], v[144:159]
    s_add_u32 m0, s45, 256
    s_nop 0
    buffer_load_dwordx4 v14, s[12:15], s42 offen offset:768 lds
    s_add_u32 m0, s45, 1280
    s_nop 0
    buffer_load_dwordx4 v14, s[12:15], s43 offen offset:768 lds
    ds_read_b64_tr_b16 v[188:189], v249 offset:33792
    ds_read_b64_tr_b16 v[190:191], v249 offset:34048
    s_waitcnt lgkmcnt(6)
    v_mfma_f32_32x32x16_bf16 v[128:143], v[176:179], v[80:83], v[128:143]
    s_add_u32 m0, s45, 2304
    s_nop 0
    buffer_load_dwordx4 v14, s[12:15], s44 offen offset:768 lds
    buffer_load_dword v242, v3, s[20:23], 0 offen sc1
    ds_read_b64_tr_b16 v[192:193], v250 offset:32768
    ds_read_b64_tr_b16 v[194:195], v250 offset:33024
    s_waitcnt lgkmcnt(6)
    v_mfma_f32_32x32x16_bf16 v[144:159], v[80:83], v[180:183], v[144:159]
    v_dot2_f32_bf16 v11, v176, v8, v11
    v_dot2_f32_bf16 v12, v180, v8, v12
    v_dot2_f32_bf16 v11, v177, v8, v11
    v_dot2_f32_bf16 v12, v181, v8, v12
    v_dot2_f32_bf16 v11, v178, v8, v11
    v_dot2_f32_bf16 v12, v182, v8, v12
    v_dot2_f32_bf16 v11, v179, v8, v11
    v_dot2_f32_bf16 v12, v183, v8, v12
    v_dot2_f32_bf16 v10, v80, v80, v10
    v_dot2_f32_bf16 v10, v81, v81, v10
    v_dot2_f32_bf16 v10, v82, v82, v10
    v_dot2_f32_bf16 v10, v83, v83, v10
    v_dot2_f32_bf16 v10, v84, v84, v10
    v_dot2_f32_bf16 v10, v85, v85, v10
    v_dot2_f32_bf16 v10, v86, v86, v10
    v_dot2_f32_bf16 v10, v87, v87, v10
    v_dot2_f32_bf16 v10, v88, v88, v10
    v_dot2_f32_bf16 v10, v89, v89, v10
    v_dot2_f32_bf16 v10, v90, v90, v10
    v_dot2_f32_bf16 v10, v91, v91, v10
    v_dot2_f32_bf16 v10, v92, v92, v10
    v_dot2_f32_bf16 v10, v93, v93, v10
    v_dot2_f32_bf16 v10, v94, v94, v10
    v_dot2_f32_bf16 v10, v95, v95, v10
    ds_read_b64_tr_b16 v[196:197], v250 offset:33792
    ds_read_b64_tr_b16 v[198:199], v250 offset:34048
    s_waitcnt vmcnt(7)
    ds_write_b16 v215, v8 offset:40960
    ds_read_b128 v[96:99], v244 offset:8192
    ds_read_b128 v[100:103], v245 offset:8192
    ds_read_b128 v[104:107], v246 offset:8192
    ds_read_b128 v[108:111], v247 offset:8192
    s_waitcnt lgkmcnt(11)
    v_mfma_f32_32x32x16_bf16 v[128:143], v[184:187], v[84:87], v[128:143]
    ds_read_b64_tr_b16 v[200:201], v251 offset:32768
    ds_read_b64_tr_b16 v[202:203], v251 offset:33024
    s_waitcnt lgkmcnt(11)
    v_mfma_f32_32x32x16_bf16 v[144:159], v[84:87], v[188:191], v[144:159]
    ds_read_b64_tr_b16 v[204:205], v251 offset:33792
    ds_read_b64_tr_b16 v[206:207], v251 offset:34048
    s_waitcnt lgkmcnt(8)
    s_barrier
    v_mfma_f32_32x32x16_bf16 v[128:143], v[192:195], v[88:91], v[128:143]
    s_add_u32 m0, s62, 0
    s_nop 0
    buffer_load_dwordx4 v15, s[16:19], s11 offen lds
    ds_read_b64_tr_b16 v[176:177], v248 offset:40960
    ds_read_b64_tr_b16 v[178:179], v248 offset:41216
    v_mfma_f32_32x32x16_bf16 v[144:159], v[88:91], v[196:199], v[144:159]
    ds_read_b64_tr_b16 v[180:181], v248 offset:41984
    ds_read_b64_tr_b16 v[182:183], v248 offset:42240
    s_waitcnt lgkmcnt(6)
    v_mfma_f32_32x32x16_bf16 v[128:143], v[200:203], v[92:95], v[128:143]
    s_add_u32 m0, s62, 4096
    s_add_u32 s11, s11, 172032
    buffer_load_dwordx4 v15, s[16:19], s11 offen lds
    ds_read_b64_tr_b16 v[184:185], v249 offset:40960
    ds_read_b64_tr_b16 v[186:187], v249 offset:41216
    s_waitcnt lgkmcnt(6)
    v_mfma_f32_32x32x16_bf16 v[144:159], v[92:95], v[204:207], v[144:159]
    ds_read_b64_tr_b16 v[188:189], v249 offset:41984
    ds_read_b64_tr_b16 v[190:191], v249 offset:42240
    s_waitcnt lgkmcnt(6)
    v_mfma_f32_32x32x16_bf16 v[128:143], v[176:179], v[96:99], v[128:143]
    s_add_u32 m0, s62, 8192
    s_add_u32 s11, s11, 172032
    buffer_load_dwordx4 v15, s[16:19], s11 offen lds
    ds_read_b64_tr_b16 v[192:193], v250 offset:40960
    ds_read_b64_tr_b16 v[194:195], v250 offset:41216
    s_waitcnt lgkmcnt(6)
    v_mfma_f32_32x32x16_bf16 v[144:159], v[96:99], v[180:183], v[144:159]
    v_dot2_f32_bf16 v11, v176, v8, v11
    v_dot2_f32_bf16 v12, v180, v8, v12
    v_dot2_f32_bf16 v11, v177, v8, v11
    v_dot2_f32_bf16 v12, v181, v8, v12
    v_dot2_f32_bf16 v11, v178, v8, v11
    v_dot2_f32_bf16 v12, v182, v8, v12
    v_dot2_f32_bf16 v11, v179, v8, v11
    v_dot2_f32_bf16 v12, v183, v8, v12
    v_dot2_f32_bf16 v10, v96, v96, v10
    v_dot2_f32_bf16 v10, v97, v97, v10
    v_dot2_f32_bf16 v10, v98, v98, v10
    v_dot2_f32_bf16 v10, v99, v99, v10
    v_dot2_f32_bf16 v10, v100, v100, v10
    v_dot2_f32_bf16 v10, v101, v101, v10
    v_dot2_f32_bf16 v10, v102, v102, v10
    v_dot2_f32_bf16 v10, v103, v103, v10
    v_dot2_f32_bf16 v10, v104, v104, v10
    v_dot2_f32_bf16 v10, v105, v105, v10
    v_dot2_f32_bf16 v10, v106, v106, v10
    v_dot2_f32_bf16 v10, v107, v107, v10
    v_dot2_f32_bf16 v10, v108, v108, v10
    v_dot2_f32_bf16 v10, v109, v109, v10
    v_dot2_f32_bf16 v10, v110, v110, v10
    v_dot2_f32_bf16 v10, v111, v111, v10
    ds_read_b64_tr_b16 v[196:197], v250 offset:41984
    ds_read_b64_tr_b16 v[198:199], v250 offset:42240
    s_waitcnt vmcnt(4)
    ds_write_b16 v215, v8 offset:49152
    ds_read_b128 v[112:115], v244 offset:0
    ds_read_b128 v[116:119], v245 offset:0
    ds_read_b128 v[120:123], v246 offset:0
    ds_read_b128 v[124:127], v247 offset:0
    s_waitcnt lgkmcnt(11)
    v_mfma_f32_32x32x16_bf16 v[128:143], v[184:187], v[100:103], v[128:143]
    s_add_u32 m0, s62, 12288
    s_add_u32 s11, s11, 172032
    buffer_load_dwordx4 v15, s[16:19], s11 offen lds
    ds_read_b64_tr_b16 v[200:201], v251 offset:40960
    ds_read_b64_tr_b16 v[202:203], v251 offset:41216
    s_waitcnt lgkmcnt(11)
    v_mfma_f32_32x32x16_bf16 v[144:159], v[100:103], v[188:191], v[144:159]
    ds_read_b64_tr_b16 v[204:205], v251 offset:41984
    ds_read_b64_tr_b16 v[206:207], v251 offset:42240
    s_waitcnt lgkmcnt(8)
    s_barrier
    v_mfma_f32_32x32x16_bf16 v[128:143], v[192:195], v[104:107], v[128:143]
    s_add_u32 m0, s62, 16384
    s_add_u32 s11, s11, 172032
    buffer_load_dwordx4 v15, s[16:19], s11 offen lds
    ds_read_b64_tr_b16 v[176:177], v248 offset:49152
    ds_read_b64_tr_b16 v[178:179], v248 offset:49408
    v_mfma_f32_32x32x16_bf16 v[144:159], v[104:107], v[196:199], v[144:159]
    s_add_u32 m0, s62, 20480
    s_add_u32 s11, s11, 172032
    buffer_load_dwordx4 v15, s[16:19], s11 offen lds
    ds_read_b64_tr_b16 v[180:181], v248 offset:50176
    ds_read_b64_tr_b16 v[182:183], v248 offset:50432
    s_waitcnt lgkmcnt(6)
    v_mfma_f32_32x32x16_bf16 v[128:143], v[200:203], v[108:111], v[128:143]
    s_add_u32 m0, s62, 24576
    s_add_u32 s11, s11, 172032
    buffer_load_dwordx4 v15, s[16:19], s11 offen lds
    ds_read_b64_tr_b16 v[184:185], v249 offset:49152
    ds_read_b64_tr_b16 v[186:187], v249 offset:49408
    s_waitcnt lgkmcnt(6)
    v_mfma_f32_32x32x16_bf16 v[144:159], v[108:111], v[204:207], v[144:159]
    s_mul_i32 s61, s8, 7168
    s_add_u32 s61, s61, 86016
    s_add_u32 m0, s61, 0
    s_nop 0
    ds_read_b64_tr_b16 v[188:189], v249 offset:50176
    ds_read_b64_tr_b16 v[190:191], v249 offset:50432
    s_waitcnt lgkmcnt(6)
    v_mfma_f32_32x32x16_bf16 v[128:143], v[176:179], v[112:115], v[128:143]
    buffer_load_dwordx4 v240, s[96:99], s51 offen lds
    s_add_u32 m0, s61, 1024
    s_add_u32 s51, s51, s58
    ds_read_b64_tr_b16 v[192:193], v250 offset:49152
    ds_read_b64_tr_b16 v[194:195], v250 offset:49408
    s_waitcnt lgkmcnt(6)
    v_mfma_f32_32x32x16_bf16 v[144:159], v[112:115], v[180:183], v[144:159]
    buffer_load_dwordx4 v241, s[96:99], s51 offen lds
    s_add_u32 m0, s61, 2048
    s_add_u32 s51, s51, s59
    v_dot2_f32_bf16 v11, v176, v8, v11
    v_dot2_f32_bf16 v12, v180, v8, v12
    v_dot2_f32_bf16 v11, v177, v8, v11
    v_dot2_f32_bf16 v12, v181, v8, v12
    v_dot2_f32_bf16 v11, v178, v8, v11
    v_dot2_f32_bf16 v12, v182, v8, v12
    v_dot2_f32_bf16 v11, v179, v8, v11
    v_dot2_f32_bf16 v12, v183, v8, v12
    v_dot2_f32_bf16 v10, v112, v112, v10
    v_dot2_f32_bf16 v10, v113, v113, v10
    v_dot2_f32_bf16 v10, v114, v114, v10
    v_dot2_f32_bf16 v10, v115, v115, v10
    v_dot2_f32_bf16 v10, v116, v116, v10
    v_dot2_f32_bf16 v10, v117, v117, v10
    v_dot2_f32_bf16 v10, v118, v118, v10
    v_dot2_f32_bf16 v10, v119, v119, v10
    v_dot2_f32_bf16 v10, v120, v120, v10
    v_dot2_f32_bf16 v10, v121, v121, v10
    v_dot2_f32_bf16 v10, v122, v122, v10
    v_dot2_f32_bf16 v10, v123, v123, v10
    v_dot2_f32_bf16 v10, v124, v124, v10
    v_dot2_f32_bf16 v10, v125, v125, v10
    v_dot2_f32_bf16 v10, v126, v126, v10
    v_dot2_f32_bf16 v10, v127, v127, v10
    s_lshl_b32 s3, s8, 8
    s_add_u32 s3, s3, 118784
    v_add_u32 v215, s3, v3
    ds_write2st64_b32 v215, v11, v12 offset0:0 offset1:4
    ds_read_b64_tr_b16 v[196:197], v250 offset:50176
    ds_read_b64_tr_b16 v[198:199], v250 offset:50432
    s_waitcnt lgkmcnt(7)
    v_mfma_f32_32x32x16_bf16 v[128:143], v[184:187], v[116:119], v[128:143]
    buffer_load_dwordx4 v240, s[96:99], s51 offen lds
    s_add_u32 m0, s61, 3072
    s_add_u32 s51, s51, s58
    ds_read_b64_tr_b16 v[200:201], v251 offset:49152
    ds_read_b64_tr_b16 v[202:203], v251 offset:49408
    s_waitcnt lgkmcnt(7)
    v_mfma_f32_32x32x16_bf16 v[144:159], v[116:119], v[188:191], v[144:159]
    buffer_load_dwordx4 v241, s[96:99], s51 offen lds
    s_add_u32 m0, s61, 4096
    s_add_u32 s51, s51, s59
    ds_read_b64_tr_b16 v[204:205], v251 offset:50176
    ds_read_b64_tr_b16 v[206:207], v251 offset:50432
    s_waitcnt lgkmcnt(6)
    s_barrier
    v_add_u32 v255, 118784, v3
    ds_read2st64_b32 v[224:225], v255 offset0:0 offset1:4
    ds_read2st64_b32 v[226:227], v255 offset0:1 offset1:5
    ds_read2st64_b32 v[228:229], v255 offset0:2 offset1:6
    ds_read2st64_b32 v[230:231], v255 offset0:3 offset1:7
    v_mfma_f32_32x32x16_bf16 v[128:143], v[192:195], v[120:123], v[128:143]
    buffer_load_dwordx4 v240, s[96:99], s51 offen lds
    s_add_u32 m0, s61, 5120
    s_add_u32 s51, s51, s58
    s_waitcnt lgkmcnt(8)
    v_mfma_f32_32x32x16_bf16 v[144:159], v[120:123], v[196:199], v[144:159]
    buffer_load_dwordx4 v241, s[96:99], s51 offen lds
    s_add_u32 m0, s61, 6144
    s_add_u32 s51, s51, s59
    s_waitcnt lgkmcnt(0)
    v_add_f32 v11, v224, v226
    v_add_f32 v12, v225, v227
    v_add_f32 v228, v228, v230
    v_add_f32 v229, v229, v231
    v_add_f32 v11, v11, v228
    v_add_f32 v12, v12, v229
    v_mfma_f32_32x32x16_bf16 v[128:143], v[200:203], v[124:127], v[128:143]
    buffer_load_dwordx4 v240, s[96:99], s51 offen lds
    v_cvt_pk_bf16_f32 v255, v11, v11
    v_lshlrev_b32 v255, 16, v255
    v_sub_f32 v255, v11, v255
    v_cvt_pk_bf16_f32 v216, v11, v255
    v_mov_b32 v217, v216
    v_mov_b32 v218, 0
    v_mov_b32 v219, 0
    v_mfma_f32_32x32x16_bf16 v[144:159], v[124:127], v[204:207], v[144:159]
    v_cvt_pk_bf16_f32 v255, v12, v12
    v_lshlrev_b32 v255, 16, v255
    v_sub_f32 v255, v12, v255
    v_cvt_pk_bf16_f32 v220, v12, v255
    v_mov_b32 v221, v220
    v_mov_b32 v222, 0
    v_mov_b32 v223, 0
    s_waitcnt vmcnt(14)
    v_mov_b32 v244, v10
    v_mov_b32 v9, v140
    v_mov_b32 v245, v140
    v_and_b32 v246, 31, v0
    s_add_u32 s9, s45, 11264
    v_permlane32_swap_b32 v10, v244
    v_permlane32_swap_b32 v245, v9
    v_add_f32 v10, v10, v244
    v_mul_f32 v9, 0x3b124925, v9
    v_mul_f32 v10, 0x3b124925, v10
    v_lshl_add_u32 v246, v246, 2, s9
    v_lshrrev_b32 v247, 5, v0
    v_fma_f32 v245, -v9, v9, v10
    v_max_f32 v245, 0, v245
    v_add_f32 v245, 0x3727c5ac, v245
    v_rsq_f32 v212, v245
    v_lshl_add_u32 v247, v247, 4, s9
    v_mov_b32 v10, v242
    ds_write_b32 v246, v212
    v_cvt_pk_bf16_f32 v208, -v9, -v9
    v_lshlrev_b32 v244, 16, v208
    v_add_f32 v244, v9, v244
    v_cvt_pk_bf16_f32 v209, -v244, -v244
    v_mov_b32 v210, 0
    v_mov_b32 v211, 0
    ds_read_b128 v[224:227], v247 offset:0
    ds_read_b128 v[228:231], v247 offset:32
    ds_read_b128 v[232:235], v247 offset:64
    ds_read_b128 v[236:239], v247 offset:96
    v_mfma_f32_32x32x16_bf16 v[128:143], v[216:219], v[208:211], v[128:143]
    v_mfma_f32_32x32x16_bf16 v[144:159], v[208:211], v[220:223], v[144:159]
    v_mul_f32 v214, 0x3e8b97f6, v212
    s_lshl_b32 s9, s26, 6
    s_add_u32 s9, s9, s28
    s_lshl_b32 s48, s9, 12
    s_lshl_b32 s9, s26, 2
    s_add_u32 s9, s9, s8
    s_lshl_b32 s9, s9, 8
    s_add_u32 s49, s9, 13578240
    s_add_u32 s9, s48, 0
    s_mov_b32 s46, 0x10000000
    s_mov_b32 s47, 0x10000000
    v_cndmask_b32 v11, 0, v8, s[46:47]
    s_mov_b32 s46, 0xf0000000
    s_mov_b32 s47, 0xf0000000
    v_mov_b32 v12, 0x3f80
    s_waitcnt vmcnt(7)
    s_barrier
    ds_read_b64_tr_b16 v[176:177], v252 offset:0
    ds_read_b64_tr_b16 v[178:179], v252 offset:256
    ds_read_b64_tr_b16 v[180:181], v252 offset:4096
    ds_read_b64_tr_b16 v[182:183], v252 offset:4352
    ds_read_b64_tr_b16 v[184:185], v252 offset:8192
    ds_read_b64_tr_b16 v[186:187], v252 offset:8448
    ds_read_b64_tr_b16 v[188:189], v252 offset:12288
    ds_read_b64_tr_b16 v[190:191], v252 offset:12544
    v_pk_mul_f32 v[128:129], v[128:129], v[212:213] op_sel_hi:[1,0]
    v_pk_mul_f32 v[130:131], v[130:131], v[212:213] op_sel_hi:[1,0]
    v_pk_mul_f32 v[132:133], v[132:133], v[212:213] op_sel_hi:[1,0]
    v_pk_mul_f32 v[134:135], v[134:135], v[212:213] op_sel_hi:[1,0]
    v_pk_mul_f32 v[136:137], v[136:137], v[212:213] op_sel_hi:[1,0]
    v_pk_mul_f32 v[138:139], v[138:139], v[212:213] op_sel_hi:[1,0]
    v_pk_mul_f32 v[140:141], v[140:141], v[212:213] op_sel_hi:[1,0]
    v_pk_mul_f32 v[142:143], v[142:143], v[212:213] op_sel_hi:[1,0]
    v_cvt_pk_bf16_f32 v160, v128, v129
    v_cvt_pk_bf16_f32 v161, v130, v131
    v_cvt_pk_bf16_f32 v162, v132, v133
    v_cvt_pk_bf16_f32 v163, v134, v135
    buffer_store_dwordx4 v[160:163], v1, s[4:7], s9 offen sc1
    v_cvt_pk_bf16_f32 v164, v136, v137
    v_cvt_pk_bf16_f32 v165, v138, v139
    v_cvt_pk_bf16_f32 v166, v140, v141
    v_cvt_pk_bf16_f32 v167, v142, v143
    v_cndmask_b32 v166, v166, v8, s[36:37]
    v_cndmask_b32 v167, v167, v12, s[36:37]
    buffer_store_dwordx4 v[164:167], v1, s[4:7], s9 offen offset:1024 sc1
    s_waitcnt lgkmcnt(8)
    v_pk_mul_f32 v[144:145], v[144:145], v[224:225]
    v_pk_mul_f32 v[146:147], v[146:147], v[226:227]
    v_pk_mul_f32 v[148:149], v[148:149], v[228:229]
    v_pk_mul_f32 v[150:151], v[150:151], v[230:231]
    v_pk_mul_f32 v[152:153], v[152:153], v[232:233]
    v_pk_mul_f32 v[154:155], v[154:155], v[234:235]
    v_pk_mul_f32 v[156:157], v[156:157], v[236:237]
    v_pk_mul_f32 v[158:159], v[158:159], v[238:239]
    v_cvt_pk_bf16_f32 v168, v144, v145
    v_cndmask_b32 v168, v168, v11, s[46:47]
    v_cvt_pk_bf16_f32 v169, v146, v147
    v_cndmask_b32 v169, v169, v11, s[46:47]
    v_cvt_pk_bf16_f32 v170, v148, v149
    v_cndmask_b32 v170, v170, v11, s[46:47]
    v_cvt_pk_bf16_f32 v171, v150, v151
    v_cndmask_b32 v171, v171, v11, s[46:47]
    buffer_store_dwordx4 v[168:171], v1, s[4:7], s9 offen offset:2048 sc1
    v_cvt_pk_bf16_f32 v172, v152, v153
    v_cndmask_b32 v172, v172, v11, s[46:47]
    v_cvt_pk_bf16_f32 v173, v154, v155
    v_cndmask_b32 v173, v173, v11, s[46:47]
    v_cvt_pk_bf16_f32 v174, v156, v157
    v_cndmask_b32 v174, v174, v11, s[46:47]
    v_cvt_pk_bf16_f32 v175, v158, v159
    v_cndmask_b32 v175, v175, v11, s[46:47]
    buffer_store_dwordx4 v[172:175], v1, s[4:7], s9 offen offset:3072 sc1
    s_waitcnt lgkmcnt(6)
    v_mfma_f32_32x32x16_bf16 v[224:239], v[176:179], v[16:19], 0
    s_cmp_ge_u32 s2, 188
    s_cselect_b32 s52, 2.0, s52
    s_cselect_b32 s55, 0, s55
    v_bfe_u32 v255, v0, 5, 1
    v_lshlrev_b32 v248, 8, v255
    v_bfe_u32 v255, v0, 2, 2
    v_lshl_add_u32 v248, v255, 6, v248
    v_bfe_u32 v255, v0, 4, 1
    v_lshl_add_u32 v248, v255, 5, v248
    v_and_b32 v255, 3, v0
    v_lshl_add_u32 v248, v255, 3, v248
    s_mul_i32 s96, s8, 7168
    s_add_u32 s96, s96, 86016
    v_add_u32 v248, s96, v248
    v_mov_b32 v255, 0x3f803f80
    s_mov_b32 s98, s52
    s_mov_b32 s99, s53
    s_mov_b32 s11, s55
    s_mov_b32 s3, s54
    v_accvgpr_write_b32 a140, v255
    v_accvgpr_write_b32 a141, v255
    v_accvgpr_write_b32 a142, v255
    v_accvgpr_write_b32 a143, v255
    s_mov_b32 s61, 0
    s_waitcnt vmcnt(4)
    ds_read_b64_tr_b16 a[112:113], v248 offset:0
    ds_read_b64_tr_b16 a[114:115], v248 offset:512
    ds_read_b64_tr_b16 a[116:117], v248 offset:1024
    ds_read_b64_tr_b16 v[192:193], v252 offset:16384
    ds_read_b64_tr_b16 v[194:195], v252 offset:16640
    s_waitcnt lgkmcnt(9)
    v_mfma_f32_32x32x16_bf16 v[224:239], v[180:183], v[32:35], v[224:239]
    ds_read_b64_tr_b16 a[118:119], v248 offset:1536
    ds_read_b64_tr_b16 a[120:121], v248 offset:2048
    ds_read_b64_tr_b16 a[122:123], v248 offset:2560
    v_dot2_f32_bf16 v13, v176, v8, v13
    v_dot2_f32_bf16 v13, v177, v8, v13
    v_dot2_f32_bf16 v13, v178, v8, v13
    v_dot2_f32_bf16 v13, v179, v8, v13
    v_dot2_f32_bf16 v13, v180, v8, v13
    v_dot2_f32_bf16 v13, v181, v8, v13
    v_dot2_f32_bf16 v13, v182, v8, v13
    v_dot2_f32_bf16 v13, v183, v8, v13
    ds_read_b64_tr_b16 v[196:197], v252 offset:20480
    ds_read_b64_tr_b16 v[198:199], v252 offset:20736
    s_waitcnt lgkmcnt(12)
    v_mfma_f32_32x32x16_bf16 v[224:239], v[184:187], v[48:51], v[224:239]
    ds_read_b64_tr_b16 a[124:125], v248 offset:3072
    ds_read_b64_tr_b16 a[126:127], v248 offset:3584
    ds_read_b64_tr_b16 a[128:129], v248 offset:4096
    ds_read_b64_tr_b16 v[200:201], v252 offset:24576
    ds_read_b64_tr_b16 v[202:203], v252 offset:24832
    s_waitcnt lgkmcnt(15)
    v_mfma_f32_32x32x16_bf16 v[224:239], v[188:191], v[64:67], v[224:239]
    ds_read_b64_tr_b16 a[130:131], v248 offset:4608
    ds_read_b64_tr_b16 a[132:133], v248 offset:5120
    ds_read_b64_tr_b16 a[134:135], v248 offset:5632
    v_dot2_f32_bf16 v13, v184, v8, v13
    v_dot2_f32_bf16 v13, v185, v8, v13
    v_dot2_f32_bf16 v13, v186, v8, v13
    v_dot2_f32_bf16 v13, v187, v8, v13
    v_dot2_f32_bf16 v13, v188, v8, v13
    v_dot2_f32_bf16 v13, v189, v8, v13
    v_dot2_f32_bf16 v13, v190, v8, v13
    v_dot2_f32_bf16 v13, v191, v8, v13
    ds_read_b64_tr_b16 v[204:205], v253 offset:0
    ds_read_b64_tr_b16 v[206:207], v253 offset:256
    s_waitcnt lgkmcnt(15)
    v_mfma_f32_32x32x16_bf16 v[224:239], v[192:195], v[80:83], v[224:239]
    ds_read_b64_tr_b16 a[136:137], v248 offset:6144
    ds_read_b64_tr_b16 a[138:139], v248 offset:6656
    s_waitcnt lgkmcnt(0)
    ds_read_b64_tr_b16 v[176:177], v254 offset:0
    ds_read_b64_tr_b16 v[178:179], v254 offset:256
    v_mfma_f32_32x32x16_bf16 v[224:239], v[196:199], v[96:99], v[224:239]
    buffer_store_dwordx4 a[112:115], v1, s[4:7], s98 offen sc1
    v_mfma_f32_32x32x16_bf16 a[144:159], a[140:143], a[112:115], 0
    s_add_u32 s98, s98, s99
    buffer_store_dwordx4 a[116:119], v1, s[4:7], s98 offen sc1
    v_dot2_f32_bf16 v13, v192, v8, v13
    v_dot2_f32_bf16 v13, v193, v8, v13
    v_dot2_f32_bf16 v13, v194, v8, v13
    v_dot2_f32_bf16 v13, v195, v8, v13
    v_dot2_f32_bf16 v13, v196, v8, v13
    v_dot2_f32_bf16 v13, v197, v8, v13
    v_dot2_f32_bf16 v13, v198, v8, v13
    v_dot2_f32_bf16 v13, v199, v8, v13
    ds_read_b64_tr_b16 v[180:181], v243 offset:0
    ds_read_b64_tr_b16 v[182:183], v243 offset:256
    v_mfma_f32_32x32x16_bf16 v[224:239], v[200:203], v[112:115], v[224:239]
    v_and_b32 v14, 0xff, v10
    v_cmp_gt_u32 vcc, 4, v14
    s_cbranch_vccnz L_init_spin_7
L_init_ok_8:
    v_mov_b32 v255, 1
    s_mov_b64 exec, 1
    s_waitcnt vmcnt(2)
    buffer_atomic_add v255, off, s[4:7], s49 sc1
    s_mov_b64 exec, -1
    v_mfma_f32_32x32x16_bf16 a[144:159], a[140:143], a[116:119], a[144:159]
    s_add_u32 s98, s98, s99
    buffer_store_dwordx4 a[120:123], v1, s[4:7], s98 offen sc1
    v_mfma_f32_32x32x16_bf16 a[144:159], a[140:143], a[120:123], a[144:159]
    s_add_u32 s98, s98, s99
    v_dot2_f32_bf16 v13, v200, v8, v13
    v_dot2_f32_bf16 v13, v201, v8, v13
    v_dot2_f32_bf16 v13, v202, v8, v13
    v_dot2_f32_bf16 v13, v203, v8, v13
    ds_read_b64_tr_b16 v[184:185], v253 offset:4096
    ds_read_b64_tr_b16 v[186:187], v253 offset:4352
    v_mfma_f32_32x32x16_bf16 v[224:239], v[204:207], v[20:23], v[224:239]
    buffer_store_dwordx4 a[124:127], v1, s[4:7], s98 offen sc1
    v_mfma_f32_32x32x16_bf16 a[144:159], a[140:143], a[124:127], a[144:159]
    s_add_u32 s98, s98, s99
    s_add_u32 s98, s98, s11
    ds_write_b32 v215, v13 offset:2048
    ds_read_b64_tr_b16 v[188:189], v254 offset:4096
    ds_read_b64_tr_b16 v[190:191], v254 offset:4352
    s_waitcnt lgkmcnt(7)
    v_mfma_f32_32x32x16_bf16 v[224:239], v[176:179], v[24:27], v[224:239]
    buffer_store_dwordx4 a[128:131], v1, s[4:7], s98 offen sc1
    v_mfma_f32_32x32x16_bf16 a[144:159], a[140:143], a[128:131], a[144:159]
    s_add_u32 s98, s98, s99
    buffer_store_dwordx4 a[132:135], v1, s[4:7], s98 offen sc1
    ds_read_b64_tr_b16 v[192:193], v243 offset:4096
    ds_read_b64_tr_b16 v[194:195], v243 offset:4352
    s_waitcnt lgkmcnt(7)
    v_mfma_f32_32x32x16_bf16 v[224:239], v[180:183], v[28:31], v[224:239]
    v_mfma_f32_32x32x16_bf16 a[144:159], a[140:143], a[132:135], a[144:159]
    s_add_u32 s98, s98, s99
    buffer_store_dwordx4 a[136:139], v1, s[4:7], s98 offen sc1
    v_mfma_f32_32x32x16_bf16 a[144:159], a[140:143], a[136:139], a[144:159]
    s_add_u32 s98, s98, s99
    ds_read_b64_tr_b16 v[196:197], v253 offset:8192
    ds_read_b64_tr_b16 v[198:199], v253 offset:8448
    s_waitcnt lgkmcnt(7)
    v_mfma_f32_32x32x16_bf16 v[224:239], v[184:187], v[36:39], v[224:239]
    s_lshl_b32 s11, s61, 12
    s_add_u32 s11, s11, s8
    s_lshl_b32 s11, s11, 8
    s_add_u32 s11, s11, 124928
    v_add_u32 v128, s11, v3
    s_waitcnt lgkmcnt(6)
    s_barrier
    v_add_u32 v244, 118784, v3
    ds_read2st64_b32 v[220:221], v244 offset0:8 offset1:9
    ds_read2st64_b32 v[222:223], v244 offset0:10 offset1:11
    ds_read_b64_tr_b16 v[200:201], v254 offset:8192
    ds_read_b64_tr_b16 v[202:203], v254 offset:8448
    s_waitcnt lgkmcnt(8)
    v_mfma_f32_32x32x16_bf16 v[224:239], v[188:191], v[40:43], v[224:239]
    ds_write_b32 v128, a144
    v_add_u32 v128, 124928, v3
    s_waitcnt lgkmcnt(0)
    ds_read_b64_tr_b16 v[204:205], v243 offset:8192
    ds_read_b64_tr_b16 v[206:207], v243 offset:8448
    v_mfma_f32_32x32x16_bf16 v[224:239], v[192:195], v[44:47], v[224:239]
    s_barrier
    ds_read2st64_b32 v[130:131], v128 offset0:2 offset1:3
    ds_read2st64_b32 v[128:129], v128 offset0:0 offset1:1
    ds_read_b64_tr_b16 v[176:177], v253 offset:12288
    ds_read_b64_tr_b16 v[178:179], v253 offset:12544
    v_mfma_f32_32x32x16_bf16 v[224:239], v[196:199], v[52:55], v[224:239]
    v_accvgpr_read_b32 v134, a0
    v_lshl_or_b32 v134, v134, 16, v134
    v_cndmask_b32 v134, v134, 0, s[36:37]
    v_add_f32 v220, v220, v221
    v_add_f32 v222, v222, v223
    v_add_f32 v13, v220, v222
    v_cvt_pk_bf16_f32 v244, v13, v13
    ds_read_b64_tr_b16 v[180:181], v254 offset:12288
    ds_read_b64_tr_b16 v[182:183], v254 offset:12544
    v_mfma_f32_32x32x16_bf16 v[224:239], v[200:203], v[56:59], v[224:239]
    s_waitcnt lgkmcnt(4)
    v_add_f32 v128, v128, v129
    v_add_f32 v130, v130, v131
    v_add_f32 v128, v128, v130
    v_cvt_pk_bf16_f32 v129, v128, v128
    v_lshlrev_b32 v129, 16, v129
    v_sub_f32 v129, v128, v129
    v_cvt_pk_bf16_f32 v132, v128, v129
    v_cndmask_b32 v132, v132, 0, s[36:37]
    v_mov_b32 v135, 0
    v_mov_b32 v133, v132
    buffer_store_dwordx4 v[132:135], v1, s[4:7], s3 offen sc1
    v_lshlrev_b32 v244, 16, v244
    v_sub_f32 v244, v13, v244
    v_cvt_pk_bf16_f32 v216, v13, v244
    v_mov_b32 v217, v216
    ds_read_b64_tr_b16 v[184:185], v243 offset:12288
    ds_read_b64_tr_b16 v[186:187], v243 offset:12544
    v_mfma_f32_32x32x16_bf16 v[224:239], v[204:207], v[60:63], v[224:239]
    s_mul_i32 s10, s35, s35
    s_lshl_b32 s10, s10, 18
    s_lshl_b32 s11, s35, 10
    s_add_u32 s10, s10, s11
    s_add_u32 s10, s10, 4
    v_cmp_ne_u32 vcc, s10, v10
    s_lshl_b32 s11, 0x01010101, s34
    s_or_b32 s9, vcc_lo, vcc_hi
    s_and_b32 s9, s9, s11
    s_cselect_b32 s24, 1, 0
    v_and_b32 v15, 31, v0
    v_mul_u32_u24 v15, 896, v15
    v_lshrrev_b32 v14, 5, v0
    v_lshl_add_u32 v15, v14, 3, v15
    ds_read_b64_tr_b16 v[188:189], v253 offset:16384
    ds_read_b64_tr_b16 v[190:191], v253 offset:16640
    s_waitcnt lgkmcnt(6)
    v_mfma_f32_32x32x16_bf16 v[224:239], v[176:179], v[68:71], v[224:239]
    s_mul_i32 s63, s30, 28672
    s_lshl_b32 s60, s31, 6
    s_add_u32 s63, s63, s60
    buffer_load_dwordx2 a[240:241], v15, s[12:15], s63 offen offset:0
    ds_read_b64_tr_b16 v[192:193], v254 offset:16384
    ds_read_b64_tr_b16 v[194:195], v254 offset:16640
    s_waitcnt lgkmcnt(6)
    v_mfma_f32_32x32x16_bf16 v[224:239], v[180:183], v[72:75], v[224:239]
    buffer_load_dwordx2 a[242:243], v15, s[12:15], s63 offen offset:16
    buffer_load_dwordx2 a[244:245], v15, s[12:15], s63 offen offset:32
    ds_read_b64_tr_b16 v[196:197], v243 offset:16384
    ds_read_b64_tr_b16 v[198:199], v243 offset:16640
    s_waitcnt lgkmcnt(6)
    v_mfma_f32_32x32x16_bf16 v[224:239], v[184:187], v[76:79], v[224:239]
    buffer_load_dwordx2 a[246:247], v15, s[12:15], s63 offen offset:48
    ds_read_b64_tr_b16 v[200:201], v253 offset:20480
    ds_read_b64_tr_b16 v[202:203], v253 offset:20736
    s_waitcnt lgkmcnt(6)
    v_mfma_f32_32x32x16_bf16 v[224:239], v[188:191], v[84:87], v[224:239]
    ds_read_b64_tr_b16 v[204:205], v254 offset:20480
    ds_read_b64_tr_b16 v[206:207], v254 offset:20736
    s_waitcnt lgkmcnt(6)
    v_mfma_f32_32x32x16_bf16 v[224:239], v[192:195], v[88:91], v[224:239]
    ds_read_b64_tr_b16 v[176:177], v243 offset:20480
    ds_read_b64_tr_b16 v[178:179], v243 offset:20736
    s_waitcnt lgkmcnt(6)
    v_mfma_f32_32x32x16_bf16 v[224:239], v[196:199], v[92:95], v[224:239]
    ds_read_b64_tr_b16 v[180:181], v253 offset:24576
    ds_read_b64_tr_b16 v[182:183], v253 offset:24832
    s_waitcnt lgkmcnt(6)
    v_mfma_f32_32x32x16_bf16 v[224:239], v[200:203], v[100:103], v[224:239]
    ds_read_b64_tr_b16 v[184:185], v254 offset:24576
    ds_read_b64_tr_b16 v[186:187], v254 offset:24832
    s_waitcnt lgkmcnt(6)
    v_mfma_f32_32x32x16_bf16 v[224:239], v[204:207], v[104:107], v[224:239]
    ds_read_b64_tr_b16 v[188:189], v243 offset:24576
    ds_read_b64_tr_b16 v[190:191], v243 offset:24832
    s_waitcnt lgkmcnt(6)
    v_mfma_f32_32x32x16_bf16 v[224:239], v[176:179], v[108:111], v[224:239]
    s_waitcnt lgkmcnt(4)
    v_mfma_f32_32x32x16_bf16 v[224:239], v[180:183], v[116:119], v[224:239]
    s_waitcnt lgkmcnt(2)
    v_mfma_f32_32x32x16_bf16 v[224:239], v[184:187], v[120:123], v[224:239]
    s_waitcnt lgkmcnt(0)
    v_mfma_f32_32x32x16_bf16 v[224:239], v[188:191], v[124:127], v[224:239]
    v_mfma_f32_32x32x16_bf16 v[224:239], v[216:219], v[208:211], v[224:239]
    s_nop 7
    s_nop 3
    v_pk_mul_f32 v[224:225], v[224:225], v[214:215] op_sel_hi:[1,0]
    v_pk_mul_f32 v[226:227], v[226:227], v[214:215] op_sel_hi:[1,0]
    v_pk_mul_f32 v[228:229], v[228:229], v[214:215] op_sel_hi:[1,0]
    v_pk_mul_f32 v[230:231], v[230:231], v[214:215] op_sel_hi:[1,0]
    v_pk_mul_f32 v[232:233], v[232:233], v[214:215] op_sel_hi:[1,0]
    v_pk_mul_f32 v[234:235], v[234:235], v[214:215] op_sel_hi:[1,0]
    v_pk_mul_f32 v[236:237], v[236:237], v[214:215] op_sel_hi:[1,0]
    v_pk_mul_f32 v[238:239], v[238:239], v[214:215] op_sel_hi:[1,0]
    v_cvt_pk_bf16_f32 v32, v224, v225
    v_cvt_pk_bf16_f32 v33, v226, v227
    v_cvt_pk_bf16_f32 v34, v228, v229
    v_cvt_pk_bf16_f32 v35, v230, v231
    ds_write_b128 v7, v[32:35] offset:8192
    v_cvt_pk_bf16_f32 v36, v232, v233
    v_cvt_pk_bf16_f32 v37, v234, v235
    v_cvt_pk_bf16_f32 v38, v236, v237
    v_cvt_pk_bf16_f32 v39, v238, v239
    v_cndmask_b32 v38, v38, 0, s[36:37]
    v_cndmask_b32 v39, v39, 0, s[36:37]
    ds_write_b128 v7, v[36:39] offset:9216
    s_waitcnt lgkmcnt(0)
    s_barrier
    ds_read_b128 v[8:11], v6 offset:0
    ds_read_b128 v[12:15], v6 offset:1024
    ds_read_b128 v[16:19], v5 offset:4096
    ds_read_b128 v[20:23], v5 offset:5120
    ds_read_b128 v[24:27], v4 offset:8192
    ds_read_b128 v[28:31], v4 offset:9216
    v_mov_b32 v255, 0
    s_mov_b64 exec, 1
    buffer_atomic_add v255, off, s[4:7], s49 offset:0 sc0 sc1
    s_mov_b64 exec, -1
    s_mov_b32 s61, 0
    v_mfma_f32_32x32x16_bf16 v[104:119], v[160:163], v[32:35], 0
    v_mfma_f32_32x32x16_bf16 v[104:119], v[164:167], v[36:39], v[104:119]
    s_waitcnt lgkmcnt(4)
    v_mfma_f32_32x32x16_bf16 v[120:135], v[160:163], v[8:11], 0
    v_mfma_f32_32x32x16_bf16 v[120:135], v[164:167], v[12:15], v[120:135]
    s_lshl_b32 s9, s26, 6
    s_add_u32 s9, s9, s8
    s_lshl_b32 s9, s9, 12
    s_add_u32 s9, s9, 0
    v_add_u32 v241, s9, v1
    s_mul_i32 s9, s33, 118784
    s_add_u32 s9, s9, 10276864
    s_add_u32 s62, s9, 114688
    s_mul_i32 s63, s8, 28672
    v_max3_f32 v227, v104, v105, v106
    v_max3_f32 v227, v227, v107, v108
    v_max3_f32 v227, v227, v109, v110
    v_max3_f32 v227, v227, v111, v112
    v_max3_f32 v227, v227, v113, v114
    v_max3_f32 v227, v227, v115, v116
    v_max3_f32 v227, v227, v117, v118
    v_max_f32 v227, v227, v119
    s_waitcnt lgkmcnt(2)
    v_mfma_f32_32x32x16_bf16 v[104:119], v[160:163], v[16:19], 0
    v_mfma_f32_32x32x16_bf16 v[104:119], v[164:167], v[20:23], v[104:119]
    s_add_u32 s9, s9, s63
    v_add_u32 v242, s9, v1
    v_max3_f32 v224, v120, v121, v122
    v_max3_f32 v224, v224, v123, v124
    v_max3_f32 v224, v224, v125, v126
    v_max3_f32 v224, v224, v127, v128
    v_max3_f32 v224, v224, v129, v130
    v_max3_f32 v224, v224, v131, v132
    v_max3_f32 v224, v224, v133, v134
    v_max_f32 v224, v224, v135
    s_waitcnt lgkmcnt(0)
    v_mfma_f32_32x32x16_bf16 v[120:135], v[160:163], v[24:27], 0
    v_mfma_f32_32x32x16_bf16 v[120:135], v[164:167], v[28:31], v[120:135]
    s_nop 0
    v_max3_f32 v225, v104, v105, v106
    v_max3_f32 v225, v225, v107, v108
    v_max3_f32 v225, v225, v109, v110
    v_max3_f32 v225, v225, v111, v112
    v_max3_f32 v225, v225, v113, v114
    v_max3_f32 v225, v225, v115, v116
    v_max3_f32 v225, v225, v117, v118
    v_max_f32 v225, v225, v119
    s_lshl_b32 s9, s31, 15
    s_lshl_b32 s10, s8, 13
    s_add_u32 s10, s10, 9818112
    v_max3_f32 v226, v120, v121, v122
    v_max3_f32 v226, v226, v123, v124
    v_max3_f32 v226, v226, v125, v126
    v_max3_f32 v226, v226, v127, v128
    v_max3_f32 v226, v226, v129, v130
    v_max3_f32 v226, v226, v131, v132
    v_max3_f32 v226, v226, v133, v134
    v_max_f32 v226, v226, v135
    s_mov_b32 exec_lo, 0
    v_cvt_pk_bf16_f32 v14, -v224, 0
    v_cvt_pk_bf16_f32 v22, -v225, 0
    v_cvt_pk_bf16_f32 v30, -v226, 0
    v_cvt_pk_bf16_f32 v38, -v227, 0
    v_lshlrev_b32 v224, 16, v14
    v_lshlrev_b32 v225, 16, v22
    v_lshlrev_b32 v226, 16, v30
    v_lshlrev_b32 v227, 16, v38
    s_mov_b32 exec_lo, -1
    s_add_u32 s11, s9, s10
    v_add_u32 v245, s11, v1
    s_xor_b32 s9, s9, 32768
    s_add_u32 s11, s9, s10
    v_add_u32 v246, s11, v1
    v_lshlrev_b32 v251, 7, v0
    v_and_b32 v252, 0x780, v251
    v_and_b32 v254, 0x180, v251
    v_bfe_u32 v253, v0, 2, 2
    v_lshlrev_b32 v253, 13, v253
    v_lshl_add_u32 v253, v254, 1, v253
    s_mul_i32 s9, s31, 114688
    s_add_u32 s10, s63, 11939840
    s_add_u32 s9, s9, s10
    v_add_u32 v243, s9, v1
    s_mov_b64 exec, 1
    s_branch L_kvchk_10
L_kvpoll_9:
    v_mov_b32 v255, 0
    buffer_atomic_add v255, off, s[4:7], s49 offset:0 sc0 sc1
L_kvchk_10:
    s_waitcnt vmcnt(0)
    v_cmp_gt_u32 vcc, 16, v255
    s_cbranch_vccz L_kvdone_11
    s_sub_u32 s25, s25, 1
    s_cmp_gt_i32 s25, 0
    s_cbranch_scc1 L_kvpoll_9
    s_mov_b32 s25, 0
L_kvdone_11:
    s_mov_b64 exec, -1
    s_waitcnt lgkmcnt(0)
    s_lshl_b32 s9, s27, 14
    s_mov_b32 m0, s63
    s_add_u32 s10, s9, 16384
    s_and_b32 s10, s10, 0x3c000
    buffer_load_dwordx4 v[176:179], v241, s[4:7], s10 offen offset:0 sc1
    buffer_load_dwordx4 v[180:183], v241, s[4:7], s10 offen offset:1024 sc1
    buffer_load_dwordx4 v[184:187], v241, s[4:7], s10 offen offset:2048 sc1
    buffer_load_dwordx4 v[188:191], v241, s[4:7], s10 offen offset:3072 sc1
    s_add_u32 s9, s10, 16384
    s_and_b32 s9, s9, 0x3c000
    buffer_load_dwordx4 v[192:195], v241, s[4:7], s9 offen offset:0 sc1
    buffer_load_dwordx4 v[196:199], v241, s[4:7], s9 offen offset:1024 sc1
    v_mov_b32 v244, s26
    s_add_u32 s96, s26, 16
    v_writelane_b32 v244, s96, 1
    s_add_u32 s96, s26, 32
    v_writelane_b32 v244, s96, 2
    s_lshl_b32 s96, s33, 2
    s_add_u32 s96, s96, 48
    v_writelane_b32 v244, s96, 3
    s_add_u32 s96, s96, 1
    v_writelane_b32 v244, s96, 4
    s_add_u32 s96, s96, 1
    v_writelane_b32 v244, s96, 5
    s_add_u32 s96, s96, 1
    v_writelane_b32 v244, s96, 6
    s_lshl_b32 s96, s31, 2
    s_add_u32 s96, s96, s8
    s_add_u32 s97, s96, 104
    v_writelane_b32 v244, s97, 7
    s_xor_b32 s96, s96, 4
    s_add_u32 s97, s96, 104
    v_writelane_b32 v244, s97, 8
    s_lshl_b32 s96, s31, 1
    s_lshr_b32 s97, s8, 1
    s_add_u32 s96, s96, s97
    s_add_u32 s96, s96, 160
    v_writelane_b32 v244, s96, 9
    s_xor_b32 s96, s96, 2
    v_writelane_b32 v244, s96, 10
    v_lshlrev_b32 v244, 7, v244
    v_add_u32 v244, 13594624, v244
L_attn_restart_12:
    v_mfma_f32_32x32x16_bf16 v[104:119], v[160:163], v[8:11], 0
    v_mfma_f32_32x32x16_bf16 v[104:119], v[164:167], v[12:15], v[104:119]
    s_nop 7
    s_nop 2
    v_mfma_f32_32x32x16_bf16 v[120:135], v[160:163], v[16:19], 0
    buffer_load_dwordx4 v[200:203], v241, s[4:7], s9 offen offset:2048 sc1
    v_exp_f32 v136, v104
    v_exp_f32 v137, v105
    v_exp_f32 v138, v106
    v_cvt_pk_bf16_f32 v144, v136, v137
    v_exp_f32 v139, v107
    v_mfma_f32_32x32x16_bf16 v[120:135], v[164:167], v[20:23], v[120:135]
    buffer_load_dwordx4 v[204:207], v241, s[4:7], s9 offen offset:3072 sc1
    s_add_u32 s10, s9, 16384
    s_and_b32 s10, s10, 0x3c000
    v_exp_f32 v140, v108
    v_cvt_pk_bf16_f32 v145, v138, v139
    v_exp_f32 v141, v109
    v_exp_f32 v142, v110
    v_cvt_pk_bf16_f32 v146, v140, v141
    v_exp_f32 v143, v111
    s_cmp_lg_u32 s61, 0
    s_cbranch_scc1 L_nosig_13
    s_barrier
    s_lshl_b32 s11, s2, 7
    s_add_u32 s11, s11, 13594624
    s_cmp_lt_u32 s2, 188
    s_cselect_b32 s11, s11, 2.0
    s_cmp_eq_u32 s8, 0
    s_cselect_b32 s11, s11, 2.0
    v_mov_b32 v250, 1
    s_mov_b64 exec, 1
    buffer_store_dword v250, off, s[4:7], s11 sc1
    s_mov_b64 exec, -1
L_nosig_13:
    v_exp_f32 v136, v112
    v_cvt_pk_bf16_f32 v147, v142, v143
    v_exp_f32 v137, v113
    v_exp_f32 v138, v114
    v_cvt_pk_bf16_f32 v148, v136, v137
    v_exp_f32 v139, v115
    s_load_dwordx2 s[16:17], s[0:1], 64
    s_mov_b32 s18, 1835008
    v_exp_f32 v140, v116
    v_cvt_pk_bf16_f32 v149, v138, v139
    v_exp_f32 v141, v117
    v_exp_f32 v142, v118
    v_cvt_pk_bf16_f32 v150, v140, v141
    v_exp_f32 v143, v119
    v_mfma_f32_32x32x16_bf16 v[104:119], v[160:163], v[24:27], 0
    buffer_load_dwordx4 v[208:211], v241, s[4:7], s10 offen offset:0 sc1
    s_mov_b32 s12, s4
    s_mov_b32 s13, s5
    v_cvt_pk_bf16_f32 v151, v142, v143
    v_exp_f32 v136, v120
    v_exp_f32 v137, v121
    v_exp_f32 v138, v122
    v_cvt_pk_bf16_f32 v152, v136, v137
    v_exp_f32 v139, v123
    v_mfma_f32_32x32x16_bf16 v[104:119], v[164:167], v[28:31], v[104:119]
    buffer_load_dwordx4 v[212:215], v241, s[4:7], s10 offen offset:1024 sc1
    s_cmp_lg_u32 s29, 0
    s_cselect_b32 s14, 27774976, 0
    s_lshl_b32 s96, s8, 2
    v_exp_f32 v140, v124
    v_cvt_pk_bf16_f32 v153, v138, v139
    v_exp_f32 v141, v125
    v_exp_f32 v142, v126
    v_cvt_pk_bf16_f32 v154, v140, v141
    v_exp_f32 v143, v127
    v_mfma_f32_32x32x16_bf16 v[40:55], v[168:171], v[144:147], 0
    buffer_load_dwordx4 v[216:219], v241, s[4:7], s10 offen offset:2048 sc1
    s_lshl_b32 s38, 0x000f000f, s96
    s_mov_b32 s39, 0
    v_exp_f32 v136, v128
    v_cvt_pk_bf16_f32 v155, v142, v143
    v_exp_f32 v137, v129
    v_exp_f32 v138, v130
    v_cvt_pk_bf16_f32 v156, v136, v137
    v_exp_f32 v139, v131
    v_mfma_f32_32x32x16_bf16 v[40:55], v[172:175], v[148:151], v[40:55]
    buffer_load_dwordx4 v[220:223], v241, s[4:7], s10 offen offset:3072 sc1
    s_add_u32 s9, s10, 16384
    s_mul_i32 s96, s8, 7
    s_lshr_b32 s96, s96, 1
    v_exp_f32 v140, v132
    v_cvt_pk_bf16_f32 v157, v138, v139
    v_exp_f32 v141, v133
    v_exp_f32 v142, v134
    v_cvt_pk_bf16_f32 v158, v140, v141
    v_exp_f32 v143, v135
    v_mfma_f32_32x32x16_bf16 v[120:135], v[160:163], v[32:35], 0
    s_and_b32 s9, s9, 0x3c000
    s_lshl_b32 s40, 0x000f000f, s96
    s_mov_b32 s41, 0
    v_cvt_pk_bf16_f32 v159, v142, v143
    v_exp_f32 v136, v104
    v_exp_f32 v137, v105
    v_exp_f32 v138, v106
    v_cvt_pk_bf16_f32 v144, v136, v137
    v_exp_f32 v139, v107
    v_mfma_f32_32x32x16_bf16 v[120:135], v[164:167], v[36:39], v[120:135]
    buffer_load_dwordx4 v[160:163], v241, s[4:7], s9 offen offset:0 sc1
    s_lshl_b32 s96, s28, 5
    s_lshl_b32 s97, s26, 1
    v_exp_f32 v140, v108
    v_cvt_pk_bf16_f32 v145, v138, v139
    v_exp_f32 v141, v109
    v_exp_f32 v142, v110
    v_cvt_pk_bf16_f32 v146, v140, v141
    v_exp_f32 v143, v111
    v_mfma_f32_32x32x16_bf16 v[56:71], v[168:171], v[152:155], 0
    s_add_u32 s96, s96, s97
    s_lshl_b32 s96, s96, 10
    v_exp_f32 v136, v112
    v_cvt_pk_bf16_f32 v147, v142, v143
    v_exp_f32 v137, v113
    v_exp_f32 v138, v114
    v_cvt_pk_bf16_f32 v148, v136, v137
    v_exp_f32 v139, v115
    v_mfma_f32_32x32x16_bf16 v[56:71], v[172:175], v[156:159], v[56:71]
    buffer_load_dwordx4 v[164:167], v241, s[4:7], s9 offen offset:1024 sc1
    s_waitcnt vmcnt(12)
    s_add_u32 s50, s96, 17747968
    s_mul_i32 s96, s30, 28
    v_exp_f32 v140, v116
    v_cvt_pk_bf16_f32 v149, v138, v139
    v_exp_f32 v141, v117
    v_exp_f32 v142, v118
    v_cvt_pk_bf16_f32 v150, v140, v141
    v_exp_f32 v143, v119
    v_mfma_f32_32x32x16_bf16 v[104:119], v[176:179], v[8:11], 0
    s_lshl_b32 s97, s31, 1
    s_add_u32 s96, s96, s97
    v_cvt_pk_bf16_f32 v151, v142, v143
    v_exp_f32 v136, v120
    v_exp_f32 v137, v121
    v_exp_f32 v138, v122
    v_cvt_pk_bf16_f32 v152, v136, v137
    v_exp_f32 v139, v123
    v_mfma_f32_32x32x16_bf16 v[104:119], v[180:183], v[12:15], v[104:119]
    s_lshl_b32 s53, s96, 10
    s_mul_i32 s96, s30, 3584
    v_exp_f32 v140, v124
    v_cvt_pk_bf16_f32 v153, v138, v139
    v_exp_f32 v141, v125
    v_exp_f32 v142, v126
    v_cvt_pk_bf16_f32 v154, v140, v141
    v_exp_f32 v143, v127
    v_mfma_f32_32x32x16_bf16 v[72:87], v[168:171], v[144:147], 0
    s_lshr_b32 s97, s31, 1
    s_lshl_b32 s97, s97, 9
    v_exp_f32 v136, v128
    v_cvt_pk_bf16_f32 v155, v142, v143
    v_exp_f32 v137, v129
    v_exp_f32 v138, v130
    v_cvt_pk_bf16_f32 v156, v136, v137
    v_exp_f32 v139, v131
    v_mfma_f32_32x32x16_bf16 v[72:87], v[172:175], v[148:151], v[72:87]
    s_add_u32 s96, s96, s97
    s_and_b32 s97, s31, 1
    v_exp_f32 v140, v132
    v_cvt_pk_bf16_f32 v157, v138, v139
    v_exp_f32 v141, v133
    v_exp_f32 v142, v134
    v_cvt_pk_bf16_f32 v158, v140, v141
    v_exp_f32 v143, v135
    v_mfma_f32_32x32x16_bf16 v[120:135], v[176:179], v[16:19], 0
    s_lshl_b32 s97, s97, 2
    s_add_u32 s54, s96, s97
    v_cvt_pk_bf16_f32 v159, v142, v143
    v_exp_f32 v136, v104
    v_exp_f32 v137, v105
    v_exp_f32 v138, v106
    v_cvt_pk_bf16_f32 v144, v136, v137
    v_exp_f32 v139, v107
    v_mfma_f32_32x32x16_bf16 v[120:135], v[180:183], v[20:23], v[120:135]
    s_mul_i32 s96, s32, 112
    s_lshl_b32 s97, s33, 3
    v_exp_f32 v140, v108
    v_cvt_pk_bf16_f32 v145, v138, v139
    v_exp_f32 v141, v109
    v_exp_f32 v142, v110
    v_cvt_pk_bf16_f32 v146, v140, v141
    v_exp_f32 v143, v111
    v_mfma_f32_32x32x16_bf16 v[88:103], v[168:171], v[152:155], 0
    s_add_u32 s96, s96, s97
    s_lshl_b32 s96, s96, 10
    v_exp_f32 v136, v112
    v_cvt_pk_bf16_f32 v147, v142, v143
    v_exp_f32 v137, v113
    v_exp_f32 v138, v114
    v_cvt_pk_bf16_f32 v148, v136, v137
    v_exp_f32 v139, v115
    v_mfma_f32_32x32x16_bf16 v[88:103], v[172:175], v[156:159], v[88:103]
    buffer_load_dwordx4 v[168:171], v241, s[4:7], s9 offen offset:2048 sc1
    s_add_u32 s57, s96, 19845120
    s_lshr_b32 s96, s30, 1
    v_exp_f32 v140, v116
    v_cvt_pk_bf16_f32 v149, v138, v139
    v_exp_f32 v141, v117
    v_exp_f32 v142, v118
    v_cvt_pk_bf16_f32 v150, v140, v141
    v_exp_f32 v143, v119
    v_mfma_f32_32x32x16_bf16 v[104:119], v[176:179], v[24:27], 0
    s_lshl_b32 s96, s96, 8
    s_add_u32 s52, s96, 13553664
    v_cvt_pk_bf16_f32 v151, v142, v143
    v_exp_f32 v136, v120
    v_exp_f32 v137, v121
    v_exp_f32 v138, v122
    v_cvt_pk_bf16_f32 v152, v136, v137
    v_exp_f32 v139, v123
    v_mfma_f32_32x32x16_bf16 v[104:119], v[180:183], v[28:31], v[104:119]
    buffer_load_dwordx4 v[172:175], v241, s[4:7], s9 offen offset:3072 sc1
    s_waitcnt vmcnt(12)
    s_add_u32 s59, s96, 13570048
    s_movk_i32 s42, 4096
    v_exp_f32 v140, v124
    v_cvt_pk_bf16_f32 v153, v138, v139
    v_exp_f32 v141, v125
    v_exp_f32 v142, v126
    v_cvt_pk_bf16_f32 v154, v140, v141
    v_exp_f32 v143, v127
    v_mfma_f32_32x32x16_bf16 v[40:55], v[184:187], v[144:147], v[40:55]
    s_movk_i32 s43, 8192
    s_movk_i32 s44, 12288
    v_exp_f32 v136, v128
    v_cvt_pk_bf16_f32 v155, v142, v143
    v_exp_f32 v137, v129
    v_exp_f32 v138, v130
    v_cvt_pk_bf16_f32 v156, v136, v137
    v_exp_f32 v139, v131
    v_mfma_f32_32x32x16_bf16 v[40:55], v[188:191], v[148:151], v[40:55]
    s_add_u32 s10, s9, 16384
    s_movk_i32 s45, 16384
    s_movk_i32 s46, 20480
    v_exp_f32 v140, v132
    v_cvt_pk_bf16_f32 v157, v138, v139
    v_exp_f32 v141, v133
    v_exp_f32 v142, v134
    v_cvt_pk_bf16_f32 v158, v140, v141
    v_exp_f32 v143, v135
    v_mfma_f32_32x32x16_bf16 v[120:135], v[176:179], v[32:35], 0
    s_and_b32 s10, s10, 0x3c000
    s_movk_i32 s47, 24576
    s_lshr_b32 s96, s28, 1
    v_cvt_pk_bf16_f32 v159, v142, v143
    v_exp_f32 v136, v104
    v_exp_f32 v137, v105
    v_exp_f32 v138, v106
    v_cvt_pk_bf16_f32 v144, v136, v137
    v_exp_f32 v139, v107
    v_mfma_f32_32x32x16_bf16 v[120:135], v[180:183], v[36:39], v[120:135]
    buffer_load_dwordx4 v[176:179], v241, s[4:7], s10 offen offset:0 sc1
    s_lshl_b32 s96, s96, 8
    s_and_b32 s97, s28, 1
    v_exp_f32 v140, v108
    v_cvt_pk_bf16_f32 v145, v138, v139
    v_exp_f32 v141, v109
    v_exp_f32 v142, v110
    v_cvt_pk_bf16_f32 v146, v140, v141
    v_exp_f32 v143, v111
    v_mfma_f32_32x32x16_bf16 v[56:71], v[184:187], v[152:155], v[56:71]
    s_lshl_b32 s97, s97, 6
    s_add_u32 s96, s96, s97
    v_exp_f32 v136, v112
    v_cvt_pk_bf16_f32 v147, v142, v143
    v_exp_f32 v137, v113
    v_exp_f32 v138, v114
    v_cvt_pk_bf16_f32 v148, v136, v137
    v_exp_f32 v139, v115
    v_mfma_f32_32x32x16_bf16 v[56:71], v[188:191], v[156:159], v[56:71]
    buffer_load_dwordx4 v[180:183], v241, s[4:7], s10 offen offset:1024 sc1
    s_waitcnt vmcnt(12)
    s_lshl_b32 s97, s26, 2
    s_add_u32 s96, s96, s97
    v_exp_f32 v140, v116
    v_cvt_pk_bf16_f32 v149, v138, v139
    v_exp_f32 v141, v117
    v_exp_f32 v142, v118
    v_cvt_pk_bf16_f32 v150, v140, v141
    v_exp_f32 v143, v119
    v_mfma_f32_32x32x16_bf16 v[104:119], v[192:195], v[8:11], 0
    s_add_u32 s51, s96, 13553664
    s_lshr_b32 s96, s30, 1
    v_cvt_pk_bf16_f32 v151, v142, v143
    v_exp_f32 v136, v120
    v_exp_f32 v137, v121
    v_exp_f32 v138, v122
    v_cvt_pk_bf16_f32 v152, v136, v137
    v_exp_f32 v139, v123
    v_mfma_f32_32x32x16_bf16 v[104:119], v[196:199], v[12:15], v[104:119]
    s_lshl_b32 s96, s96, 8
    s_and_b32 s97, s30, 1
    v_exp_f32 v140, v124
    v_cvt_pk_bf16_f32 v153, v138, v139
    v_exp_f32 v141, v125
    v_exp_f32 v142, v126
    v_cvt_pk_bf16_f32 v154, v140, v141
    v_exp_f32 v143, v127
    v_mfma_f32_32x32x16_bf16 v[72:87], v[184:187], v[144:147], v[72:87]
    s_lshl_b32 s97, s97, 6
    s_add_u32 s96, s96, s97
    v_exp_f32 v136, v128
    v_cvt_pk_bf16_f32 v155, v142, v143
    v_exp_f32 v137, v129
    v_exp_f32 v138, v130
    v_cvt_pk_bf16_f32 v156, v136, v137
    v_exp_f32 v139, v131
    v_mfma_f32_32x32x16_bf16 v[72:87], v[188:191], v[148:151], v[72:87]
    s_lshl_b32 s97, s31, 2
    s_add_u32 s96, s96, s97
    v_exp_f32 v140, v132
    v_cvt_pk_bf16_f32 v157, v138, v139
    v_exp_f32 v141, v133
    v_exp_f32 v142, v134
    v_cvt_pk_bf16_f32 v158, v140, v141
    v_exp_f32 v143, v135
    v_mfma_f32_32x32x16_bf16 v[120:135], v[192:195], v[16:19], 0
    s_add_u32 s55, s96, 0
    s_lshr_b32 s96, s32, 1
    v_cvt_pk_bf16_f32 v159, v142, v143
    v_exp_f32 v136, v104
    v_exp_f32 v137, v105
    v_exp_f32 v138, v106
    v_cvt_pk_bf16_f32 v144, v136, v137
    v_exp_f32 v139, v107
    v_mfma_f32_32x32x16_bf16 v[120:135], v[196:199], v[20:23], v[120:135]
    s_lshl_b32 s96, s96, 8
    s_and_b32 s97, s32, 1
    v_exp_f32 v140, v108
    v_cvt_pk_bf16_f32 v145, v138, v139
    v_exp_f32 v141, v109
    v_exp_f32 v142, v110
    v_cvt_pk_bf16_f32 v146, v140, v141
    v_exp_f32 v143, v111
    v_mfma_f32_32x32x16_bf16 v[88:103], v[184:187], v[152:155], v[88:103]
    s_lshl_b32 s97, s97, 6
    s_add_u32 s96, s96, s97
    v_exp_f32 v136, v112
    v_cvt_pk_bf16_f32 v147, v142, v143
    v_exp_f32 v137, v113
    v_exp_f32 v138, v114
    v_cvt_pk_bf16_f32 v148, v136, v137
    v_exp_f32 v139, v115
    v_mfma_f32_32x32x16_bf16 v[88:103], v[188:191], v[156:159], v[88:103]
    buffer_load_dwordx4 v[184:187], v241, s[4:7], s10 offen offset:2048 sc1
    s_add_u32 s56, s96, 13561856
    s_lshr_b32 s96, s32, 1
    v_exp_f32 v140, v116
    v_cvt_pk_bf16_f32 v149, v138, v139
    v_exp_f32 v141, v117
    v_exp_f32 v142, v118
    v_cvt_pk_bf16_f32 v150, v140, v141
    v_exp_f32 v143, v119
    v_mfma_f32_32x32x16_bf16 v[104:119], v[192:195], v[24:27], 0
    s_lshl_b32 s96, s96, 8
    s_and_b32 s97, s32, 1
    v_cvt_pk_bf16_f32 v151, v142, v143
    v_exp_f32 v136, v120
    v_exp_f32 v137, v121
    v_exp_f32 v138, v122
    v_cvt_pk_bf16_f32 v152, v136, v137
    v_exp_f32 v139, v123
    v_mfma_f32_32x32x16_bf16 v[104:119], v[196:199], v[28:31], v[104:119]
    buffer_load_dwordx4 v[188:191], v241, s[4:7], s10 offen offset:3072 sc1
    s_waitcnt vmcnt(12)
    s_lshl_b32 s97, s97, 6
    s_add_u32 s96, s96, s97
    v_exp_f32 v140, v124
    v_cvt_pk_bf16_f32 v153, v138, v139
    v_exp_f32 v141, v125
    v_exp_f32 v142, v126
    v_cvt_pk_bf16_f32 v154, v140, v141
    v_exp_f32 v143, v127
    v_mfma_f32_32x32x16_bf16 v[40:55], v[200:203], v[144:147], v[40:55]
    s_lshl_b32 s97, s33, 2
    s_add_u32 s96, s96, s97
    v_exp_f32 v136, v128
    v_cvt_pk_bf16_f32 v155, v142, v143
    v_exp_f32 v137, v129
    v_exp_f32 v138, v130
    v_cvt_pk_bf16_f32 v156, v136, v137
    v_exp_f32 v139, v131
    v_mfma_f32_32x32x16_bf16 v[40:55], v[204:207], v[148:151], v[40:55]
    s_add_u32 s9, s10, 16384
    s_add_u32 s58, s96, 13570048
    s_lshr_b32 s96, s28, 1
    v_exp_f32 v140, v132
    v_cvt_pk_bf16_f32 v157, v138, v139
    v_exp_f32 v141, v133
    v_exp_f32 v142, v134
    v_cvt_pk_bf16_f32 v158, v140, v141
    v_exp_f32 v143, v135
    v_mfma_f32_32x32x16_bf16 v[120:135], v[192:195], v[32:35], 0
    s_and_b32 s9, s9, 0x3c000
    s_lshl_b32 s96, s96, 8
    s_and_b32 s97, s28, 1
    v_cvt_pk_bf16_f32 v159, v142, v143
    v_exp_f32 v136, v104
    v_exp_f32 v137, v105
    v_exp_f32 v138, v106
    v_cvt_pk_bf16_f32 v144, v136, v137
    v_exp_f32 v139, v107
    v_mfma_f32_32x32x16_bf16 v[120:135], v[196:199], v[36:39], v[120:135]
    buffer_load_dwordx4 v[192:195], v241, s[4:7], s9 offen offset:0 sc1
    s_lshl_b32 s97, s97, 6
    s_add_u32 s96, s96, s97
    v_exp_f32 v140, v108
    v_cvt_pk_bf16_f32 v145, v138, v139
    v_exp_f32 v141, v109
    v_exp_f32 v142, v110
    v_cvt_pk_bf16_f32 v146, v140, v141
    v_exp_f32 v143, v111
    v_mfma_f32_32x32x16_bf16 v[56:71], v[200:203], v[152:155], v[56:71]
    s_waitcnt vmcnt(9)
    s_add_u32 s60, s96, 13545472
    s_waitcnt lgkmcnt(0)
    v_exp_f32 v136, v112
    v_cvt_pk_bf16_f32 v147, v142, v143
    v_exp_f32 v137, v113
    v_exp_f32 v138, v114
    v_cvt_pk_bf16_f32 v148, v136, v137
    v_exp_f32 v139, v115
    v_mfma_f32_32x32x16_bf16 v[56:71], v[204:207], v[156:159], v[56:71]
    buffer_load_dwordx4 v[196:199], v241, s[4:7], s9 offen offset:1024 sc1
    v_exp_f32 v140, v116
    v_cvt_pk_bf16_f32 v149, v138, v139
    v_exp_f32 v141, v117
    v_exp_f32 v142, v118
    v_cvt_pk_bf16_f32 v150, v140, v141
    v_exp_f32 v143, v119
    v_mfma_f32_32x32x16_bf16 v[104:119], v[208:211], v[8:11], 0
    buffer_load_dword v240, v244, s[4:7], 0 offen sc1
    v_cvt_pk_bf16_f32 v151, v142, v143
    v_exp_f32 v136, v120
    v_exp_f32 v137, v121
    v_exp_f32 v138, v122
    v_cvt_pk_bf16_f32 v152, v136, v137
    v_exp_f32 v139, v123
    v_mfma_f32_32x32x16_bf16 v[104:119], v[212:215], v[12:15], v[104:119]
    buffer_store_dwordx4 v[8:11], v1, s[4:7], s50 offen offset:0 sc1
    v_exp_f32 v140, v124
    v_cvt_pk_bf16_f32 v153, v138, v139
    v_exp_f32 v141, v125
    v_exp_f32 v142, v126
    v_cvt_pk_bf16_f32 v154, v140, v141
    v_exp_f32 v143, v127
    v_mfma_f32_32x32x16_bf16 v[72:87], v[200:203], v[144:147], v[72:87]
    v_exp_f32 v136, v128
    v_cvt_pk_bf16_f32 v155, v142, v143
    v_exp_f32 v137, v129
    v_exp_f32 v138, v130
    v_cvt_pk_bf16_f32 v156, v136, v137
    v_exp_f32 v139, v131
    v_mfma_f32_32x32x16_bf16 v[72:87], v[204:207], v[148:151], v[72:87]
    v_exp_f32 v140, v132
    v_cvt_pk_bf16_f32 v157, v138, v139
    v_exp_f32 v141, v133
    v_exp_f32 v142, v134
    v_cvt_pk_bf16_f32 v158, v140, v141
    v_exp_f32 v143, v135
    v_mfma_f32_32x32x16_bf16 v[120:135], v[208:211], v[16:19], 0
    v_cvt_pk_bf16_f32 v159, v142, v143
    v_exp_f32 v136, v104
    v_exp_f32 v137, v105
    v_exp_f32 v138, v106
    v_cvt_pk_bf16_f32 v144, v136, v137
    v_exp_f32 v139, v107
    v_mfma_f32_32x32x16_bf16 v[120:135], v[212:215], v[20:23], v[120:135]
    buffer_store_dwordx4 v[8:11], v1, s[4:7], s50 offen offset:1024 sc1
    v_exp_f32 v140, v108
    v_cvt_pk_bf16_f32 v145, v138, v139
    v_exp_f32 v141, v109
    v_exp_f32 v142, v110
    v_cvt_pk_bf16_f32 v146, v140, v141
    v_exp_f32 v143, v111
    v_mfma_f32_32x32x16_bf16 v[88:103], v[200:203], v[152:155], v[88:103]
    v_exp_f32 v136, v112
    v_cvt_pk_bf16_f32 v147, v142, v143
    v_exp_f32 v137, v113
    v_exp_f32 v138, v114
    v_cvt_pk_bf16_f32 v148, v136, v137
    v_exp_f32 v139, v115
    v_mfma_f32_32x32x16_bf16 v[88:103], v[204:207], v[156:159], v[88:103]
    buffer_load_dwordx4 v[200:203], v241, s[4:7], s9 offen offset:2048 sc1
    v_exp_f32 v140, v116
    v_cvt_pk_bf16_f32 v149, v138, v139
    v_exp_f32 v141, v117
    v_exp_f32 v142, v118
    v_cvt_pk_bf16_f32 v150, v140, v141
    v_exp_f32 v143, v119
    v_mfma_f32_32x32x16_bf16 v[104:119], v[208:211], v[24:27], 0
    v_cvt_pk_bf16_f32 v151, v142, v143
    v_exp_f32 v136, v120
    v_exp_f32 v137, v121
    v_exp_f32 v138, v122
    v_cvt_pk_bf16_f32 v152, v136, v137
    v_exp_f32 v139, v123
    v_mfma_f32_32x32x16_bf16 v[104:119], v[212:215], v[28:31], v[104:119]
    buffer_load_dwordx4 v[204:207], v241, s[4:7], s9 offen offset:3072 sc1
    v_exp_f32 v140, v124
    v_cvt_pk_bf16_f32 v153, v138, v139
    v_exp_f32 v141, v125
    v_exp_f32 v142, v126
    v_cvt_pk_bf16_f32 v154, v140, v141
    v_exp_f32 v143, v127
    v_mfma_f32_32x32x16_bf16 v[40:55], v[216:219], v[144:147], v[40:55]
    v_exp_f32 v136, v128
    v_cvt_pk_bf16_f32 v155, v142, v143
    v_exp_f32 v137, v129
    v_exp_f32 v138, v130
    v_cvt_pk_bf16_f32 v156, v136, v137
    v_exp_f32 v139, v131
    v_mfma_f32_32x32x16_bf16 v[40:55], v[220:223], v[148:151], v[40:55]
    s_add_u32 s10, s9, 16384
    v_exp_f32 v140, v132
    v_cvt_pk_bf16_f32 v157, v138, v139
    v_exp_f32 v141, v133
    v_exp_f32 v142, v134
    v_cvt_pk_bf16_f32 v158, v140, v141
    v_exp_f32 v143, v135
    v_mfma_f32_32x32x16_bf16 v[120:135], v[208:211], v[32:35], 0
    s_and_b32 s10, s10, 0x3c000
    v_cvt_pk_bf16_f32 v159, v142, v143
    v_exp_f32 v136, v104
    v_exp_f32 v137, v105
    v_exp_f32 v138, v106
    v_cvt_pk_bf16_f32 v144, v136, v137
    v_exp_f32 v139, v107
    v_mfma_f32_32x32x16_bf16 v[120:135], v[212:215], v[36:39], v[120:135]
    buffer_load_dwordx4 v[208:211], v241, s[4:7], s10 offen offset:0 sc1
    v_exp_f32 v140, v108
    v_cvt_pk_bf16_f32 v145, v138, v139
    v_exp_f32 v141, v109
    v_exp_f32 v142, v110
    v_cvt_pk_bf16_f32 v146, v140, v141
    v_exp_f32 v143, v111
    v_mfma_f32_32x32x16_bf16 v[56:71], v[216:219], v[152:155], v[56:71]
    s_waitcnt vmcnt(12)
    v_exp_f32 v136, v112
    v_cvt_pk_bf16_f32 v147, v142, v143
    v_exp_f32 v137, v113
    v_exp_f32 v138, v114
    v_cvt_pk_bf16_f32 v148, v136, v137
    v_exp_f32 v139, v115
    v_mfma_f32_32x32x16_bf16 v[56:71], v[220:223], v[156:159], v[56:71]
    buffer_load_dwordx4 v[212:215], v241, s[4:7], s10 offen offset:1024 sc1
    v_exp_f32 v140, v116
    v_cvt_pk_bf16_f32 v149, v138, v139
    v_exp_f32 v141, v117
    v_exp_f32 v142, v118
    v_cvt_pk_bf16_f32 v150, v140, v141
    v_exp_f32 v143, v119
    v_mfma_f32_32x32x16_bf16 v[104:119], v[160:163], v[8:11], 0
    v_cvt_pk_bf16_f32 v151, v142, v143
    v_exp_f32 v136, v120
    v_exp_f32 v137, v121
    v_exp_f32 v138, v122
    v_cvt_pk_bf16_f32 v152, v136, v137
    v_exp_f32 v139, v123
    v_mfma_f32_32x32x16_bf16 v[104:119], v[164:167], v[12:15], v[104:119]
    s_add_u32 s11, s53, 15683584
    v_exp_f32 v140, v124
    v_cvt_pk_bf16_f32 v153, v138, v139
    v_exp_f32 v141, v125
    v_exp_f32 v142, v126
    v_cvt_pk_bf16_f32 v154, v140, v141
    v_exp_f32 v143, v127
    v_mfma_f32_32x32x16_bf16 v[72:87], v[216:219], v[144:147], v[72:87]
    v_exp_f32 v136, v128
    v_cvt_pk_bf16_f32 v155, v142, v143
    v_exp_f32 v137, v129
    v_exp_f32 v138, v130
    v_cvt_pk_bf16_f32 v156, v136, v137
    v_exp_f32 v139, v131
    v_mfma_f32_32x32x16_bf16 v[72:87], v[220:223], v[148:151], v[72:87]
    v_exp_f32 v140, v132
    v_cvt_pk_bf16_f32 v157, v138, v139
    v_exp_f32 v141, v133
    v_exp_f32 v142, v134
    v_cvt_pk_bf16_f32 v158, v140, v141
    v_exp_f32 v143, v135
    v_mfma_f32_32x32x16_bf16 v[120:135], v[160:163], v[16:19], 0
    v_cvt_pk_bf16_f32 v159, v142, v143
    v_exp_f32 v136, v104
    v_exp_f32 v137, v105
    v_exp_f32 v138, v106
    v_cvt_pk_bf16_f32 v144, v136, v137
    v_exp_f32 v139, v107
    v_mfma_f32_32x32x16_bf16 v[120:135], v[164:167], v[20:23], v[120:135]
    buffer_store_dwordx4 v[8:11], v1, s[12:15], s11 offen offset:0 sc1
    v_exp_f32 v140, v108
    v_cvt_pk_bf16_f32 v145, v138, v139
    v_exp_f32 v141, v109
    v_exp_f32 v142, v110
    v_cvt_pk_bf16_f32 v146, v140, v141
    v_exp_f32 v143, v111
    v_mfma_f32_32x32x16_bf16 v[88:103], v[216:219], v[152:155], v[88:103]
    v_exp_f32 v136, v112
    v_cvt_pk_bf16_f32 v147, v142, v143
    v_exp_f32 v137, v113
    v_exp_f32 v138, v114
    v_cvt_pk_bf16_f32 v148, v136, v137
    v_exp_f32 v139, v115
    v_mfma_f32_32x32x16_bf16 v[88:103], v[220:223], v[156:159], v[88:103]
    buffer_load_dwordx4 v[216:219], v241, s[4:7], s10 offen offset:2048 sc1
    v_exp_f32 v140, v116
    v_cvt_pk_bf16_f32 v149, v138, v139
    v_exp_f32 v141, v117
    v_exp_f32 v142, v118
    v_cvt_pk_bf16_f32 v150, v140, v141
    v_exp_f32 v143, v119
    v_mfma_f32_32x32x16_bf16 v[104:119], v[160:163], v[24:27], 0
    s_waitcnt vmcnt(8)
    v_cmp_eq_u32 vcc, 0, v240
    s_cbranch_vccnz L_pk_spin_14
L_pk_ok_15:
    v_cvt_pk_bf16_f32 v151, v142, v143
    v_exp_f32 v136, v120
    v_exp_f32 v137, v121
    v_exp_f32 v138, v122
    v_cvt_pk_bf16_f32 v152, v136, v137
    v_exp_f32 v139, v123
    v_mfma_f32_32x32x16_bf16 v[104:119], v[164:167], v[28:31], v[104:119]
    buffer_load_dwordx4 v[220:223], v241, s[4:7], s10 offen offset:3072 sc1
    v_exp_f32 v140, v124
    v_cvt_pk_bf16_f32 v153, v138, v139
    v_exp_f32 v141, v125
    v_exp_f32 v142, v126
    v_cvt_pk_bf16_f32 v154, v140, v141
    v_exp_f32 v143, v127
    v_mfma_f32_32x32x16_bf16 v[40:55], v[168:171], v[144:147], v[40:55]
    buffer_load_dwordx4 v242, s[12:15], 0 offen offset:0 sc1 lds
    v_exp_f32 v136, v128
    v_cvt_pk_bf16_f32 v155, v142, v143
    v_exp_f32 v137, v129
    v_exp_f32 v138, v130
    v_cvt_pk_bf16_f32 v156, v136, v137
    v_exp_f32 v139, v131
    v_mfma_f32_32x32x16_bf16 v[40:55], v[172:175], v[148:151], v[40:55]
    s_add_u32 s9, s10, 16384
    v_exp_f32 v140, v132
    v_cvt_pk_bf16_f32 v157, v138, v139
    v_exp_f32 v141, v133
    v_exp_f32 v142, v134
    v_cvt_pk_bf16_f32 v158, v140, v141
    v_exp_f32 v143, v135
    v_mfma_f32_32x32x16_bf16 v[120:135], v[160:163], v[32:35], 0
    s_and_b32 s9, s9, 0x3c000
    v_cvt_pk_bf16_f32 v159, v142, v143
    v_exp_f32 v136, v104
    v_exp_f32 v137, v105
    v_exp_f32 v138, v106
    v_cvt_pk_bf16_f32 v144, v136, v137
    v_exp_f32 v139, v107
    v_mfma_f32_32x32x16_bf16 v[120:135], v[164:167], v[36:39], v[120:135]
    buffer_load_dwordx4 v[160:163], v241, s[4:7], s9 offen offset:0 sc1
    v_exp_f32 v140, v108
    v_cvt_pk_bf16_f32 v145, v138, v139
    v_exp_f32 v141, v109
    v_exp_f32 v142, v110
    v_cvt_pk_bf16_f32 v146, v140, v141
    v_exp_f32 v143, v111
    v_mfma_f32_32x32x16_bf16 v[56:71], v[168:171], v[152:155], v[56:71]
    v_exp_f32 v136, v112
    v_cvt_pk_bf16_f32 v147, v142, v143
    v_exp_f32 v137, v113
    v_exp_f32 v138, v114
    v_cvt_pk_bf16_f32 v148, v136, v137
    v_exp_f32 v139, v115
    v_mfma_f32_32x32x16_bf16 v[56:71], v[172:175], v[156:159], v[56:71]
    buffer_load_dwordx4 v[164:167], v241, s[4:7], s9 offen offset:1024 sc1
    v_exp_f32 v140, v116
    v_cvt_pk_bf16_f32 v149, v138, v139
    v_exp_f32 v141, v117
    v_exp_f32 v142, v118
    v_cvt_pk_bf16_f32 v150, v140, v141
    v_exp_f32 v143, v119
    v_mfma_f32_32x32x16_bf16 v[104:119], v[176:179], v[8:11], 0
    buffer_load_dwordx4 v242, s[12:15], 0 offen offset:1024 sc1 lds
    v_cvt_pk_bf16_f32 v151, v142, v143
    v_exp_f32 v136, v120
    v_exp_f32 v137, v121
    v_exp_f32 v138, v122
    v_cvt_pk_bf16_f32 v152, v136, v137
    v_exp_f32 v139, v123
    v_mfma_f32_32x32x16_bf16 v[104:119], v[180:183], v[12:15], v[104:119]
    buffer_load_dwordx4 v242, s[12:15], 0 offen offset:2048 sc1 lds
    v_exp_f32 v140, v124
    v_cvt_pk_bf16_f32 v153, v138, v139
    v_exp_f32 v141, v125
    v_exp_f32 v142, v126
    v_cvt_pk_bf16_f32 v154, v140, v141
    v_exp_f32 v143, v127
    v_mfma_f32_32x32x16_bf16 v[72:87], v[168:171], v[144:147], v[72:87]
    buffer_store_dwordx4 v[8:11], v1, s[12:15], s11 offen offset:1024 sc1
    v_exp_f32 v136, v128
    v_cvt_pk_bf16_f32 v155, v142, v143
    v_exp_f32 v137, v129
    v_exp_f32 v138, v130
    v_cvt_pk_bf16_f32 v156, v136, v137
    v_exp_f32 v139, v131
    v_mfma_f32_32x32x16_bf16 v[72:87], v[172:175], v[148:151], v[72:87]
    buffer_load_dwordx4 v242, s[12:15], 0 offen offset:3072 sc1 lds
    v_exp_f32 v140, v132
    v_cvt_pk_bf16_f32 v157, v138, v139
    v_exp_f32 v141, v133
    v_exp_f32 v142, v134
    v_cvt_pk_bf16_f32 v158, v140, v141
    v_exp_f32 v143, v135
    v_mfma_f32_32x32x16_bf16 v[120:135], v[176:179], v[16:19], 0
    v_cvt_pk_bf16_f32 v159, v142, v143
    v_exp_f32 v136, v104
    v_exp_f32 v137, v105
    v_exp_f32 v138, v106
    v_cvt_pk_bf16_f32 v144, v136, v137
    v_exp_f32 v139, v107
    v_mfma_f32_32x32x16_bf16 v[120:135], v[180:183], v[20:23], v[120:135]
    s_add_u32 m0, m0, 4096
    v_exp_f32 v140, v108
    v_cvt_pk_bf16_f32 v145, v138, v139
    v_exp_f32 v141, v109
    v_exp_f32 v142, v110
    v_cvt_pk_bf16_f32 v146, v140, v141
    v_exp_f32 v143, v111
    v_mfma_f32_32x32x16_bf16 v[88:103], v[168:171], v[152:155], v[88:103]
    buffer_load_dwordx4 v242, s[12:15], s42 offen offset:0 sc1 lds
    v_exp_f32 v136, v112
    v_cvt_pk_bf16_f32 v147, v142, v143
    v_exp_f32 v137, v113
    v_exp_f32 v138, v114
    v_cvt_pk_bf16_f32 v148, v136, v137
    v_exp_f32 v139, v115
    v_mfma_f32_32x32x16_bf16 v[88:103], v[172:175], v[156:159], v[88:103]
    buffer_load_dwordx4 v[168:171], v241, s[4:7], s9 offen offset:2048 sc1
    v_exp_f32 v140, v116
    v_cvt_pk_bf16_f32 v149, v138, v139
    v_exp_f32 v141, v117
    v_exp_f32 v142, v118
    v_cvt_pk_bf16_f32 v150, v140, v141
    v_exp_f32 v143, v119
    v_mfma_f32_32x32x16_bf16 v[104:119], v[176:179], v[24:27], 0
    s_and_b32 s3, s54, -8
    v_lshlrev_b32 v247, 3, v0
    v_cvt_pk_bf16_f32 v151, v142, v143
    v_exp_f32 v136, v120
    v_exp_f32 v137, v121
    v_exp_f32 v138, v122
    v_cvt_pk_bf16_f32 v152, v136, v137
    v_exp_f32 v139, v123
    v_mfma_f32_32x32x16_bf16 v[104:119], v[180:183], v[28:31], v[104:119]
    buffer_load_dwordx4 v[172:175], v241, s[4:7], s9 offen offset:3072 sc1
    v_exp_f32 v140, v124
    v_cvt_pk_bf16_f32 v153, v138, v139
    v_exp_f32 v141, v125
    v_exp_f32 v142, v126
    v_cvt_pk_bf16_f32 v154, v140, v141
    v_exp_f32 v143, v127
    v_mfma_f32_32x32x16_bf16 v[40:55], v[184:187], v[144:147], v[40:55]
    buffer_load_dwordx4 v242, s[12:15], s42 offen offset:1024 sc1 lds
    v_exp_f32 v136, v128
    v_cvt_pk_bf16_f32 v155, v142, v143
    v_exp_f32 v137, v129
    v_exp_f32 v138, v130
    v_cvt_pk_bf16_f32 v156, v136, v137
    v_exp_f32 v139, v131
    v_mfma_f32_32x32x16_bf16 v[40:55], v[188:191], v[148:151], v[40:55]
    s_add_u32 s10, s9, 16384
    v_exp_f32 v140, v132
    v_cvt_pk_bf16_f32 v157, v138, v139
    v_exp_f32 v141, v133
    v_exp_f32 v142, v134
    v_cvt_pk_bf16_f32 v158, v140, v141
    v_exp_f32 v143, v135
    v_mfma_f32_32x32x16_bf16 v[120:135], v[176:179], v[32:35], 0
    s_and_b32 s10, s10, 0x3c000
    v_cvt_pk_bf16_f32 v159, v142, v143
    v_exp_f32 v136, v104
    v_exp_f32 v137, v105
    v_exp_f32 v138, v106
    v_cvt_pk_bf16_f32 v144, v136, v137
    v_exp_f32 v139, v107
    v_mfma_f32_32x32x16_bf16 v[120:135], v[180:183], v[36:39], v[120:135]
    buffer_load_dwordx4 v[176:179], v241, s[4:7], s10 offen offset:0 sc1
    v_exp_f32 v140, v108
    v_cvt_pk_bf16_f32 v145, v138, v139
    v_exp_f32 v141, v109
    v_exp_f32 v142, v110
    v_cvt_pk_bf16_f32 v146, v140, v141
    v_exp_f32 v143, v111
    v_mfma_f32_32x32x16_bf16 v[56:71], v[184:187], v[152:155], v[56:71]
    s_waitcnt vmcnt(17)
    v_exp_f32 v136, v112
    v_cvt_pk_bf16_f32 v147, v142, v143
    v_exp_f32 v137, v113
    v_exp_f32 v138, v114
    v_cvt_pk_bf16_f32 v148, v136, v137
    v_exp_f32 v139, v115
    v_mfma_f32_32x32x16_bf16 v[56:71], v[188:191], v[156:159], v[56:71]
    buffer_load_dwordx4 v[180:183], v241, s[4:7], s10 offen offset:1024 sc1
    v_exp_f32 v140, v116
    v_cvt_pk_bf16_f32 v149, v138, v139
    v_exp_f32 v141, v117
    v_exp_f32 v142, v118
    v_cvt_pk_bf16_f32 v150, v140, v141
    v_exp_f32 v143, v119
    v_mfma_f32_32x32x16_bf16 v[104:119], v[192:195], v[8:11], 0
    v_cvt_pk_bf16_f32 v151, v142, v143
    v_exp_f32 v136, v120
    v_exp_f32 v137, v121
    v_exp_f32 v138, v122
    v_cvt_pk_bf16_f32 v152, v136, v137
    v_exp_f32 v139, v123
    v_mfma_f32_32x32x16_bf16 v[104:119], v[196:199], v[12:15], v[104:119]
    buffer_load_dwordx4 v242, s[12:15], s42 offen offset:2048 sc1 lds
    v_exp_f32 v140, v124
    v_cvt_pk_bf16_f32 v153, v138, v139
    v_exp_f32 v141, v125
    v_exp_f32 v142, v126
    v_cvt_pk_bf16_f32 v154, v140, v141
    v_exp_f32 v143, v127
    v_mfma_f32_32x32x16_bf16 v[72:87], v[184:187], v[144:147], v[72:87]
    s_add_u32 s11, s3, 17518592
    v_exp_f32 v136, v128
    v_cvt_pk_bf16_f32 v155, v142, v143
    v_exp_f32 v137, v129
    v_exp_f32 v138, v130
    v_cvt_pk_bf16_f32 v156, v136, v137
    v_exp_f32 v139, v131
    v_mfma_f32_32x32x16_bf16 v[72:87], v[188:191], v[148:151], v[72:87]
    buffer_load_dwordx4 v242, s[12:15], s42 offen offset:3072 sc1 lds
    v_exp_f32 v140, v132
    v_cvt_pk_bf16_f32 v157, v138, v139
    v_exp_f32 v141, v133
    v_exp_f32 v142, v134
    v_cvt_pk_bf16_f32 v158, v140, v141
    v_exp_f32 v143, v135
    v_mfma_f32_32x32x16_bf16 v[120:135], v[192:195], v[16:19], 0
    s_add_u32 m0, m0, 4096
    v_cvt_pk_bf16_f32 v159, v142, v143
    v_exp_f32 v136, v104
    v_exp_f32 v137, v105
    v_exp_f32 v138, v106
    v_cvt_pk_bf16_f32 v144, v136, v137
    v_exp_f32 v139, v107
    v_mfma_f32_32x32x16_bf16 v[120:135], v[196:199], v[20:23], v[120:135]
    v_exp_f32 v140, v108
    v_cvt_pk_bf16_f32 v145, v138, v139
    v_exp_f32 v141, v109
    v_exp_f32 v142, v110
    v_cvt_pk_bf16_f32 v146, v140, v141
    v_exp_f32 v143, v111
    v_mfma_f32_32x32x16_bf16 v[88:103], v[184:187], v[152:155], v[88:103]
    buffer_load_dwordx4 v242, s[12:15], s43 offen offset:0 sc1 lds
    v_exp_f32 v136, v112
    v_cvt_pk_bf16_f32 v147, v142, v143
    v_exp_f32 v137, v113
    v_exp_f32 v138, v114
    v_cvt_pk_bf16_f32 v148, v136, v137
    v_exp_f32 v139, v115
    v_mfma_f32_32x32x16_bf16 v[88:103], v[188:191], v[156:159], v[88:103]
    buffer_load_dwordx4 v[184:187], v241, s[4:7], s10 offen offset:2048 sc1
    v_exp_f32 v140, v116
    v_cvt_pk_bf16_f32 v149, v138, v139
    v_exp_f32 v141, v117
    v_exp_f32 v142, v118
    v_cvt_pk_bf16_f32 v150, v140, v141
    v_exp_f32 v143, v119
    v_mfma_f32_32x32x16_bf16 v[104:119], v[192:195], v[24:27], 0
    buffer_store_dwordx2 v[8:9], v247, s[12:15], s11 offen sc1
    v_cvt_pk_bf16_f32 v151, v142, v143
    v_exp_f32 v136, v120
    v_exp_f32 v137, v121
    v_exp_f32 v138, v122
    v_cvt_pk_bf16_f32 v152, v136, v137
    v_exp_f32 v139, v123
    v_mfma_f32_32x32x16_bf16 v[104:119], v[196:199], v[28:31], v[104:119]
    buffer_load_dwordx4 v[188:191], v241, s[4:7], s10 offen offset:3072 sc1
    v_exp_f32 v140, v124
    v_cvt_pk_bf16_f32 v153, v138, v139
    v_exp_f32 v141, v125
    v_exp_f32 v142, v126
    v_cvt_pk_bf16_f32 v154, v140, v141
    v_exp_f32 v143, v127
    v_mfma_f32_32x32x16_bf16 v[40:55], v[200:203], v[144:147], v[40:55]
    buffer_load_dwordx4 v242, s[12:15], s43 offen offset:1024 sc1 lds
    v_exp_f32 v136, v128
    v_cvt_pk_bf16_f32 v155, v142, v143
    v_exp_f32 v137, v129
    v_exp_f32 v138, v130
    v_cvt_pk_bf16_f32 v156, v136, v137
    v_exp_f32 v139, v131
    v_mfma_f32_32x32x16_bf16 v[40:55], v[204:207], v[148:151], v[40:55]
    s_add_u32 s9, s10, 16384
    v_exp_f32 v140, v132
    v_cvt_pk_bf16_f32 v157, v138, v139
    v_exp_f32 v141, v133
    v_exp_f32 v142, v134
    v_cvt_pk_bf16_f32 v158, v140, v141
    v_exp_f32 v143, v135
    v_mfma_f32_32x32x16_bf16 v[120:135], v[192:195], v[32:35], 0
    s_and_b32 s9, s9, 0x3c000
    v_cvt_pk_bf16_f32 v159, v142, v143
    v_exp_f32 v136, v104
    v_exp_f32 v137, v105
    v_exp_f32 v138, v106
    v_cvt_pk_bf16_f32 v144, v136, v137
    v_exp_f32 v139, v107
    v_mfma_f32_32x32x16_bf16 v[120:135], v[196:199], v[36:39], v[120:135]
    buffer_load_dwordx4 v[192:195], v241, s[4:7], s9 offen offset:0 sc1
    v_exp_f32 v140, v108
    v_cvt_pk_bf16_f32 v145, v138, v139
    v_exp_f32 v141, v109
    v_exp_f32 v142, v110
    v_cvt_pk_bf16_f32 v146, v140, v141
    v_exp_f32 v143, v111
    v_mfma_f32_32x32x16_bf16 v[56:71], v[200:203], v[152:155], v[56:71]
    s_waitcnt vmcnt(21)
    v_exp_f32 v136, v112
    v_cvt_pk_bf16_f32 v147, v142, v143
    v_exp_f32 v137, v113
    v_exp_f32 v138, v114
    v_cvt_pk_bf16_f32 v148, v136, v137
    v_exp_f32 v139, v115
    v_mfma_f32_32x32x16_bf16 v[56:71], v[204:207], v[156:159], v[56:71]
    buffer_load_dwordx4 v[196:199], v241, s[4:7], s9 offen offset:1024 sc1
    v_exp_f32 v140, v116
    v_cvt_pk_bf16_f32 v149, v138, v139
    v_exp_f32 v141, v117
    v_exp_f32 v142, v118
    v_cvt_pk_bf16_f32 v150, v140, v141
    v_exp_f32 v143, v119
    v_mfma_f32_32x32x16_bf16 v[104:119], v[208:211], v[8:11], 0
    buffer_load_dwordx4 v242, s[12:15], s43 offen offset:2048 sc1 lds
    v_cvt_pk_bf16_f32 v151, v142, v143
    v_exp_f32 v136, v120
    v_exp_f32 v137, v121
    v_exp_f32 v138, v122
    v_cvt_pk_bf16_f32 v152, v136, v137
    v_exp_f32 v139, v123
    v_mfma_f32_32x32x16_bf16 v[104:119], v[212:215], v[12:15], v[104:119]
    v_exp_f32 v140, v124
    v_cvt_pk_bf16_f32 v153, v138, v139
    v_exp_f32 v141, v125
    v_exp_f32 v142, v126
    v_cvt_pk_bf16_f32 v154, v140, v141
    v_exp_f32 v143, v127
    v_mfma_f32_32x32x16_bf16 v[72:87], v[200:203], v[144:147], v[72:87]
    s_add_u32 s11, s53, 13619200
    v_exp_f32 v136, v128
    v_cvt_pk_bf16_f32 v155, v142, v143
    v_exp_f32 v137, v129
    v_exp_f32 v138, v130
    v_cvt_pk_bf16_f32 v156, v136, v137
    v_exp_f32 v139, v131
    v_mfma_f32_32x32x16_bf16 v[72:87], v[204:207], v[148:151], v[72:87]
    buffer_load_dwordx4 v242, s[12:15], s43 offen offset:3072 sc1 lds
    v_exp_f32 v140, v132
    v_cvt_pk_bf16_f32 v157, v138, v139
    v_exp_f32 v141, v133
    v_exp_f32 v142, v134
    v_cvt_pk_bf16_f32 v158, v140, v141
    v_exp_f32 v143, v135
    v_mfma_f32_32x32x16_bf16 v[120:135], v[208:211], v[16:19], 0
    s_add_u32 m0, m0, 4096
    v_cvt_pk_bf16_f32 v159, v142, v143
    v_exp_f32 v136, v104
    v_exp_f32 v137, v105
    v_exp_f32 v138, v106
    v_cvt_pk_bf16_f32 v144, v136, v137
    v_exp_f32 v139, v107
    v_mfma_f32_32x32x16_bf16 v[120:135], v[212:215], v[20:23], v[120:135]
    buffer_load_dwordx4 v242, s[12:15], s44 offen offset:0 sc1 lds
    v_exp_f32 v140, v108
    v_cvt_pk_bf16_f32 v145, v138, v139
    v_exp_f32 v141, v109
    v_exp_f32 v142, v110
    v_cvt_pk_bf16_f32 v146, v140, v141
    v_exp_f32 v143, v111
    v_mfma_f32_32x32x16_bf16 v[88:103], v[200:203], v[152:155], v[88:103]
    v_exp_f32 v136, v112
    v_cvt_pk_bf16_f32 v147, v142, v143
    v_exp_f32 v137, v113
    v_exp_f32 v138, v114
    v_cvt_pk_bf16_f32 v148, v136, v137
    v_exp_f32 v139, v115
    v_mfma_f32_32x32x16_bf16 v[88:103], v[204:207], v[156:159], v[88:103]
    buffer_load_dwordx4 v[200:203], v241, s[4:7], s9 offen offset:2048 sc1
    v_exp_f32 v140, v116
    v_cvt_pk_bf16_f32 v149, v138, v139
    v_exp_f32 v141, v117
    v_exp_f32 v142, v118
    v_cvt_pk_bf16_f32 v150, v140, v141
    v_exp_f32 v143, v119
    v_mfma_f32_32x32x16_bf16 v[104:119], v[208:211], v[24:27], 0
    buffer_store_dwordx4 v[8:11], v1, s[12:15], s11 offen offset:0 sc1
    v_cvt_pk_bf16_f32 v151, v142, v143
    v_exp_f32 v136, v120
    v_exp_f32 v137, v121
    v_exp_f32 v138, v122
    v_cvt_pk_bf16_f32 v152, v136, v137
    v_exp_f32 v139, v123
    v_mfma_f32_32x32x16_bf16 v[104:119], v[212:215], v[28:31], v[104:119]
    buffer_load_dwordx4 v[204:207], v241, s[4:7], s9 offen offset:3072 sc1
    v_exp_f32 v140, v124
    v_cvt_pk_bf16_f32 v153, v138, v139
    v_exp_f32 v141, v125
    v_exp_f32 v142, v126
    v_cvt_pk_bf16_f32 v154, v140, v141
    v_exp_f32 v143, v127
    v_mfma_f32_32x32x16_bf16 v[40:55], v[216:219], v[144:147], v[40:55]
    buffer_load_dwordx4 v242, s[12:15], s44 offen offset:1024 sc1 lds
    v_exp_f32 v136, v128
    v_cvt_pk_bf16_f32 v155, v142, v143
    v_exp_f32 v137, v129
    v_exp_f32 v138, v130
    v_cvt_pk_bf16_f32 v156, v136, v137
    v_exp_f32 v139, v131
    v_mfma_f32_32x32x16_bf16 v[40:55], v[220:223], v[148:151], v[40:55]
    s_add_u32 s10, s9, 16384
    v_exp_f32 v140, v132
    v_cvt_pk_bf16_f32 v157, v138, v139
    v_exp_f32 v141, v133
    v_exp_f32 v142, v134
    v_cvt_pk_bf16_f32 v158, v140, v141
    v_exp_f32 v143, v135
    v_mfma_f32_32x32x16_bf16 v[120:135], v[208:211], v[32:35], 0
    s_and_b32 s10, s10, 0x3c000
    v_cvt_pk_bf16_f32 v159, v142, v143
    v_exp_f32 v136, v104
    v_exp_f32 v137, v105
    v_exp_f32 v138, v106
    v_cvt_pk_bf16_f32 v144, v136, v137
    v_exp_f32 v139, v107
    v_mfma_f32_32x32x16_bf16 v[120:135], v[212:215], v[36:39], v[120:135]
    buffer_load_dwordx4 v[208:211], v241, s[4:7], s10 offen offset:0 sc1
    v_exp_f32 v140, v108
    v_cvt_pk_bf16_f32 v145, v138, v139
    v_exp_f32 v141, v109
    v_exp_f32 v142, v110
    v_cvt_pk_bf16_f32 v146, v140, v141
    v_exp_f32 v143, v111
    v_mfma_f32_32x32x16_bf16 v[56:71], v[216:219], v[152:155], v[56:71]
    s_waitcnt vmcnt(20)
    v_exp_f32 v136, v112
    v_cvt_pk_bf16_f32 v147, v142, v143
    v_exp_f32 v137, v113
    v_exp_f32 v138, v114
    v_cvt_pk_bf16_f32 v148, v136, v137
    v_exp_f32 v139, v115
    v_mfma_f32_32x32x16_bf16 v[56:71], v[220:223], v[156:159], v[56:71]
    buffer_load_dwordx4 v[212:215], v241, s[4:7], s10 offen offset:1024 sc1
    v_exp_f32 v140, v116
    v_cvt_pk_bf16_f32 v149, v138, v139
    v_exp_f32 v141, v117
    v_exp_f32 v142, v118
    v_cvt_pk_bf16_f32 v150, v140, v141
    v_exp_f32 v143, v119
    v_mfma_f32_32x32x16_bf16 v[104:119], v[160:163], v[8:11], 0
    buffer_load_dwordx4 v242, s[12:15], s44 offen offset:2048 sc1 lds
    v_cvt_pk_bf16_f32 v151, v142, v143
    v_exp_f32 v136, v120
    v_exp_f32 v137, v121
    v_exp_f32 v138, v122
    v_cvt_pk_bf16_f32 v152, v136, v137
    v_exp_f32 v139, v123
    v_mfma_f32_32x32x16_bf16 v[104:119], v[164:167], v[12:15], v[104:119]
    buffer_load_dwordx4 v242, s[12:15], s44 offen offset:3072 sc1 lds
    v_exp_f32 v140, v124
    v_cvt_pk_bf16_f32 v153, v138, v139
    v_exp_f32 v141, v125
    v_exp_f32 v142, v126
    v_cvt_pk_bf16_f32 v154, v140, v141
    v_exp_f32 v143, v127
    v_mfma_f32_32x32x16_bf16 v[72:87], v[216:219], v[144:147], v[72:87]
    v_exp_f32 v136, v128
    v_cvt_pk_bf16_f32 v155, v142, v143
    v_exp_f32 v137, v129
    v_exp_f32 v138, v130
    v_cvt_pk_bf16_f32 v156, v136, v137
    v_exp_f32 v139, v131
    v_mfma_f32_32x32x16_bf16 v[72:87], v[220:223], v[148:151], v[72:87]
    buffer_store_dwordx4 v[8:11], v1, s[12:15], s11 offen offset:1024 sc1
    v_exp_f32 v140, v132
    v_cvt_pk_bf16_f32 v157, v138, v139
    v_exp_f32 v141, v133
    v_exp_f32 v142, v134
    v_cvt_pk_bf16_f32 v158, v140, v141
    v_exp_f32 v143, v135
    v_mfma_f32_32x32x16_bf16 v[120:135], v[160:163], v[16:19], 0
    s_add_u32 m0, m0, 4096
    v_cvt_pk_bf16_f32 v159, v142, v143
    v_exp_f32 v136, v104
    v_exp_f32 v137, v105
    v_exp_f32 v138, v106
    v_cvt_pk_bf16_f32 v144, v136, v137
    v_exp_f32 v139, v107
    v_mfma_f32_32x32x16_bf16 v[120:135], v[164:167], v[20:23], v[120:135]
    buffer_load_dwordx4 v242, s[12:15], s45 offen offset:0 sc1 lds
    v_exp_f32 v140, v108
    v_cvt_pk_bf16_f32 v145, v138, v139
    v_exp_f32 v141, v109
    v_exp_f32 v142, v110
    v_cvt_pk_bf16_f32 v146, v140, v141
    v_exp_f32 v143, v111
    v_mfma_f32_32x32x16_bf16 v[88:103], v[216:219], v[152:155], v[88:103]
    buffer_load_dwordx4 v242, s[12:15], s45 offen offset:1024 sc1 lds
    v_exp_f32 v136, v112
    v_cvt_pk_bf16_f32 v147, v142, v143
    v_exp_f32 v137, v113
    v_exp_f32 v138, v114
    v_cvt_pk_bf16_f32 v148, v136, v137
    v_exp_f32 v139, v115
    v_mfma_f32_32x32x16_bf16 v[88:103], v[220:223], v[156:159], v[88:103]
    buffer_load_dwordx4 v[216:219], v241, s[4:7], s10 offen offset:2048 sc1
    v_exp_f32 v140, v116
    v_cvt_pk_bf16_f32 v149, v138, v139
    v_exp_f32 v141, v117
    v_exp_f32 v142, v118
    v_cvt_pk_bf16_f32 v150, v140, v141
    v_exp_f32 v143, v119
    v_mfma_f32_32x32x16_bf16 v[104:119], v[160:163], v[24:27], 0
    s_add_u32 s11, s3, 15454208
    v_cvt_pk_bf16_f32 v151, v142, v143
    v_exp_f32 v136, v120
    v_exp_f32 v137, v121
    v_exp_f32 v138, v122
    v_cvt_pk_bf16_f32 v152, v136, v137
    v_exp_f32 v139, v123
    v_mfma_f32_32x32x16_bf16 v[104:119], v[164:167], v[28:31], v[104:119]
    buffer_load_dwordx4 v[220:223], v241, s[4:7], s10 offen offset:3072 sc1
    v_exp_f32 v140, v124
    v_cvt_pk_bf16_f32 v153, v138, v139
    v_exp_f32 v141, v125
    v_exp_f32 v142, v126
    v_cvt_pk_bf16_f32 v154, v140, v141
    v_exp_f32 v143, v127
    v_mfma_f32_32x32x16_bf16 v[40:55], v[168:171], v[144:147], v[40:55]
    v_exp_f32 v136, v128
    v_cvt_pk_bf16_f32 v155, v142, v143
    v_exp_f32 v137, v129
    v_exp_f32 v138, v130
    v_cvt_pk_bf16_f32 v156, v136, v137
    v_exp_f32 v139, v131
    v_mfma_f32_32x32x16_bf16 v[40:55], v[172:175], v[148:151], v[40:55]
    s_add_u32 s9, s10, 16384
    v_exp_f32 v140, v132
    v_cvt_pk_bf16_f32 v157, v138, v139
    v_exp_f32 v141, v133
    v_exp_f32 v142, v134
    v_cvt_pk_bf16_f32 v158, v140, v141
    v_exp_f32 v143, v135
    v_mfma_f32_32x32x16_bf16 v[120:135], v[160:163], v[32:35], 0
    s_and_b32 s9, s9, 0x3c000
    v_cvt_pk_bf16_f32 v159, v142, v143
    v_exp_f32 v136, v104
    v_exp_f32 v137, v105
    v_exp_f32 v138, v106
    v_cvt_pk_bf16_f32 v144, v136, v137
    v_exp_f32 v139, v107
    v_mfma_f32_32x32x16_bf16 v[120:135], v[164:167], v[36:39], v[120:135]
    buffer_load_dwordx4 v[160:163], v241, s[4:7], s9 offen offset:0 sc1
    v_exp_f32 v140, v108
    v_cvt_pk_bf16_f32 v145, v138, v139
    v_exp_f32 v141, v109
    v_exp_f32 v142, v110
    v_cvt_pk_bf16_f32 v146, v140, v141
    v_exp_f32 v143, v111
    v_mfma_f32_32x32x16_bf16 v[56:71], v[168:171], v[152:155], v[56:71]
    s_waitcnt vmcnt(20)
    v_exp_f32 v136, v112
    v_cvt_pk_bf16_f32 v147, v142, v143
    v_exp_f32 v137, v113
    v_exp_f32 v138, v114
    v_cvt_pk_bf16_f32 v148, v136, v137
    v_exp_f32 v139, v115
    v_mfma_f32_32x32x16_bf16 v[56:71], v[172:175], v[156:159], v[56:71]
    buffer_load_dwordx4 v[164:167], v241, s[4:7], s9 offen offset:1024 sc1
    v_exp_f32 v140, v116
    v_cvt_pk_bf16_f32 v149, v138, v139
    v_exp_f32 v141, v117
    v_exp_f32 v142, v118
    v_cvt_pk_bf16_f32 v150, v140, v141
    v_exp_f32 v143, v119
    v_mfma_f32_32x32x16_bf16 v[104:119], v[176:179], v[8:11], 0
    buffer_load_dwordx4 v242, s[12:15], s45 offen offset:2048 sc1 lds
    v_cvt_pk_bf16_f32 v151, v142, v143
    v_exp_f32 v136, v120
    v_exp_f32 v137, v121
    v_exp_f32 v138, v122
    v_cvt_pk_bf16_f32 v152, v136, v137
    v_exp_f32 v139, v123
    v_mfma_f32_32x32x16_bf16 v[104:119], v[180:183], v[12:15], v[104:119]
    buffer_load_dwordx4 v242, s[12:15], s45 offen offset:3072 sc1 lds
    v_exp_f32 v140, v124
    v_cvt_pk_bf16_f32 v153, v138, v139
    v_exp_f32 v141, v125
    v_exp_f32 v142, v126
    v_cvt_pk_bf16_f32 v154, v140, v141
    v_exp_f32 v143, v127
    v_mfma_f32_32x32x16_bf16 v[72:87], v[168:171], v[144:147], v[72:87]
    s_add_u32 m0, m0, 4096
    v_exp_f32 v136, v128
    v_cvt_pk_bf16_f32 v155, v142, v143
    v_exp_f32 v137, v129
    v_exp_f32 v138, v130
    v_cvt_pk_bf16_f32 v156, v136, v137
    v_exp_f32 v139, v131
    v_mfma_f32_32x32x16_bf16 v[72:87], v[172:175], v[148:151], v[72:87]
    buffer_store_dwordx2 v[8:9], v247, s[12:15], s11 offen sc1
    v_exp_f32 v140, v132
    v_cvt_pk_bf16_f32 v157, v138, v139
    v_exp_f32 v141, v133
    v_exp_f32 v142, v134
    v_cvt_pk_bf16_f32 v158, v140, v141
    v_exp_f32 v143, v135
    v_mfma_f32_32x32x16_bf16 v[120:135], v[176:179], v[16:19], 0
    buffer_load_dwordx4 v242, s[12:15], s46 offen offset:0 sc1 lds
    v_cvt_pk_bf16_f32 v159, v142, v143
    v_exp_f32 v136, v104
    v_exp_f32 v137, v105
    v_exp_f32 v138, v106
    v_cvt_pk_bf16_f32 v144, v136, v137
    v_exp_f32 v139, v107
    v_mfma_f32_32x32x16_bf16 v[120:135], v[180:183], v[20:23], v[120:135]
    v_exp_f32 v140, v108
    v_cvt_pk_bf16_f32 v145, v138, v139
    v_exp_f32 v141, v109
    v_exp_f32 v142, v110
    v_cvt_pk_bf16_f32 v146, v140, v141
    v_exp_f32 v143, v111
    v_mfma_f32_32x32x16_bf16 v[88:103], v[168:171], v[152:155], v[88:103]
    buffer_load_dwordx4 v242, s[12:15], s46 offen offset:1024 sc1 lds
    v_exp_f32 v136, v112
    v_cvt_pk_bf16_f32 v147, v142, v143
    v_exp_f32 v137, v113
    v_exp_f32 v138, v114
    v_cvt_pk_bf16_f32 v148, v136, v137
    v_exp_f32 v139, v115
    v_mfma_f32_32x32x16_bf16 v[88:103], v[172:175], v[156:159], v[88:103]
    buffer_load_dwordx4 v[168:171], v241, s[4:7], s9 offen offset:2048 sc1
    v_exp_f32 v140, v116
    v_cvt_pk_bf16_f32 v149, v138, v139
    v_exp_f32 v141, v117
    v_exp_f32 v142, v118
    v_cvt_pk_bf16_f32 v150, v140, v141
    v_exp_f32 v143, v119
    v_mfma_f32_32x32x16_bf16 v[104:119], v[176:179], v[24:27], 0
    buffer_load_dwordx4 v242, s[12:15], s46 offen offset:2048 sc1 lds
    v_cvt_pk_bf16_f32 v151, v142, v143
    v_exp_f32 v136, v120
    v_exp_f32 v137, v121
    v_exp_f32 v138, v122
    v_cvt_pk_bf16_f32 v152, v136, v137
    v_exp_f32 v139, v123
    v_mfma_f32_32x32x16_bf16 v[104:119], v[180:183], v[28:31], v[104:119]
    buffer_load_dwordx4 v[172:175], v241, s[4:7], s9 offen offset:3072 sc1
    v_exp_f32 v140, v124
    v_cvt_pk_bf16_f32 v153, v138, v139
    v_exp_f32 v141, v125
    v_exp_f32 v142, v126
    v_cvt_pk_bf16_f32 v154, v140, v141
    v_exp_f32 v143, v127
    v_mfma_f32_32x32x16_bf16 v[40:55], v[184:187], v[144:147], v[40:55]
    buffer_load_dwordx4 v242, s[12:15], s46 offen offset:3072 sc1 lds
    v_exp_f32 v136, v128
    v_cvt_pk_bf16_f32 v155, v142, v143
    v_exp_f32 v137, v129
    v_exp_f32 v138, v130
    v_cvt_pk_bf16_f32 v156, v136, v137
    v_exp_f32 v139, v131
    v_mfma_f32_32x32x16_bf16 v[40:55], v[188:191], v[148:151], v[40:55]
    s_add_u32 s10, s9, 16384
    v_exp_f32 v140, v132
    v_cvt_pk_bf16_f32 v157, v138, v139
    v_exp_f32 v141, v133
    v_exp_f32 v142, v134
    v_cvt_pk_bf16_f32 v158, v140, v141
    v_exp_f32 v143, v135
    v_mfma_f32_32x32x16_bf16 v[120:135], v[176:179], v[32:35], 0
    s_and_b32 s10, s10, 0x3c000
    v_cvt_pk_bf16_f32 v159, v142, v143
    v_exp_f32 v136, v104
    v_exp_f32 v137, v105
    v_exp_f32 v138, v106
    v_cvt_pk_bf16_f32 v144, v136, v137
    v_exp_f32 v139, v107
    v_mfma_f32_32x32x16_bf16 v[120:135], v[180:183], v[36:39], v[120:135]
    buffer_load_dwordx4 v[176:179], v241, s[4:7], s10 offen offset:0 sc1
    v_exp_f32 v140, v108
    v_cvt_pk_bf16_f32 v145, v138, v139
    v_exp_f32 v141, v109
    v_exp_f32 v142, v110
    v_cvt_pk_bf16_f32 v146, v140, v141
    v_exp_f32 v143, v111
    v_mfma_f32_32x32x16_bf16 v[56:71], v[184:187], v[152:155], v[56:71]
    s_waitcnt vmcnt(22)
    v_exp_f32 v136, v112
    v_cvt_pk_bf16_f32 v147, v142, v143
    v_exp_f32 v137, v113
    v_exp_f32 v138, v114
    v_cvt_pk_bf16_f32 v148, v136, v137
    v_exp_f32 v139, v115
    v_mfma_f32_32x32x16_bf16 v[56:71], v[188:191], v[156:159], v[56:71]
    buffer_load_dwordx4 v[180:183], v241, s[4:7], s10 offen offset:1024 sc1
    v_exp_f32 v140, v116
    v_cvt_pk_bf16_f32 v149, v138, v139
    v_exp_f32 v141, v117
    v_exp_f32 v142, v118
    v_cvt_pk_bf16_f32 v150, v140, v141
    v_exp_f32 v143, v119
    v_mfma_f32_32x32x16_bf16 v[104:119], v[192:195], v[8:11], 0
    v_cvt_pk_bf16_f32 v151, v142, v143
    v_exp_f32 v136, v120
    v_exp_f32 v137, v121
    v_exp_f32 v138, v122
    v_cvt_pk_bf16_f32 v152, v136, v137
    v_exp_f32 v139, v123
    v_mfma_f32_32x32x16_bf16 v[104:119], v[196:199], v[12:15], v[104:119]
    s_add_u32 m0, m0, 4096
    v_exp_f32 v140, v124
    v_cvt_pk_bf16_f32 v153, v138, v139
    v_exp_f32 v141, v125
    v_exp_f32 v142, v126
    v_cvt_pk_bf16_f32 v154, v140, v141
    v_exp_f32 v143, v127
    v_mfma_f32_32x32x16_bf16 v[72:87], v[184:187], v[144:147], v[72:87]
    buffer_load_dwordx4 v242, s[12:15], s47 offen offset:0 sc1 lds
    v_exp_f32 v136, v128
    v_cvt_pk_bf16_f32 v155, v142, v143
    v_exp_f32 v137, v129
    v_exp_f32 v138, v130
    v_cvt_pk_bf16_f32 v156, v136, v137
    v_exp_f32 v139, v131
    v_mfma_f32_32x32x16_bf16 v[72:87], v[188:191], v[148:151], v[72:87]
    buffer_load_dwordx4 v242, s[12:15], s47 offen offset:1024 sc1 lds
    v_exp_f32 v140, v132
    v_cvt_pk_bf16_f32 v157, v138, v139
    v_exp_f32 v141, v133
    v_exp_f32 v142, v134
    v_cvt_pk_bf16_f32 v158, v140, v141
    v_exp_f32 v143, v135
    v_mfma_f32_32x32x16_bf16 v[120:135], v[192:195], v[16:19], 0
    v_cvt_pk_bf16_f32 v159, v142, v143
    v_exp_f32 v136, v104
    v_exp_f32 v137, v105
    v_exp_f32 v138, v106
    v_cvt_pk_bf16_f32 v144, v136, v137
    v_exp_f32 v139, v107
    v_mfma_f32_32x32x16_bf16 v[120:135], v[196:199], v[20:23], v[120:135]
    buffer_load_dwordx4 v242, s[12:15], s47 offen offset:2048 sc1 lds
    v_exp_f32 v140, v108
    v_cvt_pk_bf16_f32 v145, v138, v139
    v_exp_f32 v141, v109
    v_exp_f32 v142, v110
    v_cvt_pk_bf16_f32 v146, v140, v141
    v_exp_f32 v143, v111
    v_mfma_f32_32x32x16_bf16 v[88:103], v[184:187], v[152:155], v[88:103]
    buffer_load_dwordx4 v242, s[12:15], s47 offen offset:3072 sc1 lds
    v_exp_f32 v136, v112
    v_cvt_pk_bf16_f32 v147, v142, v143
    v_exp_f32 v137, v113
    v_exp_f32 v138, v114
    v_cvt_pk_bf16_f32 v148, v136, v137
    v_exp_f32 v139, v115
    v_mfma_f32_32x32x16_bf16 v[88:103], v[188:191], v[156:159], v[88:103]
    buffer_load_dwordx4 v[184:187], v241, s[4:7], s10 offen offset:2048 sc1
    v_exp_f32 v140, v116
    v_cvt_pk_bf16_f32 v149, v138, v139
    v_exp_f32 v141, v117
    v_exp_f32 v142, v118
    v_cvt_pk_bf16_f32 v150, v140, v141
    v_exp_f32 v143, v119
    v_mfma_f32_32x32x16_bf16 v[104:119], v[192:195], v[24:27], 0
    buffer_load_dwordx4 a[224:227], v1, s[12:15], s62 offen offset:0 sc1
    v_cvt_pk_bf16_f32 v151, v142, v143
    v_exp_f32 v136, v120
    v_exp_f32 v137, v121
    v_exp_f32 v138, v122
    v_cvt_pk_bf16_f32 v152, v136, v137
    v_exp_f32 v139, v123
    v_mfma_f32_32x32x16_bf16 v[104:119], v[196:199], v[28:31], v[104:119]
    buffer_load_dwordx4 v[188:191], v241, s[4:7], s10 offen offset:3072 sc1
    v_exp_f32 v140, v124
    v_cvt_pk_bf16_f32 v153, v138, v139
    v_exp_f32 v141, v125
    v_exp_f32 v142, v126
    v_cvt_pk_bf16_f32 v154, v140, v141
    v_exp_f32 v143, v127
    v_mfma_f32_32x32x16_bf16 v[40:55], v[200:203], v[144:147], v[40:55]
    v_exp_f32 v136, v128
    v_cvt_pk_bf16_f32 v155, v142, v143
    v_exp_f32 v137, v129
    v_exp_f32 v138, v130
    v_cvt_pk_bf16_f32 v156, v136, v137
    v_exp_f32 v139, v131
    v_mfma_f32_32x32x16_bf16 v[40:55], v[204:207], v[148:151], v[40:55]
    s_add_u32 s9, s10, 16384
    v_exp_f32 v140, v132
    v_cvt_pk_bf16_f32 v157, v138, v139
    v_exp_f32 v141, v133
    v_exp_f32 v142, v134
    v_cvt_pk_bf16_f32 v158, v140, v141
    v_exp_f32 v143, v135
    v_mfma_f32_32x32x16_bf16 v[120:135], v[192:195], v[32:35], 0
    s_and_b32 s9, s9, 0x3c000
    v_cvt_pk_bf16_f32 v159, v142, v143
    v_exp_f32 v136, v104
    v_exp_f32 v137, v105
    v_exp_f32 v138, v106
    v_cvt_pk_bf16_f32 v144, v136, v137
    v_exp_f32 v139, v107
    v_mfma_f32_32x32x16_bf16 v[120:135], v[196:199], v[36:39], v[120:135]
    buffer_load_dwordx4 v[192:195], v241, s[4:7], s9 offen offset:0 sc1
    v_exp_f32 v140, v108
    v_cvt_pk_bf16_f32 v145, v138, v139
    v_exp_f32 v141, v109
    v_exp_f32 v142, v110
    v_cvt_pk_bf16_f32 v146, v140, v141
    v_exp_f32 v143, v111
    v_mfma_f32_32x32x16_bf16 v[56:71], v[200:203], v[152:155], v[56:71]
    s_waitcnt vmcnt(21)
    v_exp_f32 v136, v112
    v_cvt_pk_bf16_f32 v147, v142, v143
    v_exp_f32 v137, v113
    v_exp_f32 v138, v114
    v_cvt_pk_bf16_f32 v148, v136, v137
    v_exp_f32 v139, v115
    v_mfma_f32_32x32x16_bf16 v[56:71], v[204:207], v[156:159], v[56:71]
    buffer_load_dwordx4 v[196:199], v241, s[4:7], s9 offen offset:1024 sc1
    v_exp_f32 v140, v116
    v_cvt_pk_bf16_f32 v149, v138, v139
    v_exp_f32 v141, v117
    v_exp_f32 v142, v118
    v_cvt_pk_bf16_f32 v150, v140, v141
    v_exp_f32 v143, v119
    v_mfma_f32_32x32x16_bf16 v[104:119], v[208:211], v[8:11], 0
    buffer_load_dwordx4 a[228:231], v1, s[12:15], s62 offen offset:1024 sc1
    v_cvt_pk_bf16_f32 v151, v142, v143
    v_exp_f32 v136, v120
    v_exp_f32 v137, v121
    v_exp_f32 v138, v122
    v_cvt_pk_bf16_f32 v152, v136, v137
    v_exp_f32 v139, v123
    v_mfma_f32_32x32x16_bf16 v[104:119], v[212:215], v[12:15], v[104:119]
    buffer_load_dwordx4 a[232:235], v1, s[12:15], s62 offen offset:2048 sc1
    v_exp_f32 v140, v124
    v_cvt_pk_bf16_f32 v153, v138, v139
    v_exp_f32 v141, v125
    v_exp_f32 v142, v126
    v_cvt_pk_bf16_f32 v154, v140, v141
    v_exp_f32 v143, v127
    v_mfma_f32_32x32x16_bf16 v[72:87], v[200:203], v[144:147], v[72:87]
    buffer_load_dwordx4 a[236:239], v1, s[12:15], s62 offen offset:3072 sc1
    v_exp_f32 v136, v128
    v_cvt_pk_bf16_f32 v155, v142, v143
    v_exp_f32 v137, v129
    v_exp_f32 v138, v130
    v_cvt_pk_bf16_f32 v156, v136, v137
    v_exp_f32 v139, v131
    v_mfma_f32_32x32x16_bf16 v[72:87], v[204:207], v[148:151], v[72:87]
    v_exp_f32 v140, v132
    v_cvt_pk_bf16_f32 v157, v138, v139
    v_exp_f32 v141, v133
    v_exp_f32 v142, v134
    v_cvt_pk_bf16_f32 v158, v140, v141
    v_exp_f32 v143, v135
    v_mfma_f32_32x32x16_bf16 v[120:135], v[208:211], v[16:19], 0
    buffer_load_dword v250, v252, s[4:7], s50 offen offset:0
    v_cvt_pk_bf16_f32 v159, v142, v143
    v_exp_f32 v136, v104
    v_exp_f32 v137, v105
    v_exp_f32 v138, v106
    v_cvt_pk_bf16_f32 v144, v136, v137
    v_exp_f32 v139, v107
    v_mfma_f32_32x32x16_bf16 v[120:135], v[212:215], v[20:23], v[120:135]
    buffer_load_dwordx4 a[0:3], v243, s[12:15], 0 offen offset:0 sc1
    v_exp_f32 v140, v108
    v_cvt_pk_bf16_f32 v145, v138, v139
    v_exp_f32 v141, v109
    v_exp_f32 v142, v110
    v_cvt_pk_bf16_f32 v146, v140, v141
    v_exp_f32 v143, v111
    v_mfma_f32_32x32x16_bf16 v[88:103], v[200:203], v[152:155], v[88:103]
    buffer_load_dwordx4 a[4:7], v243, s[12:15], 0 offen offset:1024 sc1
    v_exp_f32 v136, v112
    v_cvt_pk_bf16_f32 v147, v142, v143
    v_exp_f32 v137, v113
    v_exp_f32 v138, v114
    v_cvt_pk_bf16_f32 v148, v136, v137
    v_exp_f32 v139, v115
    v_mfma_f32_32x32x16_bf16 v[88:103], v[204:207], v[156:159], v[88:103]
    buffer_load_dwordx4 v[200:203], v241, s[4:7], s9 offen offset:2048 sc1
    v_exp_f32 v140, v116
    v_cvt_pk_bf16_f32 v149, v138, v139
    v_exp_f32 v141, v117
    v_exp_f32 v142, v118
    v_cvt_pk_bf16_f32 v150, v140, v141
    v_exp_f32 v143, v119
    v_mfma_f32_32x32x16_bf16 v[104:119], v[208:211], v[24:27], 0
    buffer_load_dwordx4 a[8:11], v243, s[12:15], 0 offen offset:2048 sc1
    v_cvt_pk_bf16_f32 v151, v142, v143
    v_exp_f32 v136, v120
    v_exp_f32 v137, v121
    v_exp_f32 v138, v122
    v_cvt_pk_bf16_f32 v152, v136, v137
    v_exp_f32 v139, v123
    v_mfma_f32_32x32x16_bf16 v[104:119], v[212:215], v[28:31], v[104:119]
    buffer_load_dwordx4 v[204:207], v241, s[4:7], s9 offen offset:3072 sc1
    v_exp_f32 v140, v124
    v_cvt_pk_bf16_f32 v153, v138, v139
    v_exp_f32 v141, v125
    v_exp_f32 v142, v126
    v_cvt_pk_bf16_f32 v154, v140, v141
    v_exp_f32 v143, v127
    v_mfma_f32_32x32x16_bf16 v[40:55], v[216:219], v[144:147], v[40:55]
    s_lshl_b32 s11, s34, 10
    v_exp_f32 v136, v128
    v_cvt_pk_bf16_f32 v155, v142, v143
    v_exp_f32 v137, v129
    v_exp_f32 v138, v130
    v_cvt_pk_bf16_f32 v156, v136, v137
    v_exp_f32 v139, v131
    v_mfma_f32_32x32x16_bf16 v[40:55], v[220:223], v[148:151], v[40:55]
    s_add_u32 s10, s9, 16384
    v_exp_f32 v140, v132
    v_cvt_pk_bf16_f32 v157, v138, v139
    v_exp_f32 v141, v133
    v_exp_f32 v142, v134
    v_cvt_pk_bf16_f32 v158, v140, v141
    v_exp_f32 v143, v135
    v_mfma_f32_32x32x16_bf16 v[120:135], v[208:211], v[32:35], 0
    s_and_b32 s10, s10, 0x3c000
    v_cvt_pk_bf16_f32 v159, v142, v143
    v_exp_f32 v136, v104
    v_exp_f32 v137, v105
    v_exp_f32 v138, v106
    v_cvt_pk_bf16_f32 v144, v136, v137
    v_exp_f32 v139, v107
    v_mfma_f32_32x32x16_bf16 v[120:135], v[212:215], v[36:39], v[120:135]
    buffer_load_dwordx4 v[208:211], v241, s[4:7], s10 offen offset:0 sc1
    v_exp_f32 v140, v108
    v_cvt_pk_bf16_f32 v145, v138, v139
    v_exp_f32 v141, v109
    v_exp_f32 v142, v110
    v_cvt_pk_bf16_f32 v146, v140, v141
    v_exp_f32 v143, v111
    v_mfma_f32_32x32x16_bf16 v[56:71], v[216:219], v[152:155], v[56:71]
    s_waitcnt vmcnt(22)
    v_exp_f32 v136, v112
    v_cvt_pk_bf16_f32 v147, v142, v143
    v_exp_f32 v137, v113
    v_exp_f32 v138, v114
    v_cvt_pk_bf16_f32 v148, v136, v137
    v_exp_f32 v139, v115
    v_mfma_f32_32x32x16_bf16 v[56:71], v[220:223], v[156:159], v[56:71]
    buffer_load_dwordx4 v[212:215], v241, s[4:7], s10 offen offset:1024 sc1
    v_exp_f32 v140, v116
    v_cvt_pk_bf16_f32 v149, v138, v139
    v_exp_f32 v141, v117
    v_exp_f32 v142, v118
    v_cvt_pk_bf16_f32 v150, v140, v141
    v_exp_f32 v143, v119
    v_mfma_f32_32x32x16_bf16 v[104:119], v[160:163], v[8:11], 0
    v_cvt_pk_bf16_f32 v151, v142, v143
    v_exp_f32 v136, v120
    v_exp_f32 v137, v121
    v_exp_f32 v138, v122
    v_cvt_pk_bf16_f32 v152, v136, v137
    v_exp_f32 v139, v123
    v_mfma_f32_32x32x16_bf16 v[104:119], v[164:167], v[12:15], v[104:119]
    buffer_load_dwordx4 a[12:15], v243, s[12:15], 0 offen offset:3072 sc1
    v_exp_f32 v140, v124
    v_cvt_pk_bf16_f32 v153, v138, v139
    v_exp_f32 v141, v125
    v_exp_f32 v142, v126
    v_cvt_pk_bf16_f32 v154, v140, v141
    v_exp_f32 v143, v127
    v_mfma_f32_32x32x16_bf16 v[72:87], v[216:219], v[144:147], v[72:87]
    buffer_load_dwordx4 a[16:19], v243, s[12:15], s42 offen offset:0 sc1
    v_exp_f32 v136, v128
    v_cvt_pk_bf16_f32 v155, v142, v143
    v_exp_f32 v137, v129
    v_exp_f32 v138, v130
    v_cvt_pk_bf16_f32 v156, v136, v137
    v_exp_f32 v139, v131
    v_mfma_f32_32x32x16_bf16 v[72:87], v[220:223], v[148:151], v[72:87]
    buffer_load_dwordx4 a[20:23], v243, s[12:15], s42 offen offset:1024 sc1
    v_exp_f32 v140, v132
    v_cvt_pk_bf16_f32 v157, v138, v139
    v_exp_f32 v141, v133
    v_exp_f32 v142, v134
    v_cvt_pk_bf16_f32 v158, v140, v141
    v_exp_f32 v143, v135
    v_mfma_f32_32x32x16_bf16 v[120:135], v[160:163], v[16:19], 0
    s_add_u32 s11, s11, 13545472
    v_cvt_pk_bf16_f32 v159, v142, v143
    v_exp_f32 v136, v104
    v_exp_f32 v137, v105
    v_exp_f32 v138, v106
    v_cvt_pk_bf16_f32 v144, v136, v137
    v_exp_f32 v139, v107
    v_mfma_f32_32x32x16_bf16 v[120:135], v[164:167], v[20:23], v[120:135]
    v_exp_f32 v140, v108
    v_cvt_pk_bf16_f32 v145, v138, v139
    v_exp_f32 v141, v109
    v_exp_f32 v142, v110
    v_cvt_pk_bf16_f32 v146, v140, v141
    v_exp_f32 v143, v111
    v_mfma_f32_32x32x16_bf16 v[88:103], v[216:219], v[152:155], v[88:103]
    buffer_load_dwordx4 a[24:27], v243, s[12:15], s42 offen offset:2048 sc1
    v_exp_f32 v136, v112
    v_cvt_pk_bf16_f32 v147, v142, v143
    v_exp_f32 v137, v113
    v_exp_f32 v138, v114
    v_cvt_pk_bf16_f32 v148, v136, v137
    v_exp_f32 v139, v115
    v_mfma_f32_32x32x16_bf16 v[88:103], v[220:223], v[156:159], v[88:103]
    buffer_load_dwordx4 v[216:219], v241, s[4:7], s10 offen offset:2048 sc1
    v_exp_f32 v140, v116
    v_cvt_pk_bf16_f32 v149, v138, v139
    v_exp_f32 v141, v117
    v_exp_f32 v142, v118
    v_cvt_pk_bf16_f32 v150, v140, v141
    v_exp_f32 v143, v119
    v_mfma_f32_32x32x16_bf16 v[104:119], v[160:163], v[24:27], 0
    buffer_load_dwordx4 a[28:31], v243, s[12:15], s42 offen offset:3072 sc1
    v_cvt_pk_bf16_f32 v151, v142, v143
    v_exp_f32 v136, v120
    v_exp_f32 v137, v121
    v_exp_f32 v138, v122
    v_cvt_pk_bf16_f32 v152, v136, v137
    v_exp_f32 v139, v123
    v_mfma_f32_32x32x16_bf16 v[104:119], v[164:167], v[28:31], v[104:119]
    buffer_load_dwordx4 v[220:223], v241, s[4:7], s10 offen offset:3072 sc1
    v_exp_f32 v140, v124
    v_cvt_pk_bf16_f32 v153, v138, v139
    v_exp_f32 v141, v125
    v_exp_f32 v142, v126
    v_cvt_pk_bf16_f32 v154, v140, v141
    v_exp_f32 v143, v127
    v_mfma_f32_32x32x16_bf16 v[40:55], v[168:171], v[144:147], v[40:55]
    buffer_load_dword v250, v253, s[4:7], s11 offen offset:0
    v_exp_f32 v136, v128
    v_cvt_pk_bf16_f32 v155, v142, v143
    v_exp_f32 v137, v129
    v_exp_f32 v138, v130
    v_cvt_pk_bf16_f32 v156, v136, v137
    v_exp_f32 v139, v131
    v_mfma_f32_32x32x16_bf16 v[40:55], v[172:175], v[148:151], v[40:55]
    buffer_load_dwordx4 a[32:35], v243, s[12:15], s43 offen offset:0 sc1
    v_exp_f32 v140, v132
    v_cvt_pk_bf16_f32 v157, v138, v139
    v_exp_f32 v141, v133
    v_exp_f32 v142, v134
    v_cvt_pk_bf16_f32 v158, v140, v141
    v_exp_f32 v143, v135
    v_mfma_f32_32x32x16_bf16 v[120:135], v[160:163], v[32:35], 0
    buffer_load_dwordx4 a[36:39], v243, s[12:15], s43 offen offset:1024 sc1
    v_cvt_pk_bf16_f32 v159, v142, v143
    v_exp_f32 v136, v104
    v_exp_f32 v137, v105
    v_exp_f32 v138, v106
    v_cvt_pk_bf16_f32 v144, v136, v137
    v_exp_f32 v139, v107
    v_mfma_f32_32x32x16_bf16 v[120:135], v[164:167], v[36:39], v[120:135]
    buffer_load_dwordx4 v[160:163], v245, s[12:15], 0 offen offset:0 sc1
    v_exp_f32 v140, v108
    v_cvt_pk_bf16_f32 v145, v138, v139
    v_exp_f32 v141, v109
    v_exp_f32 v142, v110
    v_cvt_pk_bf16_f32 v146, v140, v141
    v_exp_f32 v143, v111
    v_mfma_f32_32x32x16_bf16 v[56:71], v[168:171], v[152:155], v[56:71]
    s_waitcnt vmcnt(24)
    v_exp_f32 v136, v112
    v_cvt_pk_bf16_f32 v147, v142, v143
    v_exp_f32 v137, v113
    v_exp_f32 v138, v114
    v_cvt_pk_bf16_f32 v148, v136, v137
    v_exp_f32 v139, v115
    v_mfma_f32_32x32x16_bf16 v[56:71], v[172:175], v[156:159], v[56:71]
    buffer_load_dwordx4 v[164:167], v245, s[12:15], 0 offen offset:1024 sc1
    v_exp_f32 v140, v116
    v_cvt_pk_bf16_f32 v149, v138, v139
    v_exp_f32 v141, v117
    v_exp_f32 v142, v118
    v_cvt_pk_bf16_f32 v150, v140, v141
    v_exp_f32 v143, v119
    v_mfma_f32_32x32x16_bf16 v[104:119], v[176:179], v[8:11], 0
    v_cvt_pk_bf16_f32 v151, v142, v143
    v_exp_f32 v136, v120
    v_exp_f32 v137, v121
    v_exp_f32 v138, v122
    v_cvt_pk_bf16_f32 v152, v136, v137
    v_exp_f32 v139, v123
    v_mfma_f32_32x32x16_bf16 v[104:119], v[180:183], v[12:15], v[104:119]
    buffer_load_dwordx4 a[40:43], v243, s[12:15], s43 offen offset:2048 sc1
    v_exp_f32 v140, v124
    v_cvt_pk_bf16_f32 v153, v138, v139
    v_exp_f32 v141, v125
    v_exp_f32 v142, v126
    v_cvt_pk_bf16_f32 v154, v140, v141
    v_exp_f32 v143, v127
    v_mfma_f32_32x32x16_bf16 v[72:87], v[168:171], v[144:147], v[72:87]
    s_add_u32 s11, s53, 15683584
    v_exp_f32 v136, v128
    v_cvt_pk_bf16_f32 v155, v142, v143
    v_exp_f32 v137, v129
    v_exp_f32 v138, v130
    v_cvt_pk_bf16_f32 v156, v136, v137
    v_exp_f32 v139, v131
    v_mfma_f32_32x32x16_bf16 v[72:87], v[172:175], v[148:151], v[72:87]
    buffer_load_dwordx4 a[44:47], v243, s[12:15], s43 offen offset:3072 sc1
    v_exp_f32 v140, v132
    v_cvt_pk_bf16_f32 v157, v138, v139
    v_exp_f32 v141, v133
    v_exp_f32 v142, v134
    v_cvt_pk_bf16_f32 v158, v140, v141
    v_exp_f32 v143, v135
    v_mfma_f32_32x32x16_bf16 v[120:135], v[176:179], v[16:19], 0
    buffer_load_dwordx4 a[48:51], v243, s[12:15], s44 offen offset:0 sc1
    v_cvt_pk_bf16_f32 v159, v142, v143
    v_exp_f32 v136, v104
    v_exp_f32 v137, v105
    v_exp_f32 v138, v106
    v_cvt_pk_bf16_f32 v144, v136, v137
    v_exp_f32 v139, v107
    v_mfma_f32_32x32x16_bf16 v[120:135], v[180:183], v[20:23], v[120:135]
    v_exp_f32 v140, v108
    v_cvt_pk_bf16_f32 v145, v138, v139
    v_exp_f32 v141, v109
    v_exp_f32 v142, v110
    v_cvt_pk_bf16_f32 v146, v140, v141
    v_exp_f32 v143, v111
    v_mfma_f32_32x32x16_bf16 v[88:103], v[168:171], v[152:155], v[88:103]
    buffer_load_dwordx4 a[52:55], v243, s[12:15], s44 offen offset:1024 sc1
    v_exp_f32 v136, v112
    v_cvt_pk_bf16_f32 v147, v142, v143
    v_exp_f32 v137, v113
    v_exp_f32 v138, v114
    v_cvt_pk_bf16_f32 v148, v136, v137
    v_exp_f32 v139, v115
    v_mfma_f32_32x32x16_bf16 v[88:103], v[172:175], v[156:159], v[88:103]
    buffer_load_dwordx4 v[168:171], v246, s[12:15], 0 offen offset:0 sc1
    v_exp_f32 v140, v116
    v_cvt_pk_bf16_f32 v149, v138, v139
    v_exp_f32 v141, v117
    v_exp_f32 v142, v118
    v_cvt_pk_bf16_f32 v150, v140, v141
    v_exp_f32 v143, v119
    v_mfma_f32_32x32x16_bf16 v[104:119], v[176:179], v[24:27], 0
    buffer_load_dword v250, v252, s[12:15], s11 offen offset:0
    v_cvt_pk_bf16_f32 v151, v142, v143
    v_exp_f32 v136, v120
    v_exp_f32 v137, v121
    v_exp_f32 v138, v122
    v_cvt_pk_bf16_f32 v152, v136, v137
    v_exp_f32 v139, v123
    v_mfma_f32_32x32x16_bf16 v[104:119], v[180:183], v[28:31], v[104:119]
    buffer_load_dwordx4 v[172:175], v246, s[12:15], 0 offen offset:1024 sc1
    v_exp_f32 v140, v124
    v_cvt_pk_bf16_f32 v153, v138, v139
    v_exp_f32 v141, v125
    v_exp_f32 v142, v126
    v_cvt_pk_bf16_f32 v154, v140, v141
    v_exp_f32 v143, v127
    v_mfma_f32_32x32x16_bf16 v[40:55], v[184:187], v[144:147], v[40:55]
    buffer_load_dwordx4 a[56:59], v243, s[12:15], s44 offen offset:2048 sc1
    v_exp_f32 v136, v128
    v_cvt_pk_bf16_f32 v155, v142, v143
    v_exp_f32 v137, v129
    v_exp_f32 v138, v130
    v_cvt_pk_bf16_f32 v156, v136, v137
    v_exp_f32 v139, v131
    v_mfma_f32_32x32x16_bf16 v[40:55], v[188:191], v[148:151], v[40:55]
    buffer_load_dwordx4 a[60:63], v243, s[12:15], s44 offen offset:3072 sc1
    v_exp_f32 v140, v132
    v_cvt_pk_bf16_f32 v157, v138, v139
    v_exp_f32 v141, v133
    v_exp_f32 v142, v134
    v_cvt_pk_bf16_f32 v158, v140, v141
    v_exp_f32 v143, v135
    v_mfma_f32_32x32x16_bf16 v[120:135], v[176:179], v[32:35], 0
    v_cvt_pk_bf16_f32 v159, v142, v143
    v_exp_f32 v136, v104
    v_exp_f32 v137, v105
    v_exp_f32 v138, v106
    v_cvt_pk_bf16_f32 v144, v136, v137
    v_exp_f32 v139, v107
    v_mfma_f32_32x32x16_bf16 v[120:135], v[180:183], v[36:39], v[120:135]
    buffer_load_dwordx4 v[176:179], v245, s[12:15], 0 offen offset:2048 sc1
    v_exp_f32 v140, v108
    v_cvt_pk_bf16_f32 v145, v138, v139
    v_exp_f32 v141, v109
    v_exp_f32 v142, v110
    v_cvt_pk_bf16_f32 v146, v140, v141
    v_exp_f32 v143, v111
    v_mfma_f32_32x32x16_bf16 v[56:71], v[184:187], v[152:155], v[56:71]
    s_waitcnt vmcnt(24)
    v_exp_f32 v136, v112
    v_cvt_pk_bf16_f32 v147, v142, v143
    v_exp_f32 v137, v113
    v_exp_f32 v138, v114
    v_cvt_pk_bf16_f32 v148, v136, v137
    v_exp_f32 v139, v115
    v_mfma_f32_32x32x16_bf16 v[56:71], v[188:191], v[156:159], v[56:71]
    buffer_load_dwordx4 v[180:183], v245, s[12:15], 0 offen offset:3072 sc1
    v_exp_f32 v140, v116
    v_cvt_pk_bf16_f32 v149, v138, v139
    v_exp_f32 v141, v117
    v_exp_f32 v142, v118
    v_cvt_pk_bf16_f32 v150, v140, v141
    v_exp_f32 v143, v119
    v_mfma_f32_32x32x16_bf16 v[104:119], v[192:195], v[8:11], 0
    s_add_u32 s11, s54, 17518592
    v_cvt_pk_bf16_f32 v151, v142, v143
    v_exp_f32 v136, v120
    v_exp_f32 v137, v121
    v_exp_f32 v138, v122
    v_cvt_pk_bf16_f32 v152, v136, v137
    v_exp_f32 v139, v123
    v_mfma_f32_32x32x16_bf16 v[104:119], v[196:199], v[12:15], v[104:119]
    buffer_load_dwordx4 a[64:67], v243, s[12:15], s45 offen offset:0 sc1
    v_exp_f32 v140, v124
    v_cvt_pk_bf16_f32 v153, v138, v139
    v_exp_f32 v141, v125
    v_exp_f32 v142, v126
    v_cvt_pk_bf16_f32 v154, v140, v141
    v_exp_f32 v143, v127
    v_mfma_f32_32x32x16_bf16 v[72:87], v[184:187], v[144:147], v[72:87]
    buffer_load_dwordx4 a[68:71], v243, s[12:15], s45 offen offset:1024 sc1
    v_exp_f32 v136, v128
    v_cvt_pk_bf16_f32 v155, v142, v143
    v_exp_f32 v137, v129
    v_exp_f32 v138, v130
    v_cvt_pk_bf16_f32 v156, v136, v137
    v_exp_f32 v139, v131
    v_mfma_f32_32x32x16_bf16 v[72:87], v[188:191], v[148:151], v[72:87]
    buffer_load_dwordx4 a[72:75], v243, s[12:15], s45 offen offset:2048 sc1
    v_exp_f32 v140, v132
    v_cvt_pk_bf16_f32 v157, v138, v139
    v_exp_f32 v141, v133
    v_exp_f32 v142, v134
    v_cvt_pk_bf16_f32 v158, v140, v141
    v_exp_f32 v143, v135
    v_mfma_f32_32x32x16_bf16 v[120:135], v[192:195], v[16:19], 0
    v_cvt_pk_bf16_f32 v159, v142, v143
    v_exp_f32 v136, v104
    v_exp_f32 v137, v105
    v_exp_f32 v138, v106
    v_cvt_pk_bf16_f32 v144, v136, v137
    v_exp_f32 v139, v107
    v_mfma_f32_32x32x16_bf16 v[120:135], v[196:199], v[20:23], v[120:135]
    buffer_load_dword v250, v254, s[12:15], s11 offen offset:0
    v_exp_f32 v140, v108
    v_cvt_pk_bf16_f32 v145, v138, v139
    v_exp_f32 v141, v109
    v_exp_f32 v142, v110
    v_cvt_pk_bf16_f32 v146, v140, v141
    v_exp_f32 v143, v111
    v_mfma_f32_32x32x16_bf16 v[88:103], v[184:187], v[152:155], v[88:103]
    buffer_load_dwordx4 a[76:79], v243, s[12:15], s45 offen offset:3072 sc1
    v_exp_f32 v136, v112
    v_cvt_pk_bf16_f32 v147, v142, v143
    v_exp_f32 v137, v113
    v_exp_f32 v138, v114
    v_cvt_pk_bf16_f32 v148, v136, v137
    v_exp_f32 v139, v115
    v_mfma_f32_32x32x16_bf16 v[88:103], v[188:191], v[156:159], v[88:103]
    buffer_load_dwordx4 v[184:187], v246, s[12:15], 0 offen offset:2048 sc1
    v_exp_f32 v140, v116
    v_cvt_pk_bf16_f32 v149, v138, v139
    v_exp_f32 v141, v117
    v_exp_f32 v142, v118
    v_cvt_pk_bf16_f32 v150, v140, v141
    v_exp_f32 v143, v119
    v_mfma_f32_32x32x16_bf16 v[104:119], v[192:195], v[24:27], 0
    buffer_load_dwordx4 a[80:83], v243, s[12:15], s46 offen offset:0 sc1
    v_cvt_pk_bf16_f32 v151, v142, v143
    v_exp_f32 v136, v120
    v_exp_f32 v137, v121
    v_exp_f32 v138, v122
    v_cvt_pk_bf16_f32 v152, v136, v137
    v_exp_f32 v139, v123
    v_mfma_f32_32x32x16_bf16 v[104:119], v[196:199], v[28:31], v[104:119]
    buffer_load_dwordx4 v[188:191], v246, s[12:15], 0 offen offset:3072 sc1
    v_exp_f32 v140, v124
    v_cvt_pk_bf16_f32 v153, v138, v139
    v_exp_f32 v141, v125
    v_exp_f32 v142, v126
    v_cvt_pk_bf16_f32 v154, v140, v141
    v_exp_f32 v143, v127
    v_mfma_f32_32x32x16_bf16 v[40:55], v[200:203], v[144:147], v[40:55]
    buffer_load_dwordx4 a[84:87], v243, s[12:15], s46 offen offset:1024 sc1
    v_exp_f32 v136, v128
    v_cvt_pk_bf16_f32 v155, v142, v143
    v_exp_f32 v137, v129
    v_exp_f32 v138, v130
    v_cvt_pk_bf16_f32 v156, v136, v137
    v_exp_f32 v139, v131
    v_mfma_f32_32x32x16_bf16 v[40:55], v[204:207], v[148:151], v[40:55]
    v_exp_f32 v140, v132
    v_cvt_pk_bf16_f32 v157, v138, v139
    v_exp_f32 v141, v133
    v_exp_f32 v142, v134
    v_cvt_pk_bf16_f32 v158, v140, v141
    v_exp_f32 v143, v135
    v_mfma_f32_32x32x16_bf16 v[120:135], v[192:195], v[32:35], 0
    buffer_load_dwordx4 a[88:91], v243, s[12:15], s46 offen offset:2048 sc1
    v_cvt_pk_bf16_f32 v159, v142, v143
    v_exp_f32 v136, v104
    v_exp_f32 v137, v105
    v_exp_f32 v138, v106
    v_cvt_pk_bf16_f32 v144, v136, v137
    v_exp_f32 v139, v107
    v_mfma_f32_32x32x16_bf16 v[120:135], v[196:199], v[36:39], v[120:135]
    buffer_load_dwordx4 v[192:195], v245, s[12:15], s42 offen offset:0 sc1
    v_exp_f32 v140, v108
    v_cvt_pk_bf16_f32 v145, v138, v139
    v_exp_f32 v141, v109
    v_exp_f32 v142, v110
    v_cvt_pk_bf16_f32 v146, v140, v141
    v_exp_f32 v143, v111
    v_mfma_f32_32x32x16_bf16 v[56:71], v[200:203], v[152:155], v[56:71]
    s_waitcnt vmcnt(27)
    v_exp_f32 v136, v112
    v_cvt_pk_bf16_f32 v147, v142, v143
    v_exp_f32 v137, v113
    v_exp_f32 v138, v114
    v_cvt_pk_bf16_f32 v148, v136, v137
    v_exp_f32 v139, v115
    v_mfma_f32_32x32x16_bf16 v[56:71], v[204:207], v[156:159], v[56:71]
    buffer_load_dwordx4 v[196:199], v245, s[12:15], s42 offen offset:1024 sc1
    v_exp_f32 v140, v116
    v_cvt_pk_bf16_f32 v149, v138, v139
    v_exp_f32 v141, v117
    v_exp_f32 v142, v118
    v_cvt_pk_bf16_f32 v150, v140, v141
    v_exp_f32 v143, v119
    v_mfma_f32_32x32x16_bf16 v[104:119], v[208:211], v[8:11], 0
    buffer_load_dwordx4 a[92:95], v243, s[12:15], s46 offen offset:3072 sc1
    v_cvt_pk_bf16_f32 v151, v142, v143
    v_exp_f32 v136, v120
    v_exp_f32 v137, v121
    v_exp_f32 v138, v122
    v_cvt_pk_bf16_f32 v152, v136, v137
    v_exp_f32 v139, v123
    v_mfma_f32_32x32x16_bf16 v[104:119], v[212:215], v[12:15], v[104:119]
    buffer_load_dwordx4 a[96:99], v243, s[12:15], s47 offen offset:0 sc1
    v_exp_f32 v140, v124
    v_cvt_pk_bf16_f32 v153, v138, v139
    v_exp_f32 v141, v125
    v_exp_f32 v142, v126
    v_cvt_pk_bf16_f32 v154, v140, v141
    v_exp_f32 v143, v127
    v_mfma_f32_32x32x16_bf16 v[72:87], v[200:203], v[144:147], v[72:87]
    v_exp_f32 v136, v128
    v_cvt_pk_bf16_f32 v155, v142, v143
    v_exp_f32 v137, v129
    v_exp_f32 v138, v130
    v_cvt_pk_bf16_f32 v156, v136, v137
    v_exp_f32 v139, v131
    v_mfma_f32_32x32x16_bf16 v[72:87], v[204:207], v[148:151], v[72:87]
    buffer_load_dwordx4 a[100:103], v243, s[12:15], s47 offen offset:1024 sc1
    v_exp_f32 v140, v132
    v_cvt_pk_bf16_f32 v157, v138, v139
    v_exp_f32 v141, v133
    v_exp_f32 v142, v134
    v_cvt_pk_bf16_f32 v158, v140, v141
    v_exp_f32 v143, v135
    v_mfma_f32_32x32x16_bf16 v[120:135], v[208:211], v[16:19], 0
    buffer_load_dwordx4 a[104:107], v243, s[12:15], s47 offen offset:2048 sc1
    v_cvt_pk_bf16_f32 v159, v142, v143
    v_exp_f32 v136, v104
    v_exp_f32 v137, v105
    v_exp_f32 v138, v106
    v_cvt_pk_bf16_f32 v144, v136, v137
    v_exp_f32 v139, v107
    v_mfma_f32_32x32x16_bf16 v[120:135], v[212:215], v[20:23], v[120:135]
    buffer_load_dwordx4 a[108:111], v243, s[12:15], s47 offen offset:3072 sc1
    v_exp_f32 v140, v108
    v_cvt_pk_bf16_f32 v145, v138, v139
    v_exp_f32 v141, v109
    v_exp_f32 v142, v110
    v_cvt_pk_bf16_f32 v146, v140, v141
    v_exp_f32 v143, v111
    v_mfma_f32_32x32x16_bf16 v[88:103], v[200:203], v[152:155], v[88:103]
    v_exp_f32 v136, v112
    v_cvt_pk_bf16_f32 v147, v142, v143
    v_exp_f32 v137, v113
    v_exp_f32 v138, v114
    v_cvt_pk_bf16_f32 v148, v136, v137
    v_exp_f32 v139, v115
    v_mfma_f32_32x32x16_bf16 v[88:103], v[204:207], v[156:159], v[88:103]
    buffer_load_dwordx4 v[200:203], v246, s[12:15], s42 offen offset:0 sc1
    v_exp_f32 v140, v116
    v_cvt_pk_bf16_f32 v149, v138, v139
    v_exp_f32 v141, v117
    v_exp_f32 v142, v118
    v_cvt_pk_bf16_f32 v150, v140, v141
    v_exp_f32 v143, v119
    v_mfma_f32_32x32x16_bf16 v[104:119], v[208:211], v[24:27], 0
    v_cvt_pk_bf16_f32 v151, v142, v143
    v_exp_f32 v136, v120
    v_exp_f32 v137, v121
    v_exp_f32 v138, v122
    v_cvt_pk_bf16_f32 v152, v136, v137
    v_exp_f32 v139, v123
    v_mfma_f32_32x32x16_bf16 v[104:119], v[212:215], v[28:31], v[104:119]
    buffer_load_dwordx4 v[204:207], v246, s[12:15], s42 offen offset:1024 sc1
    v_exp_f32 v140, v124
    v_cvt_pk_bf16_f32 v153, v138, v139
    v_exp_f32 v141, v125
    v_exp_f32 v142, v126
    v_cvt_pk_bf16_f32 v154, v140, v141
    v_exp_f32 v143, v127
    v_mfma_f32_32x32x16_bf16 v[40:55], v[216:219], v[144:147], v[40:55]
    v_exp_f32 v136, v128
    v_cvt_pk_bf16_f32 v155, v142, v143
    v_exp_f32 v137, v129
    v_exp_f32 v138, v130
    v_cvt_pk_bf16_f32 v156, v136, v137
    v_exp_f32 v139, v131
    v_mfma_f32_32x32x16_bf16 v[40:55], v[220:223], v[148:151], v[40:55]
    v_exp_f32 v140, v132
    v_cvt_pk_bf16_f32 v157, v138, v139
    v_exp_f32 v141, v133
    v_exp_f32 v142, v134
    v_cvt_pk_bf16_f32 v158, v140, v141
    v_exp_f32 v143, v135
    v_mfma_f32_32x32x16_bf16 v[120:135], v[208:211], v[32:35], 0
    v_cvt_pk_bf16_f32 v159, v142, v143
    v_exp_f32 v136, v104
    v_exp_f32 v137, v105
    v_exp_f32 v138, v106
    v_cvt_pk_bf16_f32 v144, v136, v137
    v_exp_f32 v139, v107
    v_mfma_f32_32x32x16_bf16 v[120:135], v[212:215], v[36:39], v[120:135]
    buffer_load_dwordx4 v[208:211], v245, s[12:15], s42 offen offset:2048 sc1
    ds_write_b128 v6, v[40:43] offset:0
    v_exp_f32 v140, v108
    v_cvt_pk_bf16_f32 v145, v138, v139
    v_exp_f32 v141, v109
    v_exp_f32 v142, v110
    v_cvt_pk_bf16_f32 v146, v140, v141
    v_exp_f32 v143, v111
    v_mfma_f32_32x32x16_bf16 v[56:71], v[216:219], v[152:155], v[56:71]
    ds_write_b128 v6, v[44:47] offset:1024
    v_cndmask_b32 v53, v53, v224, s[36:37]
    v_exp_f32 v136, v112
    v_cvt_pk_bf16_f32 v147, v142, v143
    v_exp_f32 v137, v113
    v_exp_f32 v138, v114
    v_cvt_pk_bf16_f32 v148, v136, v137
    v_exp_f32 v139, v115
    v_mfma_f32_32x32x16_bf16 v[56:71], v[220:223], v[156:159], v[56:71]
    buffer_load_dwordx4 v[212:215], v245, s[12:15], s42 offen offset:3072 sc1
    ds_write_b128 v6, v[48:51] offset:2048
    v_exp_f32 v140, v116
    v_cvt_pk_bf16_f32 v149, v138, v139
    v_exp_f32 v141, v117
    v_exp_f32 v142, v118
    v_cvt_pk_bf16_f32 v150, v140, v141
    v_exp_f32 v143, v119
    ds_write_b128 v6, v[52:55] offset:3072
    v_cvt_pk_bf16_f32 v151, v142, v143
    v_exp_f32 v136, v120
    v_exp_f32 v137, v121
    v_exp_f32 v138, v122
    v_cvt_pk_bf16_f32 v152, v136, v137
    v_exp_f32 v139, v123
    ds_write_b128 v5, v[56:59] offset:0
    v_exp_f32 v140, v124
    v_cvt_pk_bf16_f32 v153, v138, v139
    v_exp_f32 v141, v125
    v_exp_f32 v142, v126
    v_cvt_pk_bf16_f32 v154, v140, v141
    v_exp_f32 v143, v127
    v_mfma_f32_32x32x16_bf16 v[72:87], v[216:219], v[144:147], v[72:87]
    ds_write_b128 v5, v[60:63] offset:1024
    v_cndmask_b32 v69, v69, v225, s[36:37]
    v_exp_f32 v136, v128
    v_cvt_pk_bf16_f32 v155, v142, v143
    v_exp_f32 v137, v129
    v_exp_f32 v138, v130
    v_cvt_pk_bf16_f32 v156, v136, v137
    v_exp_f32 v139, v131
    v_mfma_f32_32x32x16_bf16 v[72:87], v[220:223], v[148:151], v[72:87]
    ds_write_b128 v5, v[64:67] offset:2048
    v_exp_f32 v140, v132
    v_cvt_pk_bf16_f32 v157, v138, v139
    v_exp_f32 v141, v133
    v_exp_f32 v142, v134
    v_cvt_pk_bf16_f32 v158, v140, v141
    v_exp_f32 v143, v135
    ds_write_b128 v5, v[68:71] offset:3072
    v_cvt_pk_bf16_f32 v159, v142, v143
    v_mfma_f32_32x32x16_bf16 v[88:103], v[216:219], v[152:155], v[88:103]
    v_mov_b32 v228, 0x4e800000
    v_mfma_f32_32x32x16_bf16 v[88:103], v[220:223], v[156:159], v[88:103]
    v_cmp_nle_f32 s[62:63], v52, v228
    v_cmp_nle_f32 s[10:11], v68, v228
    v_cndmask_b32 v85, v85, v226, s[36:37]
    v_cmp_nle_f32 vcc, v84, v228
    ds_write_b128 v4, v[72:75] offset:0
    ds_write_b128 v4, v[76:79] offset:1024
    ds_write_b128 v4, v[80:83] offset:2048
    ds_write_b128 v4, v[84:87] offset:3072
    buffer_load_dwordx4 v[216:219], v246, s[12:15], s42 offen offset:2048 sc1
    buffer_load_dwordx4 v[220:223], v246, s[12:15], s42 offen offset:3072 sc1
    s_or_b32 s63, s63, s11
    s_or_b32 s63, s63, vcc_hi
    v_cmp_nle_f32 vcc, v100, v228
    v_min3_f32 v228, v52, v68, v84
    s_or_b32 s63, s63, vcc_hi
    v_min_f32 v228, v228, v100
    v_cmp_gt_f32 vcc, 0x30800000, v228
    s_or_b32 s63, s63, vcc_hi
    s_cmp_lg_u32 s63, 0
    s_cbranch_scc1 L_attn_fb_17
L_attn_merge_16:
    v_mov_b32 v235, v227
    s_waitcnt lgkmcnt(0)
    s_barrier
    ds_read_b128 v[52:55], v7 offset:3072
    ds_read_b128 v[68:71], v7 offset:7168
    ds_read_b128 v[84:87], v7 offset:11264
    ds_read_b128 v[40:43], v7 offset:0
    ds_read_b128 v[44:47], v7 offset:1024
    ds_read_b128 v[48:51], v7 offset:2048
    ds_read_b128 v[56:59], v7 offset:4096
    ds_read_b128 v[60:63], v7 offset:5120
    ds_read_b128 v[64:67], v7 offset:6144
    ds_read_b128 v[72:75], v7 offset:8192
    ds_read_b128 v[76:79], v7 offset:9216
    ds_read_b128 v[80:83], v7 offset:10240
    v_permlane32_swap_b32 v235, v227
    s_waitcnt lgkmcnt(9)
    v_mov_b32 v224, v53
    v_mov_b32 v232, v53
    v_mov_b32 v225, v69
    v_mov_b32 v233, v69
    v_mov_b32 v226, v85
    v_mov_b32 v234, v85
    s_nop 0
    v_permlane32_swap_b32 v232, v224
    v_permlane32_swap_b32 v233, v225
    v_permlane32_swap_b32 v234, v226
    v_min3_f32 v229, v224, v225, v227
    v_min_f32 v229, v229, v226
    v_sub_f32 v224, v229, v224
    v_sub_f32 v225, v229, v225
    v_sub_f32 v226, v229, v226
    v_sub_f32 v227, v229, v227
    v_exp_f32 v110, v227
    v_exp_f32 v104, v224
    v_exp_f32 v106, v225
    v_exp_f32 v108, v226
    v_mul_f32 v228, v100, v110
    v_fma_f32 v228, v52, v104, v228
    v_fma_f32 v228, v68, v106, v228
    v_fma_f32 v228, v84, v108, v228
    v_mov_b32 v229, v228
    v_pk_mul_f32 v[88:89], v[88:89], v[110:111] op_sel_hi:[1,0]
    v_pk_mul_f32 v[90:91], v[90:91], v[110:111] op_sel_hi:[1,0]
    v_permlane32_swap_b32 v228, v229
    v_rcp_f32 v230, v229
    v_pk_mul_f32 v[92:93], v[92:93], v[110:111] op_sel_hi:[1,0]
    v_pk_mul_f32 v[94:95], v[94:95], v[110:111] op_sel_hi:[1,0]
    v_pk_mul_f32 v[96:97], v[96:97], v[110:111] op_sel_hi:[1,0]
    v_pk_mul_f32 v[98:99], v[98:99], v[110:111] op_sel_hi:[1,0]
    v_pk_mul_f32 v[100:101], v[100:101], v[110:111] op_sel_hi:[1,0]
    v_pk_mul_f32 v[102:103], v[102:103], v[110:111] op_sel_hi:[1,0]
    s_waitcnt lgkmcnt(6)
    v_pk_fma_f32 v[88:89], v[40:41], v[104:105], v[88:89] op_sel_hi:[1,0,1]
    v_pk_fma_f32 v[90:91], v[42:43], v[104:105], v[90:91] op_sel_hi:[1,0,1]
    v_pk_fma_f32 v[92:93], v[44:45], v[104:105], v[92:93] op_sel_hi:[1,0,1]
    v_pk_fma_f32 v[94:95], v[46:47], v[104:105], v[94:95] op_sel_hi:[1,0,1]
    v_pk_fma_f32 v[96:97], v[48:49], v[104:105], v[96:97] op_sel_hi:[1,0,1]
    v_pk_fma_f32 v[98:99], v[50:51], v[104:105], v[98:99] op_sel_hi:[1,0,1]
    v_pk_fma_f32 v[100:101], v[52:53], v[104:105], v[100:101] op_sel_hi:[1,0,1]
    v_pk_fma_f32 v[102:103], v[54:55], v[104:105], v[102:103] op_sel_hi:[1,0,1]
    s_waitcnt lgkmcnt(3)
    v_pk_fma_f32 v[88:89], v[56:57], v[106:107], v[88:89] op_sel_hi:[1,0,1]
    v_pk_fma_f32 v[90:91], v[58:59], v[106:107], v[90:91] op_sel_hi:[1,0,1]
    v_pk_fma_f32 v[92:93], v[60:61], v[106:107], v[92:93] op_sel_hi:[1,0,1]
    v_pk_fma_f32 v[94:95], v[62:63], v[106:107], v[94:95] op_sel_hi:[1,0,1]
    v_pk_fma_f32 v[96:97], v[64:65], v[106:107], v[96:97] op_sel_hi:[1,0,1]
    v_pk_fma_f32 v[98:99], v[66:67], v[106:107], v[98:99] op_sel_hi:[1,0,1]
    v_pk_fma_f32 v[100:101], v[68:69], v[106:107], v[100:101] op_sel_hi:[1,0,1]
    v_pk_fma_f32 v[102:103], v[70:71], v[106:107], v[102:103] op_sel_hi:[1,0,1]
    s_waitcnt lgkmcnt(0)
    v_pk_fma_f32 v[88:89], v[72:73], v[108:109], v[88:89] op_sel_hi:[1,0,1]
    v_pk_fma_f32 v[90:91], v[74:75], v[108:109], v[90:91] op_sel_hi:[1,0,1]
    v_pk_fma_f32 v[92:93], v[76:77], v[108:109], v[92:93] op_sel_hi:[1,0,1]
    v_pk_fma_f32 v[94:95], v[78:79], v[108:109], v[94:95] op_sel_hi:[1,0,1]
    v_pk_fma_f32 v[96:97], v[80:81], v[108:109], v[96:97] op_sel_hi:[1,0,1]
    v_pk_fma_f32 v[98:99], v[82:83], v[108:109], v[98:99] op_sel_hi:[1,0,1]
    v_pk_fma_f32 v[100:101], v[84:85], v[108:109], v[100:101] op_sel_hi:[1,0,1]
    v_pk_fma_f32 v[102:103], v[86:87], v[108:109], v[102:103] op_sel_hi:[1,0,1]
    v_pk_mul_f32 v[88:89], v[88:89], v[230:231] op_sel_hi:[1,0]
    v_pk_mul_f32 v[90:91], v[90:91], v[230:231] op_sel_hi:[1,0]
    v_pk_mul_f32 v[92:93], v[92:93], v[230:231] op_sel_hi:[1,0]
    v_pk_mul_f32 v[94:95], v[94:95], v[230:231] op_sel_hi:[1,0]
    v_cvt_pk_bf16_f32 v144, v88, v89
    v_cvt_pk_bf16_f32 v145, v90, v91
    v_cvt_pk_bf16_f32 v146, v92, v93
    v_cvt_pk_bf16_f32 v147, v94, v95
    buffer_store_dwordx4 v[144:147], v1, s[4:7], s50 offen
    v_pk_mul_f32 v[96:97], v[96:97], v[230:231] op_sel_hi:[1,0]
    v_pk_mul_f32 v[98:99], v[98:99], v[230:231] op_sel_hi:[1,0]
    v_pk_mul_f32 v[100:101], v[100:101], v[230:231] op_sel_hi:[1,0]
    v_pk_mul_f32 v[102:103], v[102:103], v[230:231] op_sel_hi:[1,0]
    v_cvt_pk_bf16_f32 v148, v96, v97
    v_cvt_pk_bf16_f32 v149, v98, v99
    v_cvt_pk_bf16_f32 v150, v100, v101
    v_cvt_pk_bf16_f32 v151, v102, v103
    v_cndmask_b32 v150, v150, 0, s[36:37]
    v_cndmask_b32 v151, v151, 0, s[36:37]
    buffer_store_dwordx4 v[148:151], v1, s[4:7], s50 offen offset:1024
    v_mov_b32 v255, 1
    s_cmp_lg_u32 s24, 0
    s_mov_b64 exec, 1
    s_waitcnt vmcnt(0)
    s_cbranch_scc1 L_pub_slow_18
    buffer_store_dword v255, off, s[4:7], s51 offset:0
L_pub_done_19:
    s_mov_b64 exec, -1
    s_barrier
    s_cmp_eq_u32 s29, 0
    s_cbranch_scc1 L_norole
    s_lshl_b32 s9, s30, 15
    s_lshl_b32 s10, s8, 13
    s_add_u32 s10, s10, 17747968
    s_add_u32 s11, s9, s10
    v_add_u32 v8, s11, v1
    s_xor_b32 s9, s9, 32768
    s_add_u32 s11, s9, s10
    v_add_u32 v9, s11, v1
    v_accvgpr_read_b32 v80, a240
    v_accvgpr_read_b32 v81, a241
    v_accvgpr_read_b32 v82, a242
    v_accvgpr_read_b32 v83, a243
    v_accvgpr_read_b32 v84, a244
    v_accvgpr_read_b32 v85, a245
    v_accvgpr_read_b32 v86, a246
    v_accvgpr_read_b32 v87, a247
    v_lshlrev_b32 v16, 16, v80
    v_and_b32 v17, 0xffff0000, v80
    v_lshlrev_b32 v18, 16, v81
    v_and_b32 v19, 0xffff0000, v81
    v_lshlrev_b32 v20, 16, v82
    v_and_b32 v21, 0xffff0000, v82
    v_lshlrev_b32 v22, 16, v83
    v_and_b32 v23, 0xffff0000, v83
    v_lshlrev_b32 v24, 16, v84
    v_and_b32 v25, 0xffff0000, v84
    v_lshlrev_b32 v26, 16, v85
    v_and_b32 v27, 0xffff0000, v85
    v_lshlrev_b32 v28, 16, v86
    v_and_b32 v29, 0xffff0000, v86
    v_lshlrev_b32 v30, 16, v87
    v_and_b32 v31, 0xffff0000, v87
    s_mov_b64 exec, s[38:39]
L_poll_20:
    buffer_load_dword v255, v3, s[4:7], s52 offen offset:0 sc1
    s_waitcnt vmcnt(0)
    v_cmp_eq_u32 vcc, 0, v255
    s_cbranch_vccz L_poll_done_21
    s_sub_u32 s25, s25, 1
    s_cmp_gt_i32 s25, 0
    s_cbranch_scc1 L_poll_20
    s_mov_b32 s25, 0
L_poll_done_21:
    s_mov_b64 exec, -1
    s_cmp_lg_u32 s24, 0
    s_cbranch_scc1 L_poll_slow_22
L_poll_ret_23:
    buffer_load_dwordx4 v[80:83], v8, s[4:7], 0 offen offset:0 sc1
    buffer_load_dwordx4 v[84:87], v9, s[4:7], 0 offen offset:0 sc1
    buffer_load_dwordx4 v[88:91], v8, s[4:7], 0 offen offset:1024 sc1
    buffer_load_dwordx4 v[92:95], v9, s[4:7], 0 offen offset:1024 sc1
    buffer_load_dwordx4 v[96:99], v8, s[4:7], 0 offen offset:2048 sc1
    buffer_load_dwordx4 v[100:103], v9, s[4:7], 0 offen offset:2048 sc1
    buffer_load_dwordx4 v[104:107], v8, s[4:7], 0 offen offset:3072 sc1
    buffer_load_dwordx4 v[108:111], v9, s[4:7], 0 offen offset:3072 sc1
    s_waitcnt vmcnt(7)
    v_mfma_f32_32x32x16_bf16 v[16:31], v[160:163], v[80:83], v[16:31]
    buffer_load_dwordx4 v[112:115], v8, s[4:7], s42 offen offset:0 sc1
    v_mfma_f32_32x32x16_bf16 v[32:47], v[168:171], v[80:83], 0
    s_waitcnt vmcnt(7)
    v_mfma_f32_32x32x16_bf16 v[48:63], v[160:163], v[84:87], 0
    buffer_load_dwordx4 v[116:119], v9, s[4:7], s42 offen offset:0 sc1
    v_mfma_f32_32x32x16_bf16 v[64:79], v[168:171], v[84:87], 0
    s_waitcnt vmcnt(7)
    v_mfma_f32_32x32x16_bf16 v[16:31], v[164:167], v[88:91], v[16:31]
    buffer_load_dwordx4 v[120:123], v8, s[4:7], s42 offen offset:1024 sc1
    v_mfma_f32_32x32x16_bf16 v[32:47], v[172:175], v[88:91], v[32:47]
    s_waitcnt vmcnt(7)
    v_mfma_f32_32x32x16_bf16 v[48:63], v[164:167], v[92:95], v[48:63]
    buffer_load_dwordx4 v[124:127], v9, s[4:7], s42 offen offset:1024 sc1
    v_mfma_f32_32x32x16_bf16 v[64:79], v[172:175], v[92:95], v[64:79]
    s_waitcnt vmcnt(7)
    v_mfma_f32_32x32x16_bf16 v[16:31], v[176:179], v[96:99], v[16:31]
    buffer_load_dwordx4 v[128:131], v8, s[4:7], s42 offen offset:2048 sc1
    v_mfma_f32_32x32x16_bf16 v[32:47], v[184:187], v[96:99], v[32:47]
    s_waitcnt vmcnt(7)
    v_mfma_f32_32x32x16_bf16 v[48:63], v[176:179], v[100:103], v[48:63]
    buffer_load_dwordx4 v[132:135], v9, s[4:7], s42 offen offset:2048 sc1
    v_mfma_f32_32x32x16_bf16 v[64:79], v[184:187], v[100:103], v[64:79]
    s_waitcnt vmcnt(7)
    v_mfma_f32_32x32x16_bf16 v[16:31], v[180:183], v[104:107], v[16:31]
    buffer_load_dwordx4 v[136:139], v8, s[4:7], s42 offen offset:3072 sc1
    v_mfma_f32_32x32x16_bf16 v[32:47], v[188:191], v[104:107], v[32:47]
    s_waitcnt vmcnt(7)
    v_mfma_f32_32x32x16_bf16 v[48:63], v[180:183], v[108:111], v[48:63]
    buffer_load_dwordx4 v[140:143], v9, s[4:7], s42 offen offset:3072 sc1
    v_mfma_f32_32x32x16_bf16 v[64:79], v[188:191], v[108:111], v[64:79]
    s_waitcnt vmcnt(7)
    v_mfma_f32_32x32x16_bf16 v[32:47], v[200:203], v[112:115], v[32:47]
    s_waitcnt vmcnt(5)
    v_mfma_f32_32x32x16_bf16 v[32:47], v[204:207], v[120:123], v[32:47]
    s_waitcnt vmcnt(3)
    v_mfma_f32_32x32x16_bf16 v[32:47], v[216:219], v[128:131], v[32:47]
    s_waitcnt vmcnt(1)
    v_mfma_f32_32x32x16_bf16 v[32:47], v[220:223], v[136:139], v[32:47]
    v_mfma_f32_32x32x16_bf16 v[64:79], v[200:203], v[116:119], v[64:79]
    s_nop 4
    v_mfma_f32_32x32x16_bf16 v[64:79], v[204:207], v[124:127], v[64:79]
    s_nop 4
    v_mfma_f32_32x32x16_bf16 v[64:79], v[216:219], v[132:135], v[64:79]
    ds_write_b128 v4, v[32:35] offset:0
    ds_write_b128 v4, v[36:39] offset:1024
    s_waitcnt vmcnt(0)
    v_mfma_f32_32x32x16_bf16 v[64:79], v[220:223], v[140:143], v[64:79]
    ds_write_b128 v4, v[40:43] offset:2048
    ds_write_b128 v4, v[44:47] offset:3072
    v_mfma_f32_32x32x16_bf16 v[48:63], v[192:195], v[116:119], v[48:63]
    s_nop 4
    v_mfma_f32_32x32x16_bf16 v[48:63], v[196:199], v[124:127], v[48:63]
    s_nop 4
    v_mfma_f32_32x32x16_bf16 v[48:63], v[208:211], v[132:135], v[48:63]
    ds_write_b128 v6, v[64:67] offset:0
    ds_write_b128 v6, v[68:71] offset:1024
    v_mfma_f32_32x32x16_bf16 v[48:63], v[212:215], v[140:143], v[48:63]
    ds_write_b128 v6, v[72:75] offset:2048
    ds_write_b128 v6, v[76:79] offset:3072
    v_mfma_f32_32x32x16_bf16 v[16:31], v[192:195], v[112:115], v[16:31]
    s_nop 4
    v_mfma_f32_32x32x16_bf16 v[16:31], v[196:199], v[120:123], v[16:31]
    s_nop 4
    v_mfma_f32_32x32x16_bf16 v[16:31], v[208:211], v[128:131], v[16:31]
    ds_write_b128 v5, v[48:51] offset:0
    ds_write_b128 v5, v[52:55] offset:1024
    v_mfma_f32_32x32x16_bf16 v[16:31], v[212:215], v[136:139], v[16:31]
    ds_write_b128 v5, v[56:59] offset:2048
    ds_write_b128 v5, v[60:63] offset:3072
    s_waitcnt lgkmcnt(0)
    s_barrier
    ds_read_b128 v[32:35], v7 offset:0
    ds_read_b128 v[36:39], v7 offset:1024
    ds_read_b128 v[40:43], v7 offset:2048
    ds_read_b128 v[44:47], v7 offset:3072
    ds_read_b128 v[48:51], v7 offset:4096
    ds_read_b128 v[52:55], v7 offset:5120
    ds_read_b128 v[56:59], v7 offset:6144
    ds_read_b128 v[60:63], v7 offset:7168
    ds_read_b128 v[64:67], v7 offset:8192
    ds_read_b128 v[68:71], v7 offset:9216
    ds_read_b128 v[72:75], v7 offset:10240
    ds_read_b128 v[76:79], v7 offset:11264
    v_mov_b32 v9, 0x3f803f80
    v_mov_b32 v10, 0
    v_mov_b32 v11, 0
    v_lshlrev_b32 v12, 3, v0
    s_add_u32 s9, s53, 15683584
    s_add_u32 s10, s54, 17518592
    s_add_u32 s11, s55, 13561856
    s_waitcnt lgkmcnt(8)
    v_pk_add_f32 v[16:17], v[16:17], v[32:33]
    v_pk_add_f32 v[18:19], v[18:19], v[34:35]
    v_pk_add_f32 v[20:21], v[20:21], v[36:37]
    v_pk_add_f32 v[22:23], v[22:23], v[38:39]
    v_pk_add_f32 v[24:25], v[24:25], v[40:41]
    v_pk_add_f32 v[26:27], v[26:27], v[42:43]
    v_pk_add_f32 v[28:29], v[28:29], v[44:45]
    v_pk_add_f32 v[30:31], v[30:31], v[46:47]
    s_waitcnt lgkmcnt(4)
    v_pk_add_f32 v[16:17], v[16:17], v[48:49]
    v_pk_add_f32 v[18:19], v[18:19], v[50:51]
    v_pk_add_f32 v[20:21], v[20:21], v[52:53]
    v_pk_add_f32 v[22:23], v[22:23], v[54:55]
    v_pk_add_f32 v[24:25], v[24:25], v[56:57]
    v_pk_add_f32 v[26:27], v[26:27], v[58:59]
    v_pk_add_f32 v[28:29], v[28:29], v[60:61]
    v_pk_add_f32 v[30:31], v[30:31], v[62:63]
    s_waitcnt lgkmcnt(0)
    v_pk_add_f32 v[16:17], v[16:17], v[64:65]
    v_pk_add_f32 v[18:19], v[18:19], v[66:67]
    v_pk_add_f32 v[20:21], v[20:21], v[68:69]
    v_pk_add_f32 v[22:23], v[22:23], v[70:71]
    v_pk_add_f32 v[24:25], v[24:25], v[72:73]
    v_pk_add_f32 v[26:27], v[26:27], v[74:75]
    v_pk_add_f32 v[28:29], v[28:29], v[76:77]
    v_pk_add_f32 v[30:31], v[30:31], v[78:79]
    v_cvt_pk_bf16_f32 v80, v16, v17
    v_cvt_pk_bf16_f32 v81, v18, v19
    v_cvt_pk_bf16_f32 v82, v20, v21
    v_cvt_pk_bf16_f32 v83, v22, v23
    buffer_store_dwordx4 v[80:83], v1, s[4:7], s9 offen
    v_cvt_pk_bf16_f32 v84, v24, v25
    v_cvt_pk_bf16_f32 v85, v26, v27
    v_cvt_pk_bf16_f32 v86, v28, v29
    v_cvt_pk_bf16_f32 v87, v30, v31
    buffer_store_dwordx4 v[84:87], v1, s[4:7], s9 offen offset:1024
    v_dot2_f32_bf16 v10, v80, v9, v10
    v_dot2_f32_bf16 v11, v80, v80, v11
    v_dot2_f32_bf16 v10, v81, v9, v10
    v_dot2_f32_bf16 v11, v81, v81, v11
    v_dot2_f32_bf16 v10, v82, v9, v10
    v_dot2_f32_bf16 v11, v82, v82, v11
    v_dot2_f32_bf16 v10, v83, v9, v10
    v_dot2_f32_bf16 v11, v83, v83, v11
    v_dot2_f32_bf16 v10, v84, v9, v10
    v_dot2_f32_bf16 v11, v84, v84, v11
    v_dot2_f32_bf16 v10, v85, v9, v10
    v_dot2_f32_bf16 v11, v85, v85, v11
    v_dot2_f32_bf16 v10, v86, v9, v10
    v_dot2_f32_bf16 v11, v86, v86, v11
    v_dot2_f32_bf16 v10, v87, v9, v10
    v_dot2_f32_bf16 v11, v87, v87, v11
    v_accvgpr_write_b32 a240, v80
    v_accvgpr_write_b32 a241, v81
    v_accvgpr_write_b32 a242, v82
    v_permlane32_swap_b32 v10, v11
    v_add_f32 v10, v10, v11
    buffer_store_dword v10, v12, s[4:7], s10 offen
    v_accvgpr_write_b32 a243, v83
    v_accvgpr_write_b32 a244, v84
    v_accvgpr_write_b32 a245, v85
    v_accvgpr_write_b32 a246, v86
    v_accvgpr_write_b32 a247, v87
    v_mov_b32 v255, 1
    s_cmp_lg_u32 s24, 0
    s_mov_b64 exec, 1
    s_waitcnt vmcnt(0)
    s_cbranch_scc1 L_pub_slow_24
    buffer_store_dword v255, off, s[4:7], s11 offset:0
L_pub_done_25:
    s_mov_b64 exec, -1
    s_mul_i32 s9, s32, 28672
    s_add_u32 s9, s9, 15683584
    v_add_u32 v252, s9, v1
    s_mul_i32 s9, s32, 3584
    s_add_u32 s9, s9, 17518592
    v_lshl_add_u32 v253, v0, 3, s9
    s_xor_b32 s9, s31, 1
    s_mul_i32 s9, s9, 114688
    s_mul_i32 s10, s8, 28672
    s_add_u32 s9, s9, s10
    s_add_u32 s9, s9, 11939840
    v_add_u32 v254, s9, v1
    ds_read_b128 v[192:195], v1 offset:0
    ds_read_b128 v[196:199], v1 offset:1024
    ds_read_b128 v[200:203], v1 offset:2048
    ds_read_b128 v[204:207], v1 offset:3072
    ds_read_b128 v[208:211], v1 offset:4096
    ds_read_b128 v[212:215], v1 offset:5120
    ds_read_b128 v[216:219], v1 offset:6144
    ds_read_b128 v[220:223], v1 offset:7168
    s_mov_b64 exec, 0x3fff
L_poll_26:
    buffer_load_dword v255, v3, s[4:7], s56 offen offset:0 sc1
    s_waitcnt vmcnt(0)
    v_cmp_eq_u32 vcc, 0, v255
    s_cbranch_vccz L_poll_done_27
    s_sub_u32 s25, s25, 1
    s_cmp_gt_i32 s25, 0
    s_cbranch_scc1 L_poll_26
    s_mov_b32 s25, 0
L_poll_done_27:
    s_mov_b64 exec, -1
    s_cmp_lg_u32 s24, 0
    s_cbranch_scc1 L_poll_slow_28
L_poll_ret_29:
    buffer_load_dwordx4 v[16:19], v252, s[4:7], 0 offen offset:0 sc1
    buffer_load_dwordx4 v[20:23], v252, s[4:7], 0 offen offset:1024 sc1
    buffer_load_dwordx4 v[24:27], v252, s[4:7], 0 offen offset:2048 sc1
    buffer_load_dwordx4 v[28:31], v252, s[4:7], 0 offen offset:3072 sc1
    buffer_load_dwordx4 v[32:35], v252, s[4:7], s42 offen offset:0 sc1
    s_waitcnt vmcnt(4) lgkmcnt(7)
    v_mfma_f32_32x32x16_bf16 v[128:143], v[192:195], v[16:19], 0
    buffer_load_dwordx4 v[36:39], v252, s[4:7], s42 offen offset:1024 sc1
    ds_read_b128 v[224:227], v1 offset:8192
    s_waitcnt lgkmcnt(7)
    v_mfma_f32_32x32x16_bf16 v[144:159], v[196:199], v[16:19], 0
    ds_read_b128 v[228:231], v1 offset:9216
    s_waitcnt lgkmcnt(7)
    v_mfma_f32_32x32x16_bf16 v[160:175], v[200:203], v[16:19], 0
    buffer_load_dwordx4 v[40:43], v252, s[4:7], s42 offen offset:2048 sc1
    ds_read_b128 v[232:235], v1 offset:10240
    s_waitcnt lgkmcnt(7)
    v_mfma_f32_32x32x16_bf16 v[176:191], v[204:207], v[16:19], 0
    ds_read_b128 v[236:239], v1 offset:11264
    s_waitcnt vmcnt(5) lgkmcnt(7)
    v_mfma_f32_32x32x16_bf16 v[128:143], v[208:211], v[20:23], v[128:143]
    buffer_load_dwordx4 v[44:47], v252, s[4:7], s42 offen offset:3072 sc1
    ds_read_b128 v[192:195], v1 offset:12288
    s_waitcnt lgkmcnt(7)
    v_mfma_f32_32x32x16_bf16 v[144:159], v[212:215], v[20:23], v[144:159]
    ds_read_b128 v[196:199], v1 offset:13312
    s_waitcnt lgkmcnt(7)
    v_mfma_f32_32x32x16_bf16 v[160:175], v[216:219], v[20:23], v[160:175]
    buffer_load_dwordx4 v[48:51], v252, s[4:7], s43 offen offset:0 sc1
    ds_read_b128 v[200:203], v1 offset:14336
    s_waitcnt lgkmcnt(7)
    v_mfma_f32_32x32x16_bf16 v[176:191], v[220:223], v[20:23], v[176:191]
    ds_read_b128 v[204:207], v1 offset:15360
    s_waitcnt vmcnt(6) lgkmcnt(7)
    v_mfma_f32_32x32x16_bf16 v[128:143], v[224:227], v[24:27], v[128:143]
    buffer_load_dwordx4 v[52:55], v252, s[4:7], s43 offen offset:1024 sc1
    ds_read_b128 v[208:211], v1 offset:16384
    s_waitcnt lgkmcnt(7)
    v_mfma_f32_32x32x16_bf16 v[144:159], v[228:231], v[24:27], v[144:159]
    buffer_load_dwordx2 v[8:9], v253, s[4:7], 0 offen offset:0 sc1
    ds_read_b128 v[212:215], v1 offset:17408
    s_waitcnt lgkmcnt(7)
    v_mfma_f32_32x32x16_bf16 v[160:175], v[232:235], v[24:27], v[160:175]
    buffer_load_dwordx4 v[56:59], v252, s[4:7], s43 offen offset:2048 sc1
    ds_read_b128 v[216:219], v1 offset:18432
    s_waitcnt lgkmcnt(7)
    v_mfma_f32_32x32x16_bf16 v[176:191], v[236:239], v[24:27], v[176:191]
    buffer_load_dwordx2 v[10:11], v253, s[4:7], 0 offen offset:512 sc1
    ds_read_b128 v[220:223], v1 offset:19456
    s_waitcnt vmcnt(9) lgkmcnt(7)
    v_mfma_f32_32x32x16_bf16 v[128:143], v[192:195], v[28:31], v[128:143]
    buffer_load_dwordx4 v[60:63], v252, s[4:7], s43 offen offset:3072 sc1
    ds_read_b128 v[224:227], v1 offset:20480
    s_waitcnt lgkmcnt(7)
    v_mfma_f32_32x32x16_bf16 v[144:159], v[196:199], v[28:31], v[144:159]
    buffer_load_dwordx2 v[12:13], v253, s[4:7], 0 offen offset:1024 sc1
    ds_read_b128 v[228:231], v1 offset:21504
    s_waitcnt lgkmcnt(7)
    v_mfma_f32_32x32x16_bf16 v[160:175], v[200:203], v[28:31], v[160:175]
    buffer_load_dwordx4 v[64:67], v252, s[4:7], s44 offen offset:0 sc1
    ds_read_b128 v[232:235], v1 offset:22528
    s_waitcnt lgkmcnt(7)
    v_mfma_f32_32x32x16_bf16 v[176:191], v[204:207], v[28:31], v[176:191]
    buffer_load_dwordx2 v[14:15], v253, s[4:7], 0 offen offset:1536 sc1
    ds_read_b128 v[236:239], v1 offset:23552
    s_waitcnt vmcnt(12) lgkmcnt(7)
    v_mfma_f32_32x32x16_bf16 v[128:143], v[208:211], v[32:35], v[128:143]
    buffer_load_dwordx4 v[68:71], v252, s[4:7], s44 offen offset:1024 sc1
    ds_read_b128 v[192:195], v1 offset:24576
    s_waitcnt lgkmcnt(7)
    v_mfma_f32_32x32x16_bf16 v[144:159], v[212:215], v[32:35], v[144:159]
    buffer_load_dwordx2 v[246:247], v253, s[4:7], 0 offen offset:2048 sc1
    ds_read_b128 v[196:199], v1 offset:25600
    s_waitcnt lgkmcnt(7)
    v_mfma_f32_32x32x16_bf16 v[160:175], v[216:219], v[32:35], v[160:175]
    buffer_load_dwordx4 v[72:75], v252, s[4:7], s44 offen offset:2048 sc1
    ds_read_b128 v[200:203], v1 offset:26624
    s_waitcnt lgkmcnt(7)
    v_mfma_f32_32x32x16_bf16 v[176:191], v[220:223], v[32:35], v[176:191]
    buffer_load_dwordx2 v[248:249], v253, s[4:7], 0 offen offset:2560 sc1
    ds_read_b128 v[204:207], v1 offset:27648
    s_waitcnt vmcnt(15) lgkmcnt(7)
    v_mfma_f32_32x32x16_bf16 v[128:143], v[224:227], v[36:39], v[128:143]
    buffer_load_dwordx4 v[76:79], v252, s[4:7], s44 offen offset:3072 sc1
    ds_read_b128 v[208:211], v1 offset:28672
    s_waitcnt lgkmcnt(7)
    v_mfma_f32_32x32x16_bf16 v[144:159], v[228:231], v[36:39], v[144:159]
    buffer_load_dwordx2 v[250:251], v253, s[4:7], 0 offen offset:3072 sc1
    ds_read_b128 v[212:215], v1 offset:29696
    s_waitcnt lgkmcnt(7)
    v_mfma_f32_32x32x16_bf16 v[160:175], v[232:235], v[36:39], v[160:175]
    buffer_load_dwordx4 v[80:83], v252, s[4:7], s45 offen offset:0 sc1
    ds_read_b128 v[216:219], v1 offset:30720
    s_waitcnt lgkmcnt(7)
    v_mfma_f32_32x32x16_bf16 v[176:191], v[236:239], v[36:39], v[176:191]
    ds_read_b128 v[220:223], v1 offset:31744
    s_waitcnt vmcnt(17) lgkmcnt(7)
    v_mfma_f32_32x32x16_bf16 v[128:143], v[192:195], v[40:43], v[128:143]
    buffer_load_dwordx4 v[84:87], v252, s[4:7], s45 offen offset:1024 sc1
    ds_read_b128 v[224:227], v1 offset:32768
    s_waitcnt lgkmcnt(7)
    v_mfma_f32_32x32x16_bf16 v[144:159], v[196:199], v[40:43], v[144:159]
    ds_read_b128 v[228:231], v1 offset:33792
    s_waitcnt lgkmcnt(7)
    v_mfma_f32_32x32x16_bf16 v[160:175], v[200:203], v[40:43], v[160:175]
    buffer_load_dwordx4 v[88:91], v252, s[4:7], s45 offen offset:2048 sc1
    ds_read_b128 v[232:235], v1 offset:34816
    s_waitcnt lgkmcnt(7)
    v_mfma_f32_32x32x16_bf16 v[176:191], v[204:207], v[40:43], v[176:191]
    ds_read_b128 v[236:239], v1 offset:35840
    s_waitcnt vmcnt(18) lgkmcnt(7)
    v_mfma_f32_32x32x16_bf16 v[128:143], v[208:211], v[44:47], v[128:143]
    buffer_load_dwordx4 v[92:95], v252, s[4:7], s45 offen offset:3072 sc1
    ds_read_b128 v[192:195], v1 offset:36864
    s_waitcnt lgkmcnt(7)
    v_mfma_f32_32x32x16_bf16 v[144:159], v[212:215], v[44:47], v[144:159]
    ds_read_b128 v[196:199], v1 offset:37888
    s_waitcnt lgkmcnt(7)
    v_mfma_f32_32x32x16_bf16 v[160:175], v[216:219], v[44:47], v[160:175]
    buffer_load_dwordx4 v[96:99], v252, s[4:7], s46 offen offset:0 sc1
    ds_read_b128 v[200:203], v1 offset:38912
    s_waitcnt lgkmcnt(7)
    v_mfma_f32_32x32x16_bf16 v[176:191], v[220:223], v[44:47], v[176:191]
    ds_read_b128 v[204:207], v1 offset:39936
    s_waitcnt vmcnt(19) lgkmcnt(7)
    v_mfma_f32_32x32x16_bf16 v[128:143], v[224:227], v[48:51], v[128:143]
    buffer_load_dwordx4 v[100:103], v252, s[4:7], s46 offen offset:1024 sc1
    ds_read_b128 v[208:211], v1 offset:40960
    s_waitcnt lgkmcnt(7)
    v_mfma_f32_32x32x16_bf16 v[144:159], v[228:231], v[48:51], v[144:159]
    ds_read_b128 v[212:215], v1 offset:41984
    s_waitcnt lgkmcnt(7)
    v_mfma_f32_32x32x16_bf16 v[160:175], v[232:235], v[48:51], v[160:175]
    buffer_load_dwordx4 v[104:107], v252, s[4:7], s46 offen offset:2048 sc1
    ds_read_b128 v[216:219], v1 offset:43008
    s_waitcnt lgkmcnt(7)
    v_mfma_f32_32x32x16_bf16 v[176:191], v[236:239], v[48:51], v[176:191]
    ds_read_b128 v[220:223], v1 offset:44032
    s_waitcnt vmcnt(20) lgkmcnt(7)
    v_mfma_f32_32x32x16_bf16 v[128:143], v[192:195], v[52:55], v[128:143]
    buffer_load_dwordx4 v[108:111], v252, s[4:7], s46 offen offset:3072 sc1
    ds_read_b128 v[224:227], v1 offset:45056
    s_waitcnt lgkmcnt(7)
    v_mfma_f32_32x32x16_bf16 v[144:159], v[196:199], v[52:55], v[144:159]
    ds_read_b128 v[228:231], v1 offset:46080
    s_waitcnt lgkmcnt(7)
    v_mfma_f32_32x32x16_bf16 v[160:175], v[200:203], v[52:55], v[160:175]
    buffer_load_dwordx4 v[112:115], v252, s[4:7], s47 offen offset:0 sc1
    ds_read_b128 v[232:235], v1 offset:47104
    s_waitcnt lgkmcnt(7)
    v_mfma_f32_32x32x16_bf16 v[176:191], v[204:207], v[52:55], v[176:191]
    ds_read_b128 v[236:239], v1 offset:48128
    s_waitcnt vmcnt(20) lgkmcnt(7)
    v_mfma_f32_32x32x16_bf16 v[128:143], v[208:211], v[56:59], v[128:143]
    buffer_load_dwordx4 v[116:119], v252, s[4:7], s47 offen offset:1024 sc1
    ds_read_b128 v[192:195], v1 offset:49152
    s_waitcnt lgkmcnt(7)
    v_mfma_f32_32x32x16_bf16 v[144:159], v[212:215], v[56:59], v[144:159]
    s_waitcnt vmcnt(10)
    v_add_f32 v8, v8, v9
    ds_read_b128 v[196:199], v1 offset:50176
    s_waitcnt lgkmcnt(7)
    v_mfma_f32_32x32x16_bf16 v[160:175], v[216:219], v[56:59], v[160:175]
    buffer_load_dwordx4 v[120:123], v252, s[4:7], s47 offen offset:2048 sc1
    ds_read_b128 v[200:203], v1 offset:51200
    s_waitcnt lgkmcnt(7)
    v_mfma_f32_32x32x16_bf16 v[176:191], v[220:223], v[56:59], v[176:191]
    v_add_f32 v10, v10, v11
    v_add_f32 v12, v12, v13
    ds_read_b128 v[204:207], v1 offset:52224
    s_waitcnt lgkmcnt(7)
    v_mfma_f32_32x32x16_bf16 v[128:143], v[224:227], v[60:63], v[128:143]
    buffer_load_dwordx4 v[124:127], v252, s[4:7], s47 offen offset:3072 sc1
    ds_read_b128 v[208:211], v1 offset:53248
    s_waitcnt lgkmcnt(7)
    v_mfma_f32_32x32x16_bf16 v[144:159], v[228:231], v[60:63], v[144:159]
    v_add_f32 v14, v14, v15
    v_add_f32 v246, v246, v247
    ds_read_b128 v[212:215], v1 offset:54272
    s_waitcnt lgkmcnt(7)
    v_mfma_f32_32x32x16_bf16 v[160:175], v[232:235], v[60:63], v[160:175]
    v_lshlrev_b32 v245, 7, v0
    ds_read_b128 v[216:219], v1 offset:55296
    s_waitcnt lgkmcnt(7)
    v_mfma_f32_32x32x16_bf16 v[176:191], v[236:239], v[60:63], v[176:191]
    v_add_f32 v248, v248, v249
    v_add_f32 v250, v250, v251
    ds_read_b128 v[220:223], v1 offset:56320
    s_waitcnt lgkmcnt(7)
    v_mfma_f32_32x32x16_bf16 v[128:143], v[192:195], v[64:67], v[128:143]
    v_and_b32 v245, 0x780, v245
    s_add_u32 s10, s53, 13619200
    buffer_load_dword v253, v245, s[4:7], s10 offen
    ds_read_b128 v[224:227], v1 offset:57344
    s_waitcnt lgkmcnt(7)
    v_mfma_f32_32x32x16_bf16 v[144:159], v[196:199], v[64:67], v[144:159]
    v_add_f32 v8, v8, v10
    v_add_f32 v12, v12, v14
    ds_read_b128 v[228:231], v1 offset:58368
    s_waitcnt lgkmcnt(7)
    v_mfma_f32_32x32x16_bf16 v[160:175], v[200:203], v[64:67], v[160:175]
    v_and_b32 v245, 0x180, v245
    s_add_u32 s10, s54, 15454208
    buffer_load_dword v253, v245, s[4:7], s10 offen
    ds_read_b128 v[232:235], v1 offset:59392
    s_waitcnt lgkmcnt(7)
    v_mfma_f32_32x32x16_bf16 v[176:191], v[204:207], v[64:67], v[176:191]
    v_add_f32 v246, v246, v248
    v_add_f32 v8, v8, v12
    ds_read_b128 v[236:239], v1 offset:60416
    s_waitcnt lgkmcnt(7)
    v_mfma_f32_32x32x16_bf16 v[128:143], v[208:211], v[68:71], v[128:143]
    buffer_load_dwordx4 a[112:115], v254, s[4:7], 0 offen offset:0 sc1
    ds_read_b128 v[192:195], v1 offset:61440
    s_waitcnt lgkmcnt(7)
    v_mfma_f32_32x32x16_bf16 v[144:159], v[212:215], v[68:71], v[144:159]
    v_add_f32 v246, v246, v250
    v_add_f32 v8, v8, v246
    ds_read_b128 v[196:199], v1 offset:62464
    s_waitcnt lgkmcnt(7)
    v_mfma_f32_32x32x16_bf16 v[160:175], v[216:219], v[68:71], v[160:175]
    buffer_load_dwordx4 a[116:119], v254, s[4:7], 0 offen offset:1024 sc1
    ds_read_b128 v[200:203], v1 offset:63488
    s_waitcnt lgkmcnt(7)
    v_mfma_f32_32x32x16_bf16 v[176:191], v[220:223], v[68:71], v[176:191]
    v_mul_f32 v8, 0x3b124925, v8
    v_mov_b32 v9, v8
    s_nop 1
    ds_read_b128 v[204:207], v1 offset:64512
    s_waitcnt lgkmcnt(7)
    v_mfma_f32_32x32x16_bf16 v[128:143], v[224:227], v[72:75], v[128:143]
    buffer_load_dwordx4 a[120:123], v254, s[4:7], 0 offen offset:2048 sc1
    ds_read_b128 v[208:211], v2 offset:0
    s_waitcnt lgkmcnt(7)
    v_mfma_f32_32x32x16_bf16 v[144:159], v[228:231], v[72:75], v[144:159]
    v_permlane32_swap_b32 v8, v9
    v_fma_f32 v10, -v8, v8, v9
    ds_read_b128 v[212:215], v2 offset:1024
    s_waitcnt lgkmcnt(7)
    v_mfma_f32_32x32x16_bf16 v[160:175], v[232:235], v[72:75], v[160:175]
    buffer_load_dwordx4 a[124:127], v254, s[4:7], 0 offen offset:3072 sc1
    ds_read_b128 v[216:219], v2 offset:2048
    s_waitcnt lgkmcnt(7)
    v_mfma_f32_32x32x16_bf16 v[176:191], v[236:239], v[72:75], v[176:191]
    v_max_f32 v10, 0, v10
    v_add_f32 v10, 0x3727c5ac, v10
    ds_read_b128 v[220:223], v2 offset:3072
    s_waitcnt lgkmcnt(7)
    v_mfma_f32_32x32x16_bf16 v[128:143], v[192:195], v[76:79], v[128:143]
    buffer_load_dwordx4 a[128:131], v254, s[4:7], s42 offen offset:0 sc1
    ds_read_b128 v[224:227], v2 offset:4096
    s_waitcnt lgkmcnt(7)
    v_mfma_f32_32x32x16_bf16 v[144:159], v[196:199], v[76:79], v[144:159]
    v_rsq_f32 v244, v10
    v_cvt_pk_bf16_f32 v240, -v8, -v8
    ds_read_b128 v[228:231], v2 offset:5120
    s_waitcnt lgkmcnt(7)
    v_mfma_f32_32x32x16_bf16 v[160:175], v[200:203], v[76:79], v[160:175]
    buffer_load_dwordx4 a[132:135], v254, s[4:7], s42 offen offset:1024 sc1
    ds_read_b128 v[232:235], v2 offset:6144
    s_waitcnt lgkmcnt(7)
    v_mfma_f32_32x32x16_bf16 v[176:191], v[204:207], v[76:79], v[176:191]
    v_mul_f32 v10, v10, v244
    v_lshlrev_b32 v11, 16, v240
    ds_read_b128 v[236:239], v2 offset:7168
    s_waitcnt vmcnt(19) lgkmcnt(7)
    v_mfma_f32_32x32x16_bf16 v[128:143], v[208:211], v[80:83], v[128:143]
    buffer_load_dwordx4 a[136:139], v254, s[4:7], s42 offen offset:2048 sc1
    ds_read_b128 v[192:195], v2 offset:8192
    s_waitcnt lgkmcnt(7)
    v_mfma_f32_32x32x16_bf16 v[144:159], v[212:215], v[80:83], v[144:159]
    v_add_f32 v11, v8, v11
    v_cvt_pk_bf16_f32 v241, -v11, -v11
    ds_read_b128 v[196:199], v2 offset:9216
    s_waitcnt lgkmcnt(7)
    v_mfma_f32_32x32x16_bf16 v[160:175], v[216:219], v[80:83], v[160:175]
    buffer_load_dwordx4 a[140:143], v254, s[4:7], s42 offen offset:3072 sc1
    ds_read_b128 v[200:203], v2 offset:10240
    s_waitcnt lgkmcnt(7)
    v_mfma_f32_32x32x16_bf16 v[176:191], v[220:223], v[80:83], v[176:191]
    v_cvt_pk_bf16_f32 v12, v10, v10
    v_lshlrev_b32 v12, 16, v12
    ds_read_b128 v[204:207], v2 offset:11264
    s_waitcnt vmcnt(20) lgkmcnt(7)
    v_mfma_f32_32x32x16_bf16 v[128:143], v[224:227], v[84:87], v[128:143]
    buffer_load_dwordx4 a[144:147], v254, s[4:7], s43 offen offset:0 sc1
    ds_read_b128 v[208:211], v2 offset:12288
    s_waitcnt lgkmcnt(7)
    v_mfma_f32_32x32x16_bf16 v[144:159], v[228:231], v[84:87], v[144:159]
    v_sub_f32 v12, v10, v12
    v_cvt_pk_bf16_f32 v242, v10, v12
    ds_read_b128 v[212:215], v2 offset:13312
    s_waitcnt lgkmcnt(7)
    v_mfma_f32_32x32x16_bf16 v[160:175], v[232:235], v[84:87], v[160:175]
    buffer_load_dwordx4 a[148:151], v254, s[4:7], s43 offen offset:1024 sc1
    ds_read_b128 v[216:219], v2 offset:14336
    s_waitcnt lgkmcnt(7)
    v_mfma_f32_32x32x16_bf16 v[176:191], v[236:239], v[84:87], v[176:191]
    v_mov_b32 v243, 0
    ds_read_b128 v[220:223], v2 offset:15360
    s_waitcnt vmcnt(21) lgkmcnt(7)
    v_mfma_f32_32x32x16_bf16 v[128:143], v[192:195], v[88:91], v[128:143]
    buffer_load_dwordx4 a[152:155], v254, s[4:7], s43 offen offset:2048 sc1
    ds_read_b128 v[224:227], v2 offset:16384
    s_waitcnt lgkmcnt(7)
    v_mfma_f32_32x32x16_bf16 v[144:159], v[196:199], v[88:91], v[144:159]
    ds_read_b128 v[228:231], v2 offset:20480
    s_waitcnt lgkmcnt(7)
    v_mfma_f32_32x32x16_bf16 v[160:175], v[200:203], v[88:91], v[160:175]
    buffer_load_dwordx4 a[156:159], v254, s[4:7], s43 offen offset:3072 sc1
    ds_read_b128 v[232:235], v2 offset:24576
    s_waitcnt lgkmcnt(7)
    v_mfma_f32_32x32x16_bf16 v[176:191], v[204:207], v[88:91], v[176:191]
    ds_read_b128 v[236:239], v2 offset:28672
    s_waitcnt vmcnt(22) lgkmcnt(7)
    v_mfma_f32_32x32x16_bf16 v[128:143], v[208:211], v[92:95], v[128:143]
    buffer_load_dwordx4 a[160:163], v254, s[4:7], s44 offen offset:0 sc1
    ds_read_b128 v[192:195], v2 offset:32768
    s_waitcnt lgkmcnt(7)
    v_mfma_f32_32x32x16_bf16 v[144:159], v[212:215], v[92:95], v[144:159]
    ds_read_b128 v[196:199], v2 offset:36864
    s_waitcnt lgkmcnt(7)
    v_mfma_f32_32x32x16_bf16 v[160:175], v[216:219], v[92:95], v[160:175]
    buffer_load_dwordx4 a[164:167], v254, s[4:7], s44 offen offset:1024 sc1
    ds_read_b128 v[200:203], v2 offset:40960
    s_waitcnt lgkmcnt(7)
    v_mfma_f32_32x32x16_bf16 v[176:191], v[220:223], v[92:95], v[176:191]
    ds_read_b128 v[204:207], v2 offset:45056
    s_add_u32 s9, s57, 4096
    s_waitcnt vmcnt(23) lgkmcnt(7)
    v_mfma_f32_32x32x16_bf16 v[128:143], v[224:227], v[96:99], v[128:143]
    buffer_load_dwordx4 a[168:171], v254, s[4:7], s44 offen offset:2048 sc1
    ds_read_b128 v[208:211], v2 offset:17408
    s_waitcnt vmcnt(23) lgkmcnt(7)
    v_mfma_f32_32x32x16_bf16 v[128:143], v[228:231], v[100:103], v[128:143]
    ds_read_b128 v[212:215], v2 offset:21504
    s_waitcnt vmcnt(22) lgkmcnt(7)
    v_mfma_f32_32x32x16_bf16 v[128:143], v[232:235], v[104:107], v[128:143]
    buffer_load_dwordx4 a[172:175], v254, s[4:7], s44 offen offset:3072 sc1
    ds_read_b128 v[216:219], v2 offset:25600
    s_waitcnt vmcnt(22) lgkmcnt(7)
    v_mfma_f32_32x32x16_bf16 v[128:143], v[236:239], v[108:111], v[128:143]
    ds_read_b128 v[220:223], v2 offset:29696
    s_waitcnt vmcnt(21) lgkmcnt(7)
    v_mfma_f32_32x32x16_bf16 v[128:143], v[192:195], v[112:115], v[128:143]
    buffer_load_dwordx4 a[176:179], v254, s[4:7], s45 offen offset:0 sc1
    ds_read_b128 v[224:227], v2 offset:33792
    s_waitcnt vmcnt(21) lgkmcnt(7)
    v_mfma_f32_32x32x16_bf16 v[128:143], v[196:199], v[116:119], v[128:143]
    ds_read_b128 v[228:231], v2 offset:37888
    s_waitcnt vmcnt(20) lgkmcnt(7)
    v_mfma_f32_32x32x16_bf16 v[128:143], v[200:203], v[120:123], v[128:143]
    buffer_load_dwordx4 a[180:183], v254, s[4:7], s45 offen offset:1024 sc1
    ds_read_b128 v[232:235], v2 offset:41984
    s_waitcnt vmcnt(20) lgkmcnt(7)
    v_mfma_f32_32x32x16_bf16 v[128:143], v[204:207], v[124:127], v[128:143]
    ds_read_b128 v[236:239], v2 offset:46080
    v_mfma_f32_32x32x16_bf16 v[128:143], a[224:227], v[240:243], v[128:143]
    buffer_load_dwordx4 a[184:187], v254, s[4:7], s45 offen offset:2048 sc1
    s_waitcnt lgkmcnt(7)
    v_mfma_f32_32x32x16_bf16 v[144:159], v[208:211], v[96:99], v[144:159]
    s_nop 3
    ds_read_b128 v[192:195], v2 offset:18432
    s_waitcnt lgkmcnt(7)
    v_mfma_f32_32x32x16_bf16 v[144:159], v[212:215], v[100:103], v[144:159]
    buffer_load_dwordx4 a[188:191], v254, s[4:7], s45 offen offset:3072 sc1
    s_nop 2
    ds_read_b128 v[196:199], v2 offset:22528
    s_waitcnt lgkmcnt(7)
    v_mfma_f32_32x32x16_bf16 v[144:159], v[216:219], v[104:107], v[144:159]
    v_max_f32 v128, 0, v128
    v_max_f32 v129, 0, v129
    v_max_f32 v130, 0, v130
    v_max_f32 v131, 0, v131
    v_max_f32 v132, 0, v132
    v_max_f32 v133, 0, v133
    ds_read_b128 v[200:203], v2 offset:26624
    s_waitcnt lgkmcnt(7)
    v_mfma_f32_32x32x16_bf16 v[144:159], v[220:223], v[108:111], v[144:159]
    buffer_load_dwordx4 a[192:195], v254, s[4:7], s46 offen offset:0 sc1
    v_max_f32 v134, 0, v134
    v_max_f32 v135, 0, v135
    v_max_f32 v136, 0, v136
    v_max_f32 v137, 0, v137
    v_max_f32 v138, 0, v138
    v_max_f32 v139, 0, v139
    ds_read_b128 v[204:207], v2 offset:30720
    s_waitcnt lgkmcnt(7)
    v_mfma_f32_32x32x16_bf16 v[144:159], v[224:227], v[112:115], v[144:159]
    v_max_f32 v140, 0, v140
    v_max_f32 v141, 0, v141
    v_max_f32 v142, 0, v142
    v_max_f32 v143, 0, v143
    v_mul_f32 v128, v128, v244
    v_mul_f32 v129, v129, v244
    ds_read_b128 v[208:211], v2 offset:34816
    s_waitcnt lgkmcnt(7)
    v_mfma_f32_32x32x16_bf16 v[144:159], v[228:231], v[116:119], v[144:159]
    buffer_load_dwordx4 a[196:199], v254, s[4:7], s46 offen offset:1024 sc1
    v_mul_f32 v130, v130, v244
    v_mul_f32 v131, v131, v244
    v_mul_f32 v132, v132, v244
    v_mul_f32 v133, v133, v244
    v_mul_f32 v134, v134, v244
    v_mul_f32 v135, v135, v244
    ds_read_b128 v[212:215], v2 offset:38912
    s_waitcnt lgkmcnt(7)
    v_mfma_f32_32x32x16_bf16 v[144:159], v[232:235], v[120:123], v[144:159]
    v_mul_f32 v136, v136, v244
    v_mul_f32 v137, v137, v244
    v_mul_f32 v138, v138, v244
    v_mul_f32 v139, v139, v244
    v_mul_f32 v140, v140, v244
    v_mul_f32 v141, v141, v244
    ds_read_b128 v[216:219], v2 offset:43008
    s_waitcnt lgkmcnt(7)
    v_mfma_f32_32x32x16_bf16 v[144:159], v[236:239], v[124:127], v[144:159]
    buffer_load_dwordx4 a[200:203], v254, s[4:7], s46 offen offset:2048 sc1
    v_mul_f32 v142, v142, v244
    v_mul_f32 v143, v143, v244
    v_mul_f32 v128, v128, v128
    v_mul_f32 v129, v129, v129
    v_mul_f32 v130, v130, v130
    v_mul_f32 v131, v131, v131
    ds_read_b128 v[220:223], v2 offset:47104
    v_mfma_f32_32x32x16_bf16 v[144:159], a[228:231], v[240:243], v[144:159]
    v_mul_f32 v132, v132, v132
    v_mul_f32 v133, v133, v133
    v_mul_f32 v134, v134, v134
    v_mul_f32 v135, v135, v135
    v_mul_f32 v136, v136, v136
    v_mul_f32 v137, v137, v137
    s_waitcnt lgkmcnt(7)
    v_mfma_f32_32x32x16_bf16 v[160:175], v[192:195], v[96:99], v[160:175]
    buffer_load_dwordx4 a[204:207], v254, s[4:7], s46 offen offset:3072 sc1
    s_nop 3
    ds_read_b128 v[224:227], v2 offset:19456
    s_waitcnt lgkmcnt(7)
    v_mfma_f32_32x32x16_bf16 v[160:175], v[196:199], v[100:103], v[160:175]
    s_nop 2
    ds_read_b128 v[228:231], v2 offset:23552
    s_waitcnt lgkmcnt(7)
    v_mfma_f32_32x32x16_bf16 v[160:175], v[200:203], v[104:107], v[160:175]
    buffer_load_dwordx4 a[208:211], v254, s[4:7], s47 offen offset:0 sc1
    v_mul_f32 v138, v138, v138
    v_mul_f32 v139, v139, v139
    v_mul_f32 v140, v140, v140
    v_mul_f32 v141, v141, v141
    v_mul_f32 v142, v142, v142
    v_mul_f32 v143, v143, v143
    ds_read_b128 v[232:235], v2 offset:27648
    s_waitcnt lgkmcnt(7)
    v_mfma_f32_32x32x16_bf16 v[160:175], v[204:207], v[108:111], v[160:175]
    v_cvt_pk_bf16_f32 v16, v128, v129
    v_cvt_pk_bf16_f32 v17, v130, v131
    v_cvt_pk_bf16_f32 v18, v132, v133
    v_cvt_pk_bf16_f32 v19, v134, v135
    buffer_store_dwordx4 v[16:19], v1, s[4:7], s57 offen offset:0 sc1
    v_cvt_pk_bf16_f32 v20, v136, v137
    ds_read_b128 v[236:239], v2 offset:31744
    s_waitcnt lgkmcnt(7)
    v_mfma_f32_32x32x16_bf16 v[160:175], v[208:211], v[112:115], v[160:175]
    buffer_load_dwordx4 a[212:215], v254, s[4:7], s47 offen offset:1024 sc1
    v_cvt_pk_bf16_f32 v21, v138, v139
    v_cvt_pk_bf16_f32 v22, v140, v141
    v_cvt_pk_bf16_f32 v23, v142, v143
    buffer_store_dwordx4 v[20:23], v1, s[4:7], s57 offen offset:1024 sc1
    v_max_f32 v144, 0, v144
    v_max_f32 v145, 0, v145
    ds_read_b128 v[192:195], v2 offset:35840
    s_waitcnt lgkmcnt(7)
    v_mfma_f32_32x32x16_bf16 v[160:175], v[212:215], v[116:119], v[160:175]
    v_max_f32 v146, 0, v146
    v_max_f32 v147, 0, v147
    v_max_f32 v148, 0, v148
    v_max_f32 v149, 0, v149
    v_max_f32 v150, 0, v150
    v_max_f32 v151, 0, v151
    ds_read_b128 v[196:199], v2 offset:39936
    s_waitcnt lgkmcnt(7)
    v_mfma_f32_32x32x16_bf16 v[160:175], v[216:219], v[120:123], v[160:175]
    buffer_load_dwordx4 a[216:219], v254, s[4:7], s47 offen offset:2048 sc1
    v_max_f32 v152, 0, v152
    v_max_f32 v153, 0, v153
    v_max_f32 v154, 0, v154
    v_max_f32 v155, 0, v155
    v_max_f32 v156, 0, v156
    v_max_f32 v157, 0, v157
    ds_read_b128 v[200:203], v2 offset:44032
    s_waitcnt lgkmcnt(7)
    v_mfma_f32_32x32x16_bf16 v[160:175], v[220:223], v[124:127], v[160:175]
    v_max_f32 v158, 0, v158
    v_max_f32 v159, 0, v159
    v_mul_f32 v144, v144, v244
    v_mul_f32 v145, v145, v244
    v_mul_f32 v146, v146, v244
    v_mul_f32 v147, v147, v244
    ds_read_b128 v[204:207], v2 offset:48128
    v_mfma_f32_32x32x16_bf16 v[160:175], a[232:235], v[240:243], v[160:175]
    buffer_load_dwordx4 a[220:223], v254, s[4:7], s47 offen offset:3072 sc1
    v_mul_f32 v148, v148, v244
    v_mul_f32 v149, v149, v244
    v_mul_f32 v150, v150, v244
    v_mul_f32 v151, v151, v244
    v_mul_f32 v152, v152, v244
    v_mul_f32 v153, v153, v244
    s_waitcnt lgkmcnt(7)
    v_mfma_f32_32x32x16_bf16 v[176:191], v[224:227], v[96:99], v[176:191]
    s_nop 3
    s_waitcnt lgkmcnt(6)
    v_mfma_f32_32x32x16_bf16 v[176:191], v[228:231], v[100:103], v[176:191]
    s_nop 2
    s_waitcnt lgkmcnt(5)
    v_mfma_f32_32x32x16_bf16 v[176:191], v[232:235], v[104:107], v[176:191]
    v_mul_f32 v154, v154, v244
    v_mul_f32 v155, v155, v244
    v_mul_f32 v156, v156, v244
    v_mul_f32 v157, v157, v244
    v_mul_f32 v158, v158, v244
    v_mul_f32 v159, v159, v244
    s_waitcnt lgkmcnt(4)
    v_mfma_f32_32x32x16_bf16 v[176:191], v[236:239], v[108:111], v[176:191]
    v_mul_f32 v144, v144, v144
    v_mul_f32 v145, v145, v145
    v_mul_f32 v146, v146, v146
    v_mul_f32 v147, v147, v147
    v_mul_f32 v148, v148, v148
    v_mul_f32 v149, v149, v149
    s_waitcnt lgkmcnt(3)
    v_mfma_f32_32x32x16_bf16 v[176:191], v[192:195], v[112:115], v[176:191]
    v_mul_f32 v150, v150, v150
    v_mul_f32 v151, v151, v151
    v_mul_f32 v152, v152, v152
    v_mul_f32 v153, v153, v153
    v_mul_f32 v154, v154, v154
    v_mul_f32 v155, v155, v155
    s_waitcnt lgkmcnt(2)
    v_mfma_f32_32x32x16_bf16 v[176:191], v[196:199], v[116:119], v[176:191]
    v_mul_f32 v156, v156, v156
    v_mul_f32 v157, v157, v157
    v_mul_f32 v158, v158, v158
    v_mul_f32 v159, v159, v159
    v_cvt_pk_bf16_f32 v24, v144, v145
    v_cvt_pk_bf16_f32 v25, v146, v147
    s_waitcnt lgkmcnt(1)
    v_mfma_f32_32x32x16_bf16 v[176:191], v[200:203], v[120:123], v[176:191]
    v_cvt_pk_bf16_f32 v26, v148, v149
    v_cvt_pk_bf16_f32 v27, v150, v151
    buffer_store_dwordx4 v[24:27], v1, s[4:7], s57 offen offset:2048 sc1
    v_cvt_pk_bf16_f32 v28, v152, v153
    v_cvt_pk_bf16_f32 v29, v154, v155
    v_cvt_pk_bf16_f32 v30, v156, v157
    s_waitcnt lgkmcnt(0)
    v_mfma_f32_32x32x16_bf16 v[176:191], v[204:207], v[124:127], v[176:191]
    v_cvt_pk_bf16_f32 v31, v158, v159
    buffer_store_dwordx4 v[28:31], v1, s[4:7], s57 offen offset:3072 sc1
    v_max_f32 v160, 0, v160
    v_max_f32 v161, 0, v161
    v_max_f32 v162, 0, v162
    v_max_f32 v163, 0, v163
    v_mfma_f32_32x32x16_bf16 v[176:191], a[236:239], v[240:243], v[176:191]
    v_max_f32 v164, 0, v164
    v_max_f32 v165, 0, v165
    v_max_f32 v166, 0, v166
    v_max_f32 v167, 0, v167
    v_max_f32 v168, 0, v168
    v_max_f32 v169, 0, v169
    v_max_f32 v170, 0, v170
    v_max_f32 v171, 0, v171
    v_max_f32 v172, 0, v172
    v_max_f32 v173, 0, v173
    v_max_f32 v174, 0, v174
    v_max_f32 v175, 0, v175
    v_mul_f32 v160, v160, v244
    v_mul_f32 v161, v161, v244
    v_mul_f32 v162, v162, v244
    v_mul_f32 v163, v163, v244
    v_mul_f32 v164, v164, v244
    v_mul_f32 v165, v165, v244
    v_mul_f32 v166, v166, v244
    v_mul_f32 v167, v167, v244
    v_mul_f32 v168, v168, v244
    v_mul_f32 v169, v169, v244
    v_mul_f32 v170, v170, v244
    v_mul_f32 v171, v171, v244
    v_mul_f32 v172, v172, v244
    v_mul_f32 v173, v173, v244
    v_mul_f32 v174, v174, v244
    v_mul_f32 v175, v175, v244
    v_mul_f32 v160, v160, v160
    v_mul_f32 v161, v161, v161
    v_mul_f32 v162, v162, v162
    v_mul_f32 v163, v163, v163
    v_mul_f32 v164, v164, v164
    v_mul_f32 v165, v165, v165
    v_mul_f32 v166, v166, v166
    v_mul_f32 v167, v167, v167
    v_mul_f32 v168, v168, v168
    v_mul_f32 v169, v169, v169
    v_mul_f32 v170, v170, v170
    v_mul_f32 v171, v171, v171
    v_mul_f32 v172, v172, v172
    v_mul_f32 v173, v173, v173
    v_mul_f32 v174, v174, v174
    v_mul_f32 v175, v175, v175
    v_cvt_pk_bf16_f32 v32, v160, v161
    v_cvt_pk_bf16_f32 v33, v162, v163
    v_cvt_pk_bf16_f32 v34, v164, v165
    v_cvt_pk_bf16_f32 v35, v166, v167
    buffer_store_dwordx4 v[32:35], v1, s[4:7], s9 offen offset:0 sc1
    v_cvt_pk_bf16_f32 v36, v168, v169
    v_cvt_pk_bf16_f32 v37, v170, v171
    v_cvt_pk_bf16_f32 v38, v172, v173
    v_cvt_pk_bf16_f32 v39, v174, v175
    buffer_store_dwordx4 v[36:39], v1, s[4:7], s9 offen offset:1024 sc1
    v_max_f32 v176, 0, v176
    v_max_f32 v177, 0, v177
    v_max_f32 v178, 0, v178
    v_max_f32 v179, 0, v179
    v_max_f32 v180, 0, v180
    v_max_f32 v181, 0, v181
    v_max_f32 v182, 0, v182
    v_max_f32 v183, 0, v183
    v_max_f32 v184, 0, v184
    v_max_f32 v185, 0, v185
    v_max_f32 v186, 0, v186
    v_max_f32 v187, 0, v187
    v_max_f32 v188, 0, v188
    v_max_f32 v189, 0, v189
    v_max_f32 v190, 0, v190
    v_max_f32 v191, 0, v191
    v_pk_mul_f32 v[176:177], v[176:177], v[244:245] op_sel_hi:[1,0]
    v_pk_mul_f32 v[178:179], v[178:179], v[244:245] op_sel_hi:[1,0]
    v_pk_mul_f32 v[180:181], v[180:181], v[244:245] op_sel_hi:[1,0]
    v_pk_mul_f32 v[182:183], v[182:183], v[244:245] op_sel_hi:[1,0]
    v_pk_mul_f32 v[184:185], v[184:185], v[244:245] op_sel_hi:[1,0]
    v_pk_mul_f32 v[186:187], v[186:187], v[244:245] op_sel_hi:[1,0]
    v_pk_mul_f32 v[188:189], v[188:189], v[244:245] op_sel_hi:[1,0]
    v_pk_mul_f32 v[190:191], v[190:191], v[244:245] op_sel_hi:[1,0]
    v_pk_mul_f32 v[176:177], v[176:177], v[176:177]
    v_pk_mul_f32 v[178:179], v[178:179], v[178:179]
    v_pk_mul_f32 v[180:181], v[180:181], v[180:181]
    v_pk_mul_f32 v[182:183], v[182:183], v[182:183]
    v_pk_mul_f32 v[184:185], v[184:185], v[184:185]
    v_pk_mul_f32 v[186:187], v[186:187], v[186:187]
    v_pk_mul_f32 v[188:189], v[188:189], v[188:189]
    v_pk_mul_f32 v[190:191], v[190:191], v[190:191]
    v_cvt_pk_bf16_f32 v40, v176, v177
    v_cvt_pk_bf16_f32 v41, v178, v179
    v_cvt_pk_bf16_f32 v42, v180, v181
    v_cvt_pk_bf16_f32 v43, v182, v183
    buffer_store_dwordx4 v[40:43], v1, s[4:7], s9 offen offset:2048 sc1
    v_cvt_pk_bf16_f32 v44, v184, v185
    v_cvt_pk_bf16_f32 v45, v186, v187
    v_cvt_pk_bf16_f32 v46, v188, v189
    v_cvt_pk_bf16_f32 v47, v190, v191
    buffer_store_dwordx4 v[44:47], v1, s[4:7], s9 offen offset:3072 sc1
    v_mov_b32 v255, 1
    s_cmp_lg_u32 s24, 0
    s_mov_b64 exec, 1
    s_waitcnt vmcnt(0)
    s_cbranch_scc1 L_pub_slow_30
    buffer_store_dword v255, off, s[4:7], s58 offset:0
L_pub_done_31:
    s_mov_b64 exec, -1
    s_barrier
    s_mul_i32 s9, s30, 114688
    s_mul_i32 s10, s8, 28672
    s_add_u32 s10, s10, 19845120
    s_add_u32 s11, s9, s10
    v_add_u32 v8, s11, v1
    s_xor_b32 s9, s30, 1
    s_mul_i32 s9, s9, 114688
    s_add_u32 s11, s9, s10
    v_add_u32 v9, s11, v1
    v_accvgpr_read_b32 v80, a240
    v_accvgpr_read_b32 v81, a241
    v_accvgpr_read_b32 v82, a242
    v_accvgpr_read_b32 v83, a243
    v_accvgpr_read_b32 v84, a244
    v_accvgpr_read_b32 v85, a245
    v_accvgpr_read_b32 v86, a246
    v_accvgpr_read_b32 v87, a247
    v_lshlrev_b32 v16, 16, v80
    v_and_b32 v17, 0xffff0000, v80
    v_lshlrev_b32 v18, 16, v81
    v_and_b32 v19, 0xffff0000, v81
    v_lshlrev_b32 v20, 16, v82
    v_and_b32 v21, 0xffff0000, v82
    v_lshlrev_b32 v22, 16, v83
    v_and_b32 v23, 0xffff0000, v83
    v_lshlrev_b32 v24, 16, v84
    v_and_b32 v25, 0xffff0000, v84
    v_lshlrev_b32 v26, 16, v85
    v_and_b32 v27, 0xffff0000, v85
    v_lshlrev_b32 v28, 16, v86
    v_and_b32 v29, 0xffff0000, v86
    v_lshlrev_b32 v30, 16, v87
    v_and_b32 v31, 0xffff0000, v87
    v_accvgpr_read_b32 v80, a248
    v_accvgpr_read_b32 v81, a249
    v_accvgpr_read_b32 v82, a250
    v_accvgpr_read_b32 v83, a251
    v_accvgpr_read_b32 v84, a252
    v_accvgpr_read_b32 v85, a253
    v_accvgpr_read_b32 v86, a254
    v_accvgpr_read_b32 v87, a255
    v_lshlrev_b32 v88, 16, v80
    v_and_b32 v89, 0xffff0000, v80
    v_lshlrev_b32 v90, 16, v81
    v_and_b32 v91, 0xffff0000, v81
    v_lshlrev_b32 v92, 16, v82
    v_and_b32 v93, 0xffff0000, v82
    v_lshlrev_b32 v94, 16, v83
    v_and_b32 v95, 0xffff0000, v83
    v_lshlrev_b32 v96, 16, v84
    v_and_b32 v97, 0xffff0000, v84
    v_lshlrev_b32 v98, 16, v85
    v_and_b32 v99, 0xffff0000, v85
    v_lshlrev_b32 v100, 16, v86
    v_and_b32 v101, 0xffff0000, v86
    v_lshlrev_b32 v102, 16, v87
    v_and_b32 v103, 0xffff0000, v87
    v_pk_add_f32 v[16:17], v[16:17], v[88:89]
    v_pk_add_f32 v[18:19], v[18:19], v[90:91]
    v_pk_add_f32 v[20:21], v[20:21], v[92:93]
    v_pk_add_f32 v[22:23], v[22:23], v[94:95]
    v_pk_add_f32 v[24:25], v[24:25], v[96:97]
    v_pk_add_f32 v[26:27], v[26:27], v[98:99]
    v_pk_add_f32 v[28:29], v[28:29], v[100:101]
    v_pk_add_f32 v[30:31], v[30:31], v[102:103]
    s_mov_b64 exec, s[40:41]
L_poll_32:
    buffer_load_dword v255, v3, s[4:7], s59 offen offset:0 sc1
    s_waitcnt vmcnt(0)
    v_cmp_eq_u32 vcc, 0, v255
    s_cbranch_vccz L_poll_done_33
    s_sub_u32 s25, s25, 1
    s_cmp_gt_i32 s25, 0
    s_cbranch_scc1 L_poll_32
    s_mov_b32 s25, 0
L_poll_done_33:
    s_mov_b64 exec, -1
    s_cmp_lg_u32 s24, 0
    s_cbranch_scc1 L_poll_slow_34
L_poll_ret_35:
    buffer_load_dwordx4 v[80:83], v8, s[4:7], 0 offen offset:0 sc1
    buffer_load_dwordx4 v[84:87], v9, s[4:7], 0 offen offset:0 sc1
    buffer_load_dwordx4 v[88:91], v8, s[4:7], 0 offen offset:1024 sc1
    buffer_load_dwordx4 v[92:95], v9, s[4:7], 0 offen offset:1024 sc1
    buffer_load_dwordx4 v[96:99], v8, s[4:7], 0 offen offset:2048 sc1
    buffer_load_dwordx4 v[100:103], v9, s[4:7], 0 offen offset:2048 sc1
    buffer_load_dwordx4 v[104:107], v8, s[4:7], 0 offen offset:3072 sc1
    buffer_load_dwordx4 v[108:111], v9, s[4:7], 0 offen offset:3072 sc1
    buffer_load_dwordx4 v[112:115], v8, s[4:7], s42 offen offset:0 sc1
    buffer_load_dwordx4 v[116:119], v9, s[4:7], s42 offen offset:0 sc1
    s_waitcnt vmcnt(9)
    v_mfma_f32_32x32x16_bf16 v[16:31], a[0:3], v[80:83], v[16:31]
    buffer_load_dwordx4 v[120:123], v8, s[4:7], s42 offen offset:1024 sc1
    v_mfma_f32_32x32x16_bf16 v[32:47], a[112:115], v[80:83], 0
    s_waitcnt vmcnt(9)
    v_mfma_f32_32x32x16_bf16 v[48:63], a[0:3], v[84:87], 0
    buffer_load_dwordx4 v[124:127], v9, s[4:7], s42 offen offset:1024 sc1
    v_mfma_f32_32x32x16_bf16 v[64:79], a[112:115], v[84:87], 0
    s_waitcnt vmcnt(9)
    v_mfma_f32_32x32x16_bf16 v[16:31], a[4:7], v[88:91], v[16:31]
    buffer_load_dwordx4 v[128:131], v8, s[4:7], s42 offen offset:2048 sc1
    v_mfma_f32_32x32x16_bf16 v[32:47], a[116:119], v[88:91], v[32:47]
    s_waitcnt vmcnt(9)
    v_mfma_f32_32x32x16_bf16 v[48:63], a[4:7], v[92:95], v[48:63]
    buffer_load_dwordx4 v[132:135], v9, s[4:7], s42 offen offset:2048 sc1
    v_mfma_f32_32x32x16_bf16 v[64:79], a[116:119], v[92:95], v[64:79]
    s_waitcnt vmcnt(9)
    v_mfma_f32_32x32x16_bf16 v[16:31], a[8:11], v[96:99], v[16:31]
    buffer_load_dwordx4 v[136:139], v8, s[4:7], s42 offen offset:3072 sc1
    v_mfma_f32_32x32x16_bf16 v[32:47], a[120:123], v[96:99], v[32:47]
    s_waitcnt vmcnt(9)
    v_mfma_f32_32x32x16_bf16 v[48:63], a[8:11], v[100:103], v[48:63]
    buffer_load_dwordx4 v[140:143], v9, s[4:7], s42 offen offset:3072 sc1
    v_mfma_f32_32x32x16_bf16 v[64:79], a[120:123], v[100:103], v[64:79]
    s_waitcnt vmcnt(9)
    v_mfma_f32_32x32x16_bf16 v[16:31], a[12:15], v[104:107], v[16:31]
    buffer_load_dwordx4 v[144:147], v8, s[4:7], s43 offen offset:0 sc1
    v_mfma_f32_32x32x16_bf16 v[32:47], a[124:127], v[104:107], v[32:47]
    s_waitcnt vmcnt(9)
    v_mfma_f32_32x32x16_bf16 v[48:63], a[12:15], v[108:111], v[48:63]
    buffer_load_dwordx4 v[148:151], v9, s[4:7], s43 offen offset:0 sc1
    v_mfma_f32_32x32x16_bf16 v[64:79], a[124:127], v[108:111], v[64:79]
    s_waitcnt vmcnt(9)
    v_mfma_f32_32x32x16_bf16 v[16:31], a[16:19], v[112:115], v[16:31]
    buffer_load_dwordx4 v[152:155], v8, s[4:7], s43 offen offset:1024 sc1
    v_mfma_f32_32x32x16_bf16 v[32:47], a[128:131], v[112:115], v[32:47]
    s_waitcnt vmcnt(9)
    v_mfma_f32_32x32x16_bf16 v[48:63], a[16:19], v[116:119], v[48:63]
    buffer_load_dwordx4 v[156:159], v9, s[4:7], s43 offen offset:1024 sc1
    v_mfma_f32_32x32x16_bf16 v[64:79], a[128:131], v[116:119], v[64:79]
    s_waitcnt vmcnt(9)
    v_mfma_f32_32x32x16_bf16 v[16:31], a[20:23], v[120:123], v[16:31]
    buffer_load_dwordx4 v[160:163], v8, s[4:7], s43 offen offset:2048 sc1
    v_mfma_f32_32x32x16_bf16 v[32:47], a[132:135], v[120:123], v[32:47]
    s_waitcnt vmcnt(9)
    v_mfma_f32_32x32x16_bf16 v[48:63], a[20:23], v[124:127], v[48:63]
    buffer_load_dwordx4 v[164:167], v9, s[4:7], s43 offen offset:2048 sc1
    v_mfma_f32_32x32x16_bf16 v[64:79], a[132:135], v[124:127], v[64:79]
    s_waitcnt vmcnt(9)
    v_mfma_f32_32x32x16_bf16 v[16:31], a[24:27], v[128:131], v[16:31]
    buffer_load_dwordx4 v[168:171], v8, s[4:7], s43 offen offset:3072 sc1
    v_mfma_f32_32x32x16_bf16 v[32:47], a[136:139], v[128:131], v[32:47]
    s_waitcnt vmcnt(9)
    v_mfma_f32_32x32x16_bf16 v[48:63], a[24:27], v[132:135], v[48:63]
    buffer_load_dwordx4 v[172:175], v9, s[4:7], s43 offen offset:3072 sc1
    v_mfma_f32_32x32x16_bf16 v[64:79], a[136:139], v[132:135], v[64:79]
    s_waitcnt vmcnt(9)
    v_mfma_f32_32x32x16_bf16 v[16:31], a[28:31], v[136:139], v[16:31]
    buffer_load_dwordx4 v[176:179], v8, s[4:7], s44 offen offset:0 sc1
    v_mfma_f32_32x32x16_bf16 v[32:47], a[140:143], v[136:139], v[32:47]
    s_waitcnt vmcnt(9)
    v_mfma_f32_32x32x16_bf16 v[48:63], a[28:31], v[140:143], v[48:63]
    buffer_load_dwordx4 v[180:183], v9, s[4:7], s44 offen offset:0 sc1
    v_mfma_f32_32x32x16_bf16 v[64:79], a[140:143], v[140:143], v[64:79]
    s_waitcnt vmcnt(9)
    v_mfma_f32_32x32x16_bf16 v[16:31], a[32:35], v[144:147], v[16:31]
    buffer_load_dwordx4 v[184:187], v8, s[4:7], s44 offen offset:1024 sc1
    v_mfma_f32_32x32x16_bf16 v[32:47], a[144:147], v[144:147], v[32:47]
    s_waitcnt vmcnt(9)
    v_mfma_f32_32x32x16_bf16 v[48:63], a[32:35], v[148:151], v[48:63]
    buffer_load_dwordx4 v[188:191], v9, s[4:7], s44 offen offset:1024 sc1
    v_mfma_f32_32x32x16_bf16 v[64:79], a[144:147], v[148:151], v[64:79]
    s_waitcnt vmcnt(9)
    v_mfma_f32_32x32x16_bf16 v[16:31], a[36:39], v[152:155], v[16:31]
    buffer_load_dwordx4 v[192:195], v8, s[4:7], s44 offen offset:2048 sc1
    v_mfma_f32_32x32x16_bf16 v[32:47], a[148:151], v[152:155], v[32:47]
    s_waitcnt vmcnt(9)
    v_mfma_f32_32x32x16_bf16 v[48:63], a[36:39], v[156:159], v[48:63]
    buffer_load_dwordx4 v[196:199], v9, s[4:7], s44 offen offset:2048 sc1
    v_mfma_f32_32x32x16_bf16 v[64:79], a[148:151], v[156:159], v[64:79]
    s_waitcnt vmcnt(9)
    v_mfma_f32_32x32x16_bf16 v[16:31], a[40:43], v[160:163], v[16:31]
    buffer_load_dwordx4 v[200:203], v8, s[4:7], s44 offen offset:3072 sc1
    v_mfma_f32_32x32x16_bf16 v[32:47], a[152:155], v[160:163], v[32:47]
    s_waitcnt vmcnt(9)
    v_mfma_f32_32x32x16_bf16 v[48:63], a[40:43], v[164:167], v[48:63]
    buffer_load_dwordx4 v[204:207], v9, s[4:7], s44 offen offset:3072 sc1
    v_mfma_f32_32x32x16_bf16 v[64:79], a[152:155], v[164:167], v[64:79]
    s_waitcnt vmcnt(9)
    v_mfma_f32_32x32x16_bf16 v[16:31], a[44:47], v[168:171], v[16:31]
    buffer_load_dwordx4 v[80:83], v8, s[4:7], s45 offen offset:0 sc1
    v_mfma_f32_32x32x16_bf16 v[32:47], a[156:159], v[168:171], v[32:47]
    s_waitcnt vmcnt(9)
    v_mfma_f32_32x32x16_bf16 v[48:63], a[44:47], v[172:175], v[48:63]
    buffer_load_dwordx4 v[84:87], v9, s[4:7], s45 offen offset:0 sc1
    v_mfma_f32_32x32x16_bf16 v[64:79], a[156:159], v[172:175], v[64:79]
    s_waitcnt vmcnt(9)
    v_mfma_f32_32x32x16_bf16 v[16:31], a[48:51], v[176:179], v[16:31]
    buffer_load_dwordx4 v[88:91], v8, s[4:7], s45 offen offset:1024 sc1
    v_mfma_f32_32x32x16_bf16 v[32:47], a[160:163], v[176:179], v[32:47]
    s_waitcnt vmcnt(9)
    v_mfma_f32_32x32x16_bf16 v[48:63], a[48:51], v[180:183], v[48:63]
    buffer_load_dwordx4 v[92:95], v9, s[4:7], s45 offen offset:1024 sc1
    v_mfma_f32_32x32x16_bf16 v[64:79], a[160:163], v[180:183], v[64:79]
    s_waitcnt vmcnt(9)
    v_mfma_f32_32x32x16_bf16 v[16:31], a[52:55], v[184:187], v[16:31]
    buffer_load_dwordx4 v[96:99], v8, s[4:7], s45 offen offset:2048 sc1
    v_mfma_f32_32x32x16_bf16 v[32:47], a[164:167], v[184:187], v[32:47]
    s_waitcnt vmcnt(9)
    v_mfma_f32_32x32x16_bf16 v[48:63], a[52:55], v[188:191], v[48:63]
    buffer_load_dwordx4 v[100:103], v9, s[4:7], s45 offen offset:2048 sc1
    v_mfma_f32_32x32x16_bf16 v[64:79], a[164:167], v[188:191], v[64:79]
    s_waitcnt vmcnt(9)
    v_mfma_f32_32x32x16_bf16 v[16:31], a[56:59], v[192:195], v[16:31]
    buffer_load_dwordx4 v[104:107], v8, s[4:7], s45 offen offset:3072 sc1
    v_mfma_f32_32x32x16_bf16 v[32:47], a[168:171], v[192:195], v[32:47]
    s_waitcnt vmcnt(9)
    v_mfma_f32_32x32x16_bf16 v[48:63], a[56:59], v[196:199], v[48:63]
    buffer_load_dwordx4 v[108:111], v9, s[4:7], s45 offen offset:3072 sc1
    v_mfma_f32_32x32x16_bf16 v[64:79], a[168:171], v[196:199], v[64:79]
    s_waitcnt vmcnt(9)
    v_mfma_f32_32x32x16_bf16 v[16:31], a[60:63], v[200:203], v[16:31]
    buffer_load_dwordx4 v[112:115], v8, s[4:7], s46 offen offset:0 sc1
    v_mfma_f32_32x32x16_bf16 v[32:47], a[172:175], v[200:203], v[32:47]
    s_waitcnt vmcnt(9)
    v_mfma_f32_32x32x16_bf16 v[48:63], a[60:63], v[204:207], v[48:63]
    buffer_load_dwordx4 v[116:119], v9, s[4:7], s46 offen offset:0 sc1
    v_mfma_f32_32x32x16_bf16 v[64:79], a[172:175], v[204:207], v[64:79]
    s_waitcnt vmcnt(9)
    v_mfma_f32_32x32x16_bf16 v[16:31], a[64:67], v[80:83], v[16:31]
    buffer_load_dwordx4 v[120:123], v8, s[4:7], s46 offen offset:1024 sc1
    v_mfma_f32_32x32x16_bf16 v[32:47], a[176:179], v[80:83], v[32:47]
    s_waitcnt vmcnt(9)
    v_mfma_f32_32x32x16_bf16 v[48:63], a[64:67], v[84:87], v[48:63]
    buffer_load_dwordx4 v[124:127], v9, s[4:7], s46 offen offset:1024 sc1
    v_mfma_f32_32x32x16_bf16 v[64:79], a[176:179], v[84:87], v[64:79]
    s_waitcnt vmcnt(9)
    v_mfma_f32_32x32x16_bf16 v[16:31], a[68:71], v[88:91], v[16:31]
    buffer_load_dwordx4 v[128:131], v8, s[4:7], s46 offen offset:2048 sc1
    v_mfma_f32_32x32x16_bf16 v[32:47], a[180:183], v[88:91], v[32:47]
    s_waitcnt vmcnt(9)
    v_mfma_f32_32x32x16_bf16 v[48:63], a[68:71], v[92:95], v[48:63]
    buffer_load_dwordx4 v[132:135], v9, s[4:7], s46 offen offset:2048 sc1
    v_mfma_f32_32x32x16_bf16 v[64:79], a[180:183], v[92:95], v[64:79]
    s_waitcnt vmcnt(9)
    v_mfma_f32_32x32x16_bf16 v[16:31], a[72:75], v[96:99], v[16:31]
    buffer_load_dwordx4 v[136:139], v8, s[4:7], s46 offen offset:3072 sc1
    v_mfma_f32_32x32x16_bf16 v[32:47], a[184:187], v[96:99], v[32:47]
    s_waitcnt vmcnt(9)
    v_mfma_f32_32x32x16_bf16 v[48:63], a[72:75], v[100:103], v[48:63]
    buffer_load_dwordx4 v[140:143], v9, s[4:7], s46 offen offset:3072 sc1
    v_mfma_f32_32x32x16_bf16 v[64:79], a[184:187], v[100:103], v[64:79]
    s_waitcnt vmcnt(9)
    v_mfma_f32_32x32x16_bf16 v[16:31], a[76:79], v[104:107], v[16:31]
    buffer_load_dwordx4 v[144:147], v8, s[4:7], s47 offen offset:0 sc1
    v_mfma_f32_32x32x16_bf16 v[32:47], a[188:191], v[104:107], v[32:47]
    s_waitcnt vmcnt(9)
    v_mfma_f32_32x32x16_bf16 v[48:63], a[76:79], v[108:111], v[48:63]
    buffer_load_dwordx4 v[148:151], v9, s[4:7], s47 offen offset:0 sc1
    v_mfma_f32_32x32x16_bf16 v[64:79], a[188:191], v[108:111], v[64:79]
    s_waitcnt vmcnt(9)
    v_mfma_f32_32x32x16_bf16 v[16:31], a[80:83], v[112:115], v[16:31]
    buffer_load_dwordx4 v[152:155], v8, s[4:7], s47 offen offset:1024 sc1
    v_mfma_f32_32x32x16_bf16 v[32:47], a[192:195], v[112:115], v[32:47]
    s_waitcnt vmcnt(9)
    v_mfma_f32_32x32x16_bf16 v[48:63], a[80:83], v[116:119], v[48:63]
    buffer_load_dwordx4 v[156:159], v9, s[4:7], s47 offen offset:1024 sc1
    v_mfma_f32_32x32x16_bf16 v[64:79], a[192:195], v[116:119], v[64:79]
    s_waitcnt vmcnt(9)
    v_mfma_f32_32x32x16_bf16 v[16:31], a[84:87], v[120:123], v[16:31]
    buffer_load_dwordx4 v[160:163], v8, s[4:7], s47 offen offset:2048 sc1
    v_mfma_f32_32x32x16_bf16 v[32:47], a[196:199], v[120:123], v[32:47]
    s_waitcnt vmcnt(9)
    v_mfma_f32_32x32x16_bf16 v[48:63], a[84:87], v[124:127], v[48:63]
    buffer_load_dwordx4 v[164:167], v9, s[4:7], s47 offen offset:2048 sc1
    v_mfma_f32_32x32x16_bf16 v[64:79], a[196:199], v[124:127], v[64:79]
    s_waitcnt vmcnt(9)
    v_mfma_f32_32x32x16_bf16 v[16:31], a[88:91], v[128:131], v[16:31]
    buffer_load_dwordx4 v[168:171], v8, s[4:7], s47 offen offset:3072 sc1
    v_mfma_f32_32x32x16_bf16 v[32:47], a[200:203], v[128:131], v[32:47]
    s_waitcnt vmcnt(9)
    v_mfma_f32_32x32x16_bf16 v[48:63], a[88:91], v[132:135], v[48:63]
    buffer_load_dwordx4 v[172:175], v9, s[4:7], s47 offen offset:3072 sc1
    v_mfma_f32_32x32x16_bf16 v[64:79], a[200:203], v[132:135], v[64:79]
    s_mul_i32 s9, s8, 22528
    s_add_u32 s9, s9, 0
    s_mul_i32 s10, s26, 89088
    s_add_u32 s10, s10, s9
    s_add_u32 s10, s10, 8388608
    s_mov_b32 m0, s9
    v_add_u32 v13, s10, v1
    s_waitcnt vmcnt(9)
    v_mfma_f32_32x32x16_bf16 v[16:31], a[92:95], v[136:139], v[16:31]
    buffer_load_dwordx4 v13, s[4:7], 0 offen offset:0 sc1 lds
    v_mfma_f32_32x32x16_bf16 v[32:47], a[204:207], v[136:139], v[32:47]
    buffer_load_dwordx4 v13, s[4:7], 0 offen offset:1024 sc1 lds
    s_waitcnt vmcnt(10)
    v_mfma_f32_32x32x16_bf16 v[48:63], a[92:95], v[140:143], v[48:63]
    buffer_load_dwordx4 v13, s[4:7], 0 offen offset:2048 sc1 lds
    v_mfma_f32_32x32x16_bf16 v[64:79], a[204:207], v[140:143], v[64:79]
    buffer_load_dwordx4 v13, s[4:7], 0 offen offset:3072 sc1 lds
    s_waitcnt vmcnt(11)
    v_mfma_f32_32x32x16_bf16 v[32:47], a[208:211], v[144:147], v[32:47]
    s_add_u32 m0, m0, 4096
    s_nop 0
    s_waitcnt vmcnt(9)
    v_mfma_f32_32x32x16_bf16 v[32:47], a[212:215], v[152:155], v[32:47]
    buffer_load_dwordx4 v13, s[4:7], s42 offen offset:0 sc1 lds
    s_waitcnt vmcnt(8)
    v_mfma_f32_32x32x16_bf16 v[32:47], a[216:219], v[160:163], v[32:47]
    buffer_load_dwordx4 v13, s[4:7], s42 offen offset:1024 sc1 lds
    s_waitcnt vmcnt(7)
    v_mfma_f32_32x32x16_bf16 v[32:47], a[220:223], v[168:171], v[32:47]
    buffer_load_dwordx4 v13, s[4:7], s42 offen offset:2048 sc1 lds
    v_mfma_f32_32x32x16_bf16 v[64:79], a[208:211], v[148:151], v[64:79]
    buffer_load_dwordx4 v13, s[4:7], s42 offen offset:3072 sc1 lds
    s_nop 4
    v_mfma_f32_32x32x16_bf16 v[64:79], a[212:215], v[156:159], v[64:79]
    s_add_u32 m0, m0, 4096
    s_nop 0
    s_nop 4
    v_mfma_f32_32x32x16_bf16 v[64:79], a[216:219], v[164:167], v[64:79]
    buffer_load_dwordx4 v13, s[4:7], s43 offen offset:0 sc1 lds
    ds_write_b128 v4, v[32:35] offset:0
    ds_write_b128 v4, v[36:39] offset:1024
    s_waitcnt vmcnt(9)
    v_mfma_f32_32x32x16_bf16 v[64:79], a[220:223], v[172:175], v[64:79]
    buffer_load_dwordx4 v13, s[4:7], s43 offen offset:1024 sc1 lds
    ds_write_b128 v4, v[40:43] offset:2048
    ds_write_b128 v4, v[44:47] offset:3072
    v_mfma_f32_32x32x16_bf16 v[48:63], a[96:99], v[148:151], v[48:63]
    buffer_load_dwordx4 v13, s[4:7], s43 offen offset:2048 sc1 lds
    s_nop 4
    v_mfma_f32_32x32x16_bf16 v[48:63], a[100:103], v[156:159], v[48:63]
    buffer_load_dwordx4 v13, s[4:7], s43 offen offset:3072 sc1 lds
    s_nop 4
    v_mfma_f32_32x32x16_bf16 v[48:63], a[104:107], v[164:167], v[48:63]
    s_add_u32 m0, m0, 4096
    s_nop 0
    ds_write_b128 v6, v[64:67] offset:0
    ds_write_b128 v6, v[68:71] offset:1024
    v_mfma_f32_32x32x16_bf16 v[48:63], a[108:111], v[172:175], v[48:63]
    buffer_load_dwordx4 v13, s[4:7], s44 offen offset:0 sc1 lds
    ds_write_b128 v6, v[72:75] offset:2048
    ds_write_b128 v6, v[76:79] offset:3072
    v_mfma_f32_32x32x16_bf16 v[16:31], a[96:99], v[144:147], v[16:31]
    buffer_load_dwordx4 v13, s[4:7], s44 offen offset:1024 sc1 lds
    s_nop 4
    v_mfma_f32_32x32x16_bf16 v[16:31], a[100:103], v[152:155], v[16:31]
    buffer_load_dwordx4 v13, s[4:7], s44 offen offset:2048 sc1 lds
    s_nop 4
    v_mfma_f32_32x32x16_bf16 v[16:31], a[104:107], v[160:163], v[16:31]
    buffer_load_dwordx4 v13, s[4:7], s44 offen offset:3072 sc1 lds
    ds_write_b128 v5, v[48:51] offset:0
    ds_write_b128 v5, v[52:55] offset:1024
    v_mfma_f32_32x32x16_bf16 v[16:31], a[108:111], v[168:171], v[16:31]
    s_add_u32 m0, m0, 4096
    s_nop 0
    ds_write_b128 v5, v[56:59] offset:2048
    ds_write_b128 v5, v[60:63] offset:3072
    buffer_load_dwordx4 v13, s[4:7], s45 offen offset:0 sc1 lds
    buffer_load_dwordx4 v13, s[4:7], s45 offen offset:1024 sc1 lds
    buffer_load_dwordx4 v13, s[4:7], s45 offen offset:2048 sc1 lds
    buffer_load_dwordx4 v13, s[4:7], s45 offen offset:3072 sc1 lds
    s_add_u32 m0, m0, 4096
    s_nop 0
    buffer_load_dwordx4 v13, s[4:7], s46 offen offset:0 sc1 lds
    buffer_load_dwordx4 v13, s[4:7], s46 offen offset:1024 sc1 lds
    s_waitcnt lgkmcnt(0)
    s_barrier
    ds_read_b128 v[32:35], v7 offset:0
    ds_read_b128 v[36:39], v7 offset:1024
    ds_read_b128 v[40:43], v7 offset:2048
    ds_read_b128 v[44:47], v7 offset:3072
    ds_read_b128 v[48:51], v7 offset:4096
    ds_read_b128 v[52:55], v7 offset:5120
    ds_read_b128 v[56:59], v7 offset:6144
    ds_read_b128 v[60:63], v7 offset:7168
    ds_read_b128 v[64:67], v7 offset:8192
    ds_read_b128 v[68:71], v7 offset:9216
    ds_read_b128 v[72:75], v7 offset:10240
    ds_read_b128 v[76:79], v7 offset:11264
    v_mov_b32 v9, 0x3f803f80
    v_mov_b32 v10, 0
    v_mov_b32 v11, 0
    v_lshlrev_b32 v12, 3, v0
    s_add_u32 s9, s53, 13619200
    s_add_u32 s10, s54, 15454208
    s_add_u32 s11, s55, 13545472
    s_waitcnt lgkmcnt(8)
    v_pk_add_f32 v[16:17], v[16:17], v[32:33]
    v_pk_add_f32 v[18:19], v[18:19], v[34:35]
    v_pk_add_f32 v[20:21], v[20:21], v[36:37]
    v_pk_add_f32 v[22:23], v[22:23], v[38:39]
    v_pk_add_f32 v[24:25], v[24:25], v[40:41]
    v_pk_add_f32 v[26:27], v[26:27], v[42:43]
    v_pk_add_f32 v[28:29], v[28:29], v[44:45]
    v_pk_add_f32 v[30:31], v[30:31], v[46:47]
    s_waitcnt lgkmcnt(4)
    v_pk_add_f32 v[16:17], v[16:17], v[48:49]
    v_pk_add_f32 v[18:19], v[18:19], v[50:51]
    v_pk_add_f32 v[20:21], v[20:21], v[52:53]
    v_pk_add_f32 v[22:23], v[22:23], v[54:55]
    v_pk_add_f32 v[24:25], v[24:25], v[56:57]
    v_pk_add_f32 v[26:27], v[26:27], v[58:59]
    v_pk_add_f32 v[28:29], v[28:29], v[60:61]
    v_pk_add_f32 v[30:31], v[30:31], v[62:63]
    s_waitcnt lgkmcnt(0)
    v_pk_add_f32 v[16:17], v[16:17], v[64:65]
    v_pk_add_f32 v[18:19], v[18:19], v[66:67]
    v_pk_add_f32 v[20:21], v[20:21], v[68:69]
    v_pk_add_f32 v[22:23], v[22:23], v[70:71]
    v_pk_add_f32 v[24:25], v[24:25], v[72:73]
    v_pk_add_f32 v[26:27], v[26:27], v[74:75]
    v_pk_add_f32 v[28:29], v[28:29], v[76:77]
    v_pk_add_f32 v[30:31], v[30:31], v[78:79]
    v_cvt_pk_bf16_f32 v80, v16, v17
    v_cvt_pk_bf16_f32 v81, v18, v19
    v_cvt_pk_bf16_f32 v82, v20, v21
    v_cvt_pk_bf16_f32 v83, v22, v23
    buffer_store_dwordx4 v[80:83], v1, s[4:7], s9 offen
    v_cvt_pk_bf16_f32 v84, v24, v25
    v_cvt_pk_bf16_f32 v85, v26, v27
    v_cvt_pk_bf16_f32 v86, v28, v29
    v_cvt_pk_bf16_f32 v87, v30, v31
    buffer_store_dwordx4 v[84:87], v1, s[4:7], s9 offen offset:1024
    v_dot2_f32_bf16 v10, v80, v9, v10
    v_dot2_f32_bf16 v11, v80, v80, v11
    v_dot2_f32_bf16 v10, v81, v9, v10
    v_dot2_f32_bf16 v11, v81, v81, v11
    v_dot2_f32_bf16 v10, v82, v9, v10
    v_dot2_f32_bf16 v11, v82, v82, v11
    v_dot2_f32_bf16 v10, v83, v9, v10
    v_dot2_f32_bf16 v11, v83, v83, v11
    v_dot2_f32_bf16 v10, v84, v9, v10
    v_dot2_f32_bf16 v11, v84, v84, v11
    v_dot2_f32_bf16 v10, v85, v9, v10
    v_dot2_f32_bf16 v11, v85, v85, v11
    v_dot2_f32_bf16 v10, v86, v9, v10
    v_dot2_f32_bf16 v11, v86, v86, v11
    v_dot2_f32_bf16 v10, v87, v9, v10
    v_dot2_f32_bf16 v11, v87, v87, v11
    v_accvgpr_write_b32 a240, v80
    v_accvgpr_write_b32 a241, v81
    v_accvgpr_write_b32 a242, v82
    v_permlane32_swap_b32 v10, v11
    v_add_f32 v10, v10, v11
    buffer_store_dword v10, v12, s[4:7], s10 offen
    v_accvgpr_write_b32 a243, v83
    v_accvgpr_write_b32 a244, v84
    v_accvgpr_write_b32 a245, v85
    v_accvgpr_write_b32 a246, v86
    v_accvgpr_write_b32 a247, v87
    v_mov_b32 v255, 1
    s_cmp_lg_u32 s24, 0
    s_mov_b64 exec, 1
    s_waitcnt vmcnt(0)
    s_cbranch_scc1 L_pub_slow_36
    buffer_store_dword v255, off, s[4:7], s11 offset:0
L_pub_done_37:
    s_mov_b64 exec, -1
L_layer1:
    s_mul_i32 s9, s28, 28672
    s_add_u32 s9, s9, 13619200
    v_add_u32 v222, s9, v1
    s_mul_i32 s9, s28, 3584
    s_add_u32 s9, s9, 15454208
    v_lshl_add_u32 v223, v0, 3, s9
    s_barrier
    ds_read_b128 v[176:179], v1 offset:0
    ds_read_b128 v[180:183], v1 offset:1024
    ds_read_b128 v[184:187], v1 offset:2048
    ds_read_b128 v[188:191], v1 offset:3072
    ds_read_b128 v[192:195], v1 offset:4096
    ds_read_b128 v[196:199], v1 offset:5120
    s_mov_b64 exec, 0x3fff
L_poll_38:
    buffer_load_dword v255, v3, s[4:7], s60 offen offset:0 sc1
    s_waitcnt vmcnt(0)
    v_cmp_eq_u32 vcc, 0, v255
    s_cbranch_vccz L_poll_done_39
    s_sub_u32 s25, s25, 1
    s_cmp_gt_i32 s25, 0
    s_cbranch_scc1 L_poll_38
    s_mov_b32 s25, 0
L_poll_done_39:
    s_mov_b64 exec, -1
    s_cmp_lg_u32 s24, 0
    s_cbranch_scc1 L_poll_slow_40
L_poll_ret_41:
    buffer_load_dwordx4 v[16:19], v222, s[4:7], 0 offen offset:0 sc1
    buffer_load_dwordx4 v[20:23], v222, s[4:7], 0 offen offset:1024 sc1
    buffer_load_dwordx4 v[24:27], v222, s[4:7], 0 offen offset:2048 sc1
    buffer_load_dwordx4 v[28:31], v222, s[4:7], 0 offen offset:3072 sc1
    buffer_load_dwordx4 v[32:35], v222, s[4:7], s42 offen offset:0 sc1
    buffer_load_dwordx4 v[36:39], v222, s[4:7], s42 offen offset:1024 sc1
    s_waitcnt vmcnt(5) lgkmcnt(4)
    v_mfma_f32_32x32x16_bf16 v[128:143], v[176:179], v[16:19], 0
    buffer_load_dwordx4 v[40:43], v222, s[4:7], s42 offen offset:2048 sc1
    ds_read_b128 v[200:203], v1 offset:6144
    v_mfma_f32_32x32x16_bf16 v[144:159], v[16:19], v[180:183], 0
    ds_read_b128 v[204:207], v1 offset:7168
    s_waitcnt vmcnt(5) lgkmcnt(4)
    v_mfma_f32_32x32x16_bf16 v[128:143], v[184:187], v[20:23], v[128:143]
    buffer_load_dwordx4 v[44:47], v222, s[4:7], s42 offen offset:3072 sc1
    ds_read_b128 v[176:179], v1 offset:8192
    v_mfma_f32_32x32x16_bf16 v[144:159], v[20:23], v[188:191], v[144:159]
    ds_read_b128 v[180:183], v1 offset:9216
    s_waitcnt vmcnt(5) lgkmcnt(4)
    v_mfma_f32_32x32x16_bf16 v[128:143], v[192:195], v[24:27], v[128:143]
    buffer_load_dwordx4 v[48:51], v222, s[4:7], s43 offen offset:0 sc1
    ds_read_b128 v[184:187], v1 offset:10240
    v_mfma_f32_32x32x16_bf16 v[144:159], v[24:27], v[196:199], v[144:159]
    buffer_load_dwordx2 v[8:9], v223, s[4:7], 0 offen offset:0 sc1
    ds_read_b128 v[188:191], v1 offset:11264
    s_waitcnt vmcnt(6) lgkmcnt(4)
    v_mfma_f32_32x32x16_bf16 v[128:143], v[200:203], v[28:31], v[128:143]
    buffer_load_dwordx4 v[52:55], v222, s[4:7], s43 offen offset:1024 sc1
    ds_read_b128 v[192:195], v1 offset:12288
    v_mfma_f32_32x32x16_bf16 v[144:159], v[28:31], v[204:207], v[144:159]
    buffer_load_dwordx2 v[10:11], v223, s[4:7], 0 offen offset:512 sc1
    ds_read_b128 v[196:199], v1 offset:13312
    s_waitcnt vmcnt(7) lgkmcnt(4)
    v_mfma_f32_32x32x16_bf16 v[128:143], v[176:179], v[32:35], v[128:143]
    buffer_load_dwordx4 v[56:59], v222, s[4:7], s43 offen offset:2048 sc1
    ds_read_b128 v[200:203], v1 offset:14336
    v_mfma_f32_32x32x16_bf16 v[144:159], v[32:35], v[180:183], v[144:159]
    buffer_load_dwordx2 v[12:13], v223, s[4:7], 0 offen offset:1024 sc1
    ds_read_b128 v[204:207], v1 offset:15360
    s_waitcnt vmcnt(8) lgkmcnt(4)
    v_mfma_f32_32x32x16_bf16 v[128:143], v[184:187], v[36:39], v[128:143]
    buffer_load_dwordx4 v[60:63], v222, s[4:7], s43 offen offset:3072 sc1
    ds_read_b128 v[176:179], v1 offset:16384
    v_mfma_f32_32x32x16_bf16 v[144:159], v[36:39], v[188:191], v[144:159]
    buffer_load_dwordx2 v[14:15], v223, s[4:7], 0 offen offset:1536 sc1
    ds_read_b128 v[180:183], v1 offset:17408
    s_waitcnt vmcnt(9) lgkmcnt(4)
    v_mfma_f32_32x32x16_bf16 v[128:143], v[192:195], v[40:43], v[128:143]
    buffer_load_dwordx4 v[64:67], v222, s[4:7], s44 offen offset:0 sc1
    ds_read_b128 v[184:187], v1 offset:18432
    v_mfma_f32_32x32x16_bf16 v[144:159], v[40:43], v[196:199], v[144:159]
    buffer_load_dwordx2 v[216:217], v223, s[4:7], 0 offen offset:2048 sc1
    ds_read_b128 v[188:191], v1 offset:19456
    s_waitcnt vmcnt(10) lgkmcnt(4)
    v_mfma_f32_32x32x16_bf16 v[128:143], v[200:203], v[44:47], v[128:143]
    buffer_load_dwordx4 v[68:71], v222, s[4:7], s44 offen offset:1024 sc1
    ds_read_b128 v[192:195], v1 offset:20480
    v_mfma_f32_32x32x16_bf16 v[144:159], v[44:47], v[204:207], v[144:159]
    buffer_load_dwordx2 v[218:219], v223, s[4:7], 0 offen offset:2560 sc1
    ds_read_b128 v[196:199], v1 offset:21504
    s_waitcnt vmcnt(11) lgkmcnt(4)
    v_mfma_f32_32x32x16_bf16 v[128:143], v[176:179], v[48:51], v[128:143]
    buffer_load_dwordx4 v[72:75], v222, s[4:7], s44 offen offset:2048 sc1
    ds_read_b128 v[200:203], v1 offset:22528
    v_mfma_f32_32x32x16_bf16 v[144:159], v[48:51], v[180:183], v[144:159]
    buffer_load_dwordx2 v[220:221], v223, s[4:7], 0 offen offset:3072 sc1
    ds_read_b128 v[204:207], v1 offset:23552
    s_waitcnt vmcnt(11) lgkmcnt(4)
    v_mfma_f32_32x32x16_bf16 v[128:143], v[184:187], v[52:55], v[128:143]
    buffer_load_dwordx4 v[76:79], v222, s[4:7], s44 offen offset:3072 sc1
    ds_read_b128 v[176:179], v1 offset:24576
    v_mfma_f32_32x32x16_bf16 v[144:159], v[52:55], v[188:191], v[144:159]
    ds_read_b128 v[180:183], v1 offset:25600
    s_waitcnt vmcnt(10) lgkmcnt(4)
    v_mfma_f32_32x32x16_bf16 v[128:143], v[192:195], v[56:59], v[128:143]
    buffer_load_dwordx4 v[80:83], v222, s[4:7], s45 offen offset:0 sc1
    ds_read_b128 v[184:187], v1 offset:26624
    v_mfma_f32_32x32x16_bf16 v[144:159], v[56:59], v[196:199], v[144:159]
    ds_read_b128 v[188:191], v1 offset:27648
    s_waitcnt vmcnt(9) lgkmcnt(4)
    v_mfma_f32_32x32x16_bf16 v[128:143], v[200:203], v[60:63], v[128:143]
    buffer_load_dwordx4 v[84:87], v222, s[4:7], s45 offen offset:1024 sc1
    ds_read_b128 v[192:195], v1 offset:28672
    v_mfma_f32_32x32x16_bf16 v[144:159], v[60:63], v[204:207], v[144:159]
    ds_read_b128 v[196:199], v1 offset:29696
    s_waitcnt vmcnt(8) lgkmcnt(4)
    v_mfma_f32_32x32x16_bf16 v[128:143], v[176:179], v[64:67], v[128:143]
    buffer_load_dwordx4 v[88:91], v222, s[4:7], s45 offen offset:2048 sc1
    ds_read_b128 v[200:203], v1 offset:30720
    v_mfma_f32_32x32x16_bf16 v[144:159], v[64:67], v[180:183], v[144:159]
    ds_read_b128 v[204:207], v1 offset:31744
    s_waitcnt vmcnt(7) lgkmcnt(4)
    v_mfma_f32_32x32x16_bf16 v[128:143], v[184:187], v[68:71], v[128:143]
    buffer_load_dwordx4 v[92:95], v222, s[4:7], s45 offen offset:3072 sc1
    ds_read_b128 v[176:179], v1 offset:32768
    v_mfma_f32_32x32x16_bf16 v[144:159], v[68:71], v[188:191], v[144:159]
    ds_read_b128 v[180:183], v1 offset:33792
    s_waitcnt vmcnt(6) lgkmcnt(4)
    v_mfma_f32_32x32x16_bf16 v[128:143], v[192:195], v[72:75], v[128:143]
    buffer_load_dwordx4 v[96:99], v222, s[4:7], s46 offen offset:0 sc1
    s_waitcnt vmcnt(6)
    ds_read_b128 v[184:187], v1 offset:34816
    v_mfma_f32_32x32x16_bf16 v[144:159], v[72:75], v[196:199], v[144:159]
    v_add_f32 v8, v8, v9
    v_add_f32 v10, v10, v11
    ds_read_b128 v[188:191], v1 offset:35840
    s_waitcnt vmcnt(5) lgkmcnt(4)
    v_mfma_f32_32x32x16_bf16 v[128:143], v[200:203], v[76:79], v[128:143]
    buffer_load_dwordx4 v[100:103], v222, s[4:7], s46 offen offset:1024 sc1
    v_add_f32 v12, v12, v13
    ds_read_b128 v[192:195], v1 offset:36864
    v_mfma_f32_32x32x16_bf16 v[144:159], v[76:79], v[204:207], v[144:159]
    v_add_f32 v14, v14, v15
    v_add_f32 v216, v216, v217
    ds_read_b128 v[196:199], v1 offset:37888
    s_waitcnt vmcnt(5) lgkmcnt(4)
    v_mfma_f32_32x32x16_bf16 v[128:143], v[176:179], v[80:83], v[128:143]
    buffer_load_dwordx4 v[104:107], v222, s[4:7], s46 offen offset:2048 sc1
    v_add_f32 v218, v218, v219
    ds_read_b128 v[200:203], v1 offset:38912
    v_mfma_f32_32x32x16_bf16 v[144:159], v[80:83], v[180:183], v[144:159]
    v_add_f32 v220, v220, v221
    v_add_f32 v8, v8, v10
    ds_read_b128 v[204:207], v1 offset:39936
    s_waitcnt vmcnt(5) lgkmcnt(4)
    v_mfma_f32_32x32x16_bf16 v[128:143], v[184:187], v[84:87], v[128:143]
    buffer_load_dwordx4 v[108:111], v222, s[4:7], s46 offen offset:3072 sc1
    v_add_f32 v12, v12, v14
    ds_read_b128 v[176:179], v1 offset:40960
    v_mfma_f32_32x32x16_bf16 v[144:159], v[84:87], v[188:191], v[144:159]
    v_add_f32 v216, v216, v218
    v_add_f32 v8, v8, v12
    ds_read_b128 v[180:183], v1 offset:41984
    s_waitcnt vmcnt(5) lgkmcnt(4)
    v_mfma_f32_32x32x16_bf16 v[128:143], v[192:195], v[88:91], v[128:143]
    buffer_load_dwordx4 v[112:115], v222, s[4:7], s47 offen offset:0 sc1
    v_add_f32 v216, v216, v220
    ds_read_b128 v[184:187], v1 offset:43008
    v_mfma_f32_32x32x16_bf16 v[144:159], v[88:91], v[196:199], v[144:159]
    v_add_f32 v8, v8, v216
    v_mul_f32 v8, 0x3b124925, v8
    ds_read_b128 v[188:191], v1 offset:44032
    s_waitcnt vmcnt(5) lgkmcnt(4)
    v_mfma_f32_32x32x16_bf16 v[128:143], v[200:203], v[92:95], v[128:143]
    buffer_load_dwordx4 v[116:119], v222, s[4:7], s47 offen offset:1024 sc1
    v_mov_b32 v9, v8
    s_nop 1
    ds_read_b128 v[192:195], v1 offset:45056
    v_mfma_f32_32x32x16_bf16 v[144:159], v[92:95], v[204:207], v[144:159]
    v_permlane32_swap_b32 v8, v9
    v_fma_f32 v10, -v8, v8, v9
    ds_read_b128 v[196:199], v1 offset:46080
    s_waitcnt vmcnt(5) lgkmcnt(4)
    v_mfma_f32_32x32x16_bf16 v[128:143], v[176:179], v[96:99], v[128:143]
    buffer_load_dwordx4 v[120:123], v222, s[4:7], s47 offen offset:2048 sc1
    v_max_f32 v10, 0, v10
    ds_read_b128 v[200:203], v1 offset:47104
    v_mfma_f32_32x32x16_bf16 v[144:159], v[96:99], v[180:183], v[144:159]
    v_add_f32 v10, 0x3727c5ac, v10
    v_rsq_f32 v212, v10
    ds_read_b128 v[204:207], v1 offset:48128
    s_waitcnt vmcnt(5) lgkmcnt(4)
    v_mfma_f32_32x32x16_bf16 v[128:143], v[184:187], v[100:103], v[128:143]
    buffer_load_dwordx4 v[124:127], v222, s[4:7], s47 offen offset:3072 sc1
    v_cvt_pk_bf16_f32 v208, -v8, -v8
    ds_read_b128 v[176:179], v1 offset:49152
    v_mfma_f32_32x32x16_bf16 v[144:159], v[100:103], v[188:191], v[144:159]
    v_mul_f32 v10, v10, v212
    v_lshlrev_b32 v11, 16, v208
    ds_read_b128 v[180:183], v1 offset:50176
    s_waitcnt vmcnt(5) lgkmcnt(4)
    v_mfma_f32_32x32x16_bf16 v[128:143], v[192:195], v[104:107], v[128:143]
    v_add_f32 v11, v8, v11
    ds_read_b128 v[184:187], v1 offset:51200
    v_mfma_f32_32x32x16_bf16 v[144:159], v[104:107], v[196:199], v[144:159]
    v_cvt_pk_bf16_f32 v209, -v11, -v11
    v_cvt_pk_bf16_f32 v12, v10, v10
    ds_read_b128 v[188:191], v1 offset:52224
    s_waitcnt vmcnt(4) lgkmcnt(4)
    v_mfma_f32_32x32x16_bf16 v[128:143], v[200:203], v[108:111], v[128:143]
    v_lshlrev_b32 v12, 16, v12
    ds_read_b128 v[192:195], v1 offset:53248
    v_mfma_f32_32x32x16_bf16 v[144:159], v[108:111], v[204:207], v[144:159]
    v_sub_f32 v12, v10, v12
    v_cvt_pk_bf16_f32 v210, v10, v12
    ds_read_b128 v[196:199], v1 offset:54272
    s_waitcnt vmcnt(3) lgkmcnt(4)
    v_mfma_f32_32x32x16_bf16 v[128:143], v[176:179], v[112:115], v[128:143]
    v_mov_b32 v211, 0
    ds_read_b128 v[200:203], v1 offset:55296
    v_mfma_f32_32x32x16_bf16 v[144:159], v[112:115], v[180:183], v[144:159]
    v_mul_f32 v214, 0x3e8b97f6, v212
    v_and_b32 v14, 31, v0
    ds_read_b128 v[204:207], v1 offset:56320
    s_waitcnt vmcnt(2) lgkmcnt(4)
    v_mfma_f32_32x32x16_bf16 v[128:143], v[184:187], v[116:119], v[128:143]
    s_mul_i32 s11, s8, 12288
    ds_read_b128 v[176:179], v1 offset:57344
    v_mfma_f32_32x32x16_bf16 v[144:159], v[116:119], v[188:191], v[144:159]
    s_add_u32 s11, s11, 125952
    v_lshl_add_u32 v14, v14, 2, s11
    ds_read_b128 v[180:183], v1 offset:58368
    s_waitcnt vmcnt(1) lgkmcnt(4)
    v_mfma_f32_32x32x16_bf16 v[128:143], v[192:195], v[120:123], v[128:143]
    ds_write_b32 v14, v212
    ds_read_b128 v[184:187], v1 offset:59392
    v_mfma_f32_32x32x16_bf16 v[144:159], v[120:123], v[196:199], v[144:159]
    v_lshrrev_b32 v15, 5, v0
    v_lshl_add_u32 v15, v15, 4, s11
    ds_read_b128 v[188:191], v1 offset:60416
    s_waitcnt vmcnt(0) lgkmcnt(5)
    v_mfma_f32_32x32x16_bf16 v[128:143], v[200:203], v[124:127], v[128:143]
    ds_read_b128 v[240:243], v15 offset:0
    ds_read_b128 v[192:195], v1 offset:61440
    v_mfma_f32_32x32x16_bf16 v[144:159], v[124:127], v[204:207], v[144:159]
    ds_read_b128 v[244:247], v15 offset:32
    ds_read_b128 v[248:251], v15 offset:64
    ds_read_b128 v[196:199], v1 offset:62464
    ds_read_b128 v[252:255], v15 offset:96
    s_nop 1
    s_waitcnt lgkmcnt(9)
    v_mfma_f32_32x32x16_bf16 v[128:143], v[176:179], v[208:211], v[128:143]
    ds_read_b128 v[200:203], v1 offset:63488
    v_mfma_f32_32x32x16_bf16 v[144:159], v[208:211], v[180:183], v[144:159]
    ds_read_b128 v[204:207], v1 offset:64512
    s_add_u32 s9, s48, 4194304
    s_mov_b32 s10, 0x10000000
    s_mov_b32 s11, 0x10000000
    v_mov_b32 v8, 0x3f803f80
    v_mov_b32 v9, 0x3f80
    v_cndmask_b32 v10, 0, v8, s[10:11]
    s_mov_b32 s10, 0xf0000000
    s_mov_b32 s11, 0xf0000000
    s_nop 3
    v_pk_mul_f32 v[128:129], v[128:129], v[212:213] op_sel_hi:[1,0]
    v_pk_mul_f32 v[130:131], v[130:131], v[212:213] op_sel_hi:[1,0]
    v_pk_mul_f32 v[132:133], v[132:133], v[212:213] op_sel_hi:[1,0]
    v_pk_mul_f32 v[134:135], v[134:135], v[212:213] op_sel_hi:[1,0]
    v_pk_mul_f32 v[136:137], v[136:137], v[212:213] op_sel_hi:[1,0]
    v_pk_mul_f32 v[138:139], v[138:139], v[212:213] op_sel_hi:[1,0]
    v_pk_mul_f32 v[140:141], v[140:141], v[212:213] op_sel_hi:[1,0]
    v_pk_mul_f32 v[142:143], v[142:143], v[212:213] op_sel_hi:[1,0]
    v_cvt_pk_bf16_f32 v160, v128, v129
    v_cvt_pk_bf16_f32 v161, v130, v131
    v_cvt_pk_bf16_f32 v162, v132, v133
    v_cvt_pk_bf16_f32 v163, v134, v135
    buffer_store_dwordx4 v[160:163], v1, s[4:7], s9 offen offset:0 sc1
    v_cvt_pk_bf16_f32 v164, v136, v137
    v_cvt_pk_bf16_f32 v165, v138, v139
    v_cvt_pk_bf16_f32 v166, v140, v141
    v_cvt_pk_bf16_f32 v167, v142, v143
    v_cndmask_b32 v166, v166, v8, s[36:37]
    v_cndmask_b32 v167, v167, v9, s[36:37]
    buffer_store_dwordx4 v[164:167], v1, s[4:7], s9 offen offset:1024 sc1
    s_waitcnt lgkmcnt(2)
    v_pk_mul_f32 v[144:145], v[144:145], v[240:241]
    v_pk_mul_f32 v[146:147], v[146:147], v[242:243]
    v_pk_mul_f32 v[148:149], v[148:149], v[244:245]
    v_pk_mul_f32 v[150:151], v[150:151], v[246:247]
    v_pk_mul_f32 v[152:153], v[152:153], v[248:249]
    v_pk_mul_f32 v[154:155], v[154:155], v[250:251]
    v_pk_mul_f32 v[156:157], v[156:157], v[252:253]
    v_pk_mul_f32 v[158:159], v[158:159], v[254:255]
    v_cvt_pk_bf16_f32 v168, v144, v145
    v_cndmask_b32 v168, v168, v10, s[10:11]
    v_cvt_pk_bf16_f32 v169, v146, v147
    v_cndmask_b32 v169, v169, v10, s[10:11]
    v_cvt_pk_bf16_f32 v170, v148, v149
    v_cndmask_b32 v170, v170, v10, s[10:11]
    v_cvt_pk_bf16_f32 v171, v150, v151
    v_cndmask_b32 v171, v171, v10, s[10:11]
    buffer_store_dwordx4 v[168:171], v1, s[4:7], s9 offen offset:2048 sc1
    v_cvt_pk_bf16_f32 v172, v152, v153
    v_cndmask_b32 v172, v172, v10, s[10:11]
    v_cvt_pk_bf16_f32 v173, v154, v155
    v_cndmask_b32 v173, v173, v10, s[10:11]
    v_cvt_pk_bf16_f32 v174, v156, v157
    v_cndmask_b32 v174, v174, v10, s[10:11]
    v_cvt_pk_bf16_f32 v175, v158, v159
    v_cndmask_b32 v175, v175, v10, s[10:11]
    buffer_store_dwordx4 v[172:175], v1, s[4:7], s9 offen offset:3072 sc1
    v_mfma_f32_32x32x16_bf16 v[224:239], v[184:187], v[16:19], 0
    ds_read_b128 v[176:179], v2 offset:0
    v_mfma_f32_32x32x16_bf16 v[224:239], v[188:191], v[20:23], v[224:239]
    ds_read_b128 v[180:183], v2 offset:1024
    v_mfma_f32_32x32x16_bf16 v[224:239], v[192:195], v[24:27], v[224:239]
    ds_read_b128 v[184:187], v2 offset:2048
    v_mfma_f32_32x32x16_bf16 v[224:239], v[196:199], v[28:31], v[224:239]
    ds_read_b128 v[188:191], v2 offset:3072
    s_waitcnt lgkmcnt(5)
    v_mfma_f32_32x32x16_bf16 v[224:239], v[200:203], v[32:35], v[224:239]
    ds_read_b128 v[192:195], v2 offset:4096
    s_waitcnt lgkmcnt(5)
    v_mfma_f32_32x32x16_bf16 v[224:239], v[204:207], v[36:39], v[224:239]
    ds_read_b128 v[196:199], v2 offset:5120
    s_waitcnt lgkmcnt(5)
    v_mfma_f32_32x32x16_bf16 v[224:239], v[176:179], v[40:43], v[224:239]
    ds_read_b128 v[200:203], v2 offset:6144
    s_waitcnt lgkmcnt(5)
    v_mfma_f32_32x32x16_bf16 v[224:239], v[180:183], v[44:47], v[224:239]
    ds_read_b128 v[204:207], v2 offset:7168
    s_waitcnt lgkmcnt(5)
    v_mfma_f32_32x32x16_bf16 v[224:239], v[184:187], v[48:51], v[224:239]
    ds_read_b128 v[176:179], v2 offset:8192
    s_waitcnt lgkmcnt(5)
    v_mfma_f32_32x32x16_bf16 v[224:239], v[188:191], v[52:55], v[224:239]
    ds_read_b128 v[180:183], v2 offset:9216
    s_waitcnt lgkmcnt(5)
    v_mfma_f32_32x32x16_bf16 v[224:239], v[192:195], v[56:59], v[224:239]
    ds_read_b128 v[184:187], v2 offset:10240
    s_waitcnt lgkmcnt(5)
    v_mfma_f32_32x32x16_bf16 v[224:239], v[196:199], v[60:63], v[224:239]
    ds_read_b128 v[188:191], v2 offset:11264
    s_waitcnt lgkmcnt(5)
    v_mfma_f32_32x32x16_bf16 v[224:239], v[200:203], v[64:67], v[224:239]
    ds_read_b128 v[192:195], v2 offset:12288
    s_waitcnt lgkmcnt(5)
    v_mfma_f32_32x32x16_bf16 v[224:239], v[204:207], v[68:71], v[224:239]
    ds_read_b128 v[196:199], v2 offset:13312
    s_waitcnt lgkmcnt(5)
    v_mfma_f32_32x32x16_bf16 v[224:239], v[176:179], v[72:75], v[224:239]
    ds_read_b128 v[200:203], v2 offset:14336
    s_waitcnt lgkmcnt(5)
    v_mfma_f32_32x32x16_bf16 v[224:239], v[180:183], v[76:79], v[224:239]
    ds_read_b128 v[204:207], v2 offset:15360
    s_waitcnt lgkmcnt(5)
    v_mfma_f32_32x32x16_bf16 v[224:239], v[184:187], v[80:83], v[224:239]
    ds_read_b128 v[176:179], v2 offset:16384
    s_waitcnt lgkmcnt(5)
    v_mfma_f32_32x32x16_bf16 v[224:239], v[188:191], v[84:87], v[224:239]
    ds_read_b128 v[180:183], v2 offset:17408
    s_waitcnt lgkmcnt(5)
    v_mfma_f32_32x32x16_bf16 v[224:239], v[192:195], v[88:91], v[224:239]
    ds_read_b128 v[184:187], v2 offset:18432
    v_mov_b32 v255, 1
    s_mov_b64 exec, 1
    s_waitcnt vmcnt(0)
    buffer_atomic_add v255, off, s[4:7], s49 offset:128 sc1
    s_mov_b64 exec, -1
    s_waitcnt lgkmcnt(5)
    v_mfma_f32_32x32x16_bf16 v[224:239], v[196:199], v[92:95], v[224:239]
    ds_read_b128 v[188:191], v2 offset:19456
    s_waitcnt lgkmcnt(5)
    v_mfma_f32_32x32x16_bf16 v[224:239], v[200:203], v[96:99], v[224:239]
    ds_read_b128 v[192:195], v2 offset:20480
    s_waitcnt lgkmcnt(5)
    v_mfma_f32_32x32x16_bf16 v[224:239], v[204:207], v[100:103], v[224:239]
    ds_read_b128 v[196:199], v2 offset:21504
    s_waitcnt lgkmcnt(5)
    v_mfma_f32_32x32x16_bf16 v[224:239], v[176:179], v[104:107], v[224:239]
    ds_read_b128 v[200:203], v2 offset:22528
    s_waitcnt lgkmcnt(5)
    v_mfma_f32_32x32x16_bf16 v[224:239], v[180:183], v[108:111], v[224:239]
    s_waitcnt lgkmcnt(4)
    v_mfma_f32_32x32x16_bf16 v[224:239], v[184:187], v[112:115], v[224:239]
    s_waitcnt lgkmcnt(3)
    v_mfma_f32_32x32x16_bf16 v[224:239], v[188:191], v[116:119], v[224:239]
    s_waitcnt lgkmcnt(2)
    v_mfma_f32_32x32x16_bf16 v[224:239], v[192:195], v[120:123], v[224:239]
    s_waitcnt lgkmcnt(1)
    v_mfma_f32_32x32x16_bf16 v[224:239], v[196:199], v[124:127], v[224:239]
    s_waitcnt lgkmcnt(0)
    v_mfma_f32_32x32x16_bf16 v[224:239], v[200:203], v[208:211], v[224:239]
    s_nop 7
    s_nop 3
    v_pk_mul_f32 v[224:225], v[224:225], v[214:215] op_sel_hi:[1,0]
    v_pk_mul_f32 v[226:227], v[226:227], v[214:215] op_sel_hi:[1,0]
    v_pk_mul_f32 v[228:229], v[228:229], v[214:215] op_sel_hi:[1,0]
    v_pk_mul_f32 v[230:231], v[230:231], v[214:215] op_sel_hi:[1,0]
    v_pk_mul_f32 v[232:233], v[232:233], v[214:215] op_sel_hi:[1,0]
    v_pk_mul_f32 v[234:235], v[234:235], v[214:215] op_sel_hi:[1,0]
    v_pk_mul_f32 v[236:237], v[236:237], v[214:215] op_sel_hi:[1,0]
    v_pk_mul_f32 v[238:239], v[238:239], v[214:215] op_sel_hi:[1,0]
    v_cvt_pk_bf16_f32 v32, v224, v225
    v_cvt_pk_bf16_f32 v33, v226, v227
    v_cvt_pk_bf16_f32 v34, v228, v229
    v_cvt_pk_bf16_f32 v35, v230, v231
    ds_write_b128 v7, v[32:35] offset:8192
    v_cvt_pk_bf16_f32 v36, v232, v233
    v_cvt_pk_bf16_f32 v37, v234, v235
    v_cvt_pk_bf16_f32 v38, v236, v237
    v_cvt_pk_bf16_f32 v39, v238, v239
    v_cndmask_b32 v38, v38, 0, s[36:37]
    v_cndmask_b32 v39, v39, 0, s[36:37]
    ds_write_b128 v7, v[36:39] offset:9216
    s_waitcnt lgkmcnt(0)
    s_barrier
    ds_read_b128 v[8:11], v6 offset:0
    ds_read_b128 v[12:15], v6 offset:1024
    ds_read_b128 v[16:19], v5 offset:4096
    ds_read_b128 v[20:23], v5 offset:5120
    ds_read_b128 v[24:27], v4 offset:8192
    ds_read_b128 v[28:31], v4 offset:9216
    v_mov_b32 v255, 0
    s_mov_b64 exec, 1
    buffer_atomic_add v255, off, s[4:7], s49 offset:128 sc0 sc1
    s_mov_b64 exec, -1
    s_mov_b32 s61, 0
    v_mfma_f32_32x32x16_bf16 v[104:119], v[160:163], v[32:35], 0
    v_mfma_f32_32x32x16_bf16 v[104:119], v[164:167], v[36:39], v[104:119]
    s_waitcnt lgkmcnt(4)
    v_mfma_f32_32x32x16_bf16 v[120:135], v[160:163], v[8:11], 0
    v_mfma_f32_32x32x16_bf16 v[120:135], v[164:167], v[12:15], v[120:135]
    s_lshl_b32 s9, s26, 6
    s_add_u32 s9, s9, s8
    s_lshl_b32 s9, s9, 12
    s_add_u32 s9, s9, 4194304
    v_add_u32 v241, s9, v1
    s_mul_i32 s9, s33, 118784
    s_add_u32 s9, s9, 10276864
    s_add_u32 s62, s9, 114688
    s_mul_i32 s63, s8, 28672
    v_max3_f32 v227, v104, v105, v106
    v_max3_f32 v227, v227, v107, v108
    v_max3_f32 v227, v227, v109, v110
    v_max3_f32 v227, v227, v111, v112
    v_max3_f32 v227, v227, v113, v114
    v_max3_f32 v227, v227, v115, v116
    v_max3_f32 v227, v227, v117, v118
    v_max_f32 v227, v227, v119
    s_waitcnt lgkmcnt(2)
    v_mfma_f32_32x32x16_bf16 v[104:119], v[160:163], v[16:19], 0
    v_mfma_f32_32x32x16_bf16 v[104:119], v[164:167], v[20:23], v[104:119]
    s_add_u32 s9, s9, s63
    v_add_u32 v242, s9, v1
    v_max3_f32 v224, v120, v121, v122
    v_max3_f32 v224, v224, v123, v124
    v_max3_f32 v224, v224, v125, v126
    v_max3_f32 v224, v224, v127, v128
    v_max3_f32 v224, v224, v129, v130
    v_max3_f32 v224, v224, v131, v132
    v_max3_f32 v224, v224, v133, v134
    v_max_f32 v224, v224, v135
    s_waitcnt lgkmcnt(0)
    v_mfma_f32_32x32x16_bf16 v[120:135], v[160:163], v[24:27], 0
    v_mfma_f32_32x32x16_bf16 v[120:135], v[164:167], v[28:31], v[120:135]
    s_nop 0
    v_max3_f32 v225, v104, v105, v106
    v_max3_f32 v225, v225, v107, v108
    v_max3_f32 v225, v225, v109, v110
    v_max3_f32 v225, v225, v111, v112
    v_max3_f32 v225, v225, v113, v114
    v_max3_f32 v225, v225, v115, v116
    v_max3_f32 v225, v225, v117, v118
    v_max_f32 v225, v225, v119
    s_lshl_b32 s9, s31, 15
    s_lshl_b32 s10, s8, 13
    s_add_u32 s10, s10, 9818112
    v_max3_f32 v226, v120, v121, v122
    v_max3_f32 v226, v226, v123, v124
    v_max3_f32 v226, v226, v125, v126
    v_max3_f32 v226, v226, v127, v128
    v_max3_f32 v226, v226, v129, v130
    v_max3_f32 v226, v226, v131, v132
    v_max3_f32 v226, v226, v133, v134
    v_max_f32 v226, v226, v135
    s_mov_b32 exec_lo, 0
    v_cvt_pk_bf16_f32 v14, -v224, 0
    v_cvt_pk_bf16_f32 v22, -v225, 0
    v_cvt_pk_bf16_f32 v30, -v226, 0
    v_cvt_pk_bf16_f32 v38, -v227, 0
    v_lshlrev_b32 v224, 16, v14
    v_lshlrev_b32 v225, 16, v22
    v_lshlrev_b32 v226, 16, v30
    v_lshlrev_b32 v227, 16, v38
    s_mov_b32 exec_lo, -1
    s_add_u32 s11, s9, s10
    v_add_u32 v245, s11, v1
    s_xor_b32 s9, s9, 32768
    s_add_u32 s11, s9, s10
    v_add_u32 v246, s11, v1
    v_lshlrev_b32 v251, 7, v0
    v_and_b32 v252, 0x780, v251
    v_and_b32 v254, 0x180, v251
    v_bfe_u32 v253, v0, 2, 2
    v_lshlrev_b32 v253, 13, v253
    v_lshl_add_u32 v253, v254, 1, v253
    s_barrier
    s_mov_b64 exec, 1
    s_branch L_kvchk_43
L_kvpoll_42:
    v_mov_b32 v255, 0
    buffer_atomic_add v255, off, s[4:7], s49 offset:128 sc0 sc1
L_kvchk_43:
    s_waitcnt vmcnt(0)
    v_cmp_gt_u32 vcc, 16, v255
    s_cbranch_vccz L_kvdone_44
    s_sub_u32 s25, s25, 1
    s_cmp_gt_i32 s25, 0
    s_cbranch_scc1 L_kvpoll_42
    s_mov_b32 s25, 0
L_kvdone_44:
    s_mov_b64 exec, -1
    s_waitcnt lgkmcnt(0)
    s_lshl_b32 s9, s27, 14
    s_mov_b32 m0, s63
    s_add_u32 s10, s9, 16384
    s_and_b32 s10, s10, 0x3c000
    buffer_load_dwordx4 v[176:179], v241, s[4:7], s10 offen offset:0 sc1
    buffer_load_dwordx4 v[180:183], v241, s[4:7], s10 offen offset:1024 sc1
    buffer_load_dwordx4 v[184:187], v241, s[4:7], s10 offen offset:2048 sc1
    buffer_load_dwordx4 v[188:191], v241, s[4:7], s10 offen offset:3072 sc1
    s_add_u32 s9, s10, 16384
    s_and_b32 s9, s9, 0x3c000
    buffer_load_dwordx4 v[192:195], v241, s[4:7], s9 offen offset:0 sc1
    buffer_load_dwordx4 v[196:199], v241, s[4:7], s9 offen offset:1024 sc1
L_attn_restart_45:
    v_mfma_f32_32x32x16_bf16 v[104:119], v[160:163], v[8:11], 0
    v_mfma_f32_32x32x16_bf16 v[104:119], v[164:167], v[12:15], v[104:119]
    s_nop 7
    s_nop 2
    v_mfma_f32_32x32x16_bf16 v[120:135], v[160:163], v[16:19], 0
    buffer_load_dwordx4 v[200:203], v241, s[4:7], s9 offen offset:2048 sc1
    v_exp_f32 v136, v104
    v_exp_f32 v137, v105
    v_exp_f32 v138, v106
    v_cvt_pk_bf16_f32 v144, v136, v137
    v_exp_f32 v139, v107
    v_mfma_f32_32x32x16_bf16 v[120:135], v[164:167], v[20:23], v[120:135]
    buffer_load_dwordx4 v[204:207], v241, s[4:7], s9 offen offset:3072 sc1
    s_add_u32 s10, s9, 16384
    s_and_b32 s10, s10, 0x3c000
    v_exp_f32 v140, v108
    v_cvt_pk_bf16_f32 v145, v138, v139
    v_exp_f32 v141, v109
    v_exp_f32 v142, v110
    v_cvt_pk_bf16_f32 v146, v140, v141
    v_exp_f32 v143, v111
    v_exp_f32 v136, v112
    v_cvt_pk_bf16_f32 v147, v142, v143
    v_exp_f32 v137, v113
    v_exp_f32 v138, v114
    v_cvt_pk_bf16_f32 v148, v136, v137
    v_exp_f32 v139, v115
    v_exp_f32 v140, v116
    v_cvt_pk_bf16_f32 v149, v138, v139
    v_exp_f32 v141, v117
    v_exp_f32 v142, v118
    v_cvt_pk_bf16_f32 v150, v140, v141
    v_exp_f32 v143, v119
    v_mfma_f32_32x32x16_bf16 v[104:119], v[160:163], v[24:27], 0
    buffer_load_dwordx4 v[208:211], v241, s[4:7], s10 offen offset:0 sc1
    v_cvt_pk_bf16_f32 v151, v142, v143
    v_exp_f32 v136, v120
    v_exp_f32 v137, v121
    v_exp_f32 v138, v122
    v_cvt_pk_bf16_f32 v152, v136, v137
    v_exp_f32 v139, v123
    v_mfma_f32_32x32x16_bf16 v[104:119], v[164:167], v[28:31], v[104:119]
    buffer_load_dwordx4 v[212:215], v241, s[4:7], s10 offen offset:1024 sc1
    v_exp_f32 v140, v124
    v_cvt_pk_bf16_f32 v153, v138, v139
    v_exp_f32 v141, v125
    v_exp_f32 v142, v126
    v_cvt_pk_bf16_f32 v154, v140, v141
    v_exp_f32 v143, v127
    v_mfma_f32_32x32x16_bf16 v[40:55], v[168:171], v[144:147], 0
    buffer_load_dwordx4 v[216:219], v241, s[4:7], s10 offen offset:2048 sc1
    v_exp_f32 v136, v128
    v_cvt_pk_bf16_f32 v155, v142, v143
    v_exp_f32 v137, v129
    v_exp_f32 v138, v130
    v_cvt_pk_bf16_f32 v156, v136, v137
    v_exp_f32 v139, v131
    v_mfma_f32_32x32x16_bf16 v[40:55], v[172:175], v[148:151], v[40:55]
    buffer_load_dwordx4 v[220:223], v241, s[4:7], s10 offen offset:3072 sc1
    s_add_u32 s9, s10, 16384
    v_exp_f32 v140, v132
    v_cvt_pk_bf16_f32 v157, v138, v139
    v_exp_f32 v141, v133
    v_exp_f32 v142, v134
    v_cvt_pk_bf16_f32 v158, v140, v141
    v_exp_f32 v143, v135
    v_mfma_f32_32x32x16_bf16 v[120:135], v[160:163], v[32:35], 0
    s_and_b32 s9, s9, 0x3c000
    v_cvt_pk_bf16_f32 v159, v142, v143
    v_exp_f32 v136, v104
    v_exp_f32 v137, v105
    v_exp_f32 v138, v106
    v_cvt_pk_bf16_f32 v144, v136, v137
    v_exp_f32 v139, v107
    v_mfma_f32_32x32x16_bf16 v[120:135], v[164:167], v[36:39], v[120:135]
    buffer_load_dwordx4 v[160:163], v241, s[4:7], s9 offen offset:0 sc1
    v_exp_f32 v140, v108
    v_cvt_pk_bf16_f32 v145, v138, v139
    v_exp_f32 v141, v109
    v_exp_f32 v142, v110
    v_cvt_pk_bf16_f32 v146, v140, v141
    v_exp_f32 v143, v111
    v_mfma_f32_32x32x16_bf16 v[56:71], v[168:171], v[152:155], 0
    v_exp_f32 v136, v112
    v_cvt_pk_bf16_f32 v147, v142, v143
    v_exp_f32 v137, v113
    v_exp_f32 v138, v114
    v_cvt_pk_bf16_f32 v148, v136, v137
    v_exp_f32 v139, v115
    v_mfma_f32_32x32x16_bf16 v[56:71], v[172:175], v[156:159], v[56:71]
    buffer_load_dwordx4 v[164:167], v241, s[4:7], s9 offen offset:1024 sc1
    s_waitcnt vmcnt(12)
    v_exp_f32 v140, v116
    v_cvt_pk_bf16_f32 v149, v138, v139
    v_exp_f32 v141, v117
    v_exp_f32 v142, v118
    v_cvt_pk_bf16_f32 v150, v140, v141
    v_exp_f32 v143, v119
    v_mfma_f32_32x32x16_bf16 v[104:119], v[176:179], v[8:11], 0
    v_cvt_pk_bf16_f32 v151, v142, v143
    v_exp_f32 v136, v120
    v_exp_f32 v137, v121
    v_exp_f32 v138, v122
    v_cvt_pk_bf16_f32 v152, v136, v137
    v_exp_f32 v139, v123
    v_mfma_f32_32x32x16_bf16 v[104:119], v[180:183], v[12:15], v[104:119]
    v_exp_f32 v140, v124
    v_cvt_pk_bf16_f32 v153, v138, v139
    v_exp_f32 v141, v125
    v_exp_f32 v142, v126
    v_cvt_pk_bf16_f32 v154, v140, v141
    v_exp_f32 v143, v127
    v_mfma_f32_32x32x16_bf16 v[72:87], v[168:171], v[144:147], 0
    v_exp_f32 v136, v128
    v_cvt_pk_bf16_f32 v155, v142, v143
    v_exp_f32 v137, v129
    v_exp_f32 v138, v130
    v_cvt_pk_bf16_f32 v156, v136, v137
    v_exp_f32 v139, v131
    v_mfma_f32_32x32x16_bf16 v[72:87], v[172:175], v[148:151], v[72:87]
    v_exp_f32 v140, v132
    v_cvt_pk_bf16_f32 v157, v138, v139
    v_exp_f32 v141, v133
    v_exp_f32 v142, v134
    v_cvt_pk_bf16_f32 v158, v140, v141
    v_exp_f32 v143, v135
    v_mfma_f32_32x32x16_bf16 v[120:135], v[176:179], v[16:19], 0
    v_cvt_pk_bf16_f32 v159, v142, v143
    v_exp_f32 v136, v104
    v_exp_f32 v137, v105
    v_exp_f32 v138, v106
    v_cvt_pk_bf16_f32 v144, v136, v137
    v_exp_f32 v139, v107
    v_mfma_f32_32x32x16_bf16 v[120:135], v[180:183], v[20:23], v[120:135]
    v_exp_f32 v140, v108
    v_cvt_pk_bf16_f32 v145, v138, v139
    v_exp_f32 v141, v109
    v_exp_f32 v142, v110
    v_cvt_pk_bf16_f32 v146, v140, v141
    v_exp_f32 v143, v111
    v_mfma_f32_32x32x16_bf16 v[88:103], v[168:171], v[152:155], 0
    v_exp_f32 v136, v112
    v_cvt_pk_bf16_f32 v147, v142, v143
    v_exp_f32 v137, v113
    v_exp_f32 v138, v114
    v_cvt_pk_bf16_f32 v148, v136, v137
    v_exp_f32 v139, v115
    v_mfma_f32_32x32x16_bf16 v[88:103], v[172:175], v[156:159], v[88:103]
    buffer_load_dwordx4 v[168:171], v241, s[4:7], s9 offen offset:2048 sc1
    v_exp_f32 v140, v116
    v_cvt_pk_bf16_f32 v149, v138, v139
    v_exp_f32 v141, v117
    v_exp_f32 v142, v118
    v_cvt_pk_bf16_f32 v150, v140, v141
    v_exp_f32 v143, v119
    v_mfma_f32_32x32x16_bf16 v[104:119], v[176:179], v[24:27], 0
    v_cvt_pk_bf16_f32 v151, v142, v143
    v_exp_f32 v136, v120
    v_exp_f32 v137, v121
    v_exp_f32 v138, v122
    v_cvt_pk_bf16_f32 v152, v136, v137
    v_exp_f32 v139, v123
    v_mfma_f32_32x32x16_bf16 v[104:119], v[180:183], v[28:31], v[104:119]
    buffer_load_dwordx4 v[172:175], v241, s[4:7], s9 offen offset:3072 sc1
    s_waitcnt vmcnt(12)
    v_exp_f32 v140, v124
    v_cvt_pk_bf16_f32 v153, v138, v139
    v_exp_f32 v141, v125
    v_exp_f32 v142, v126
    v_cvt_pk_bf16_f32 v154, v140, v141
    v_exp_f32 v143, v127
    v_mfma_f32_32x32x16_bf16 v[40:55], v[184:187], v[144:147], v[40:55]
    v_exp_f32 v136, v128
    v_cvt_pk_bf16_f32 v155, v142, v143
    v_exp_f32 v137, v129
    v_exp_f32 v138, v130
    v_cvt_pk_bf16_f32 v156, v136, v137
    v_exp_f32 v139, v131
    v_mfma_f32_32x32x16_bf16 v[40:55], v[188:191], v[148:151], v[40:55]
    s_add_u32 s10, s9, 16384
    v_exp_f32 v140, v132
    v_cvt_pk_bf16_f32 v157, v138, v139
    v_exp_f32 v141, v133
    v_exp_f32 v142, v134
    v_cvt_pk_bf16_f32 v158, v140, v141
    v_exp_f32 v143, v135
    v_mfma_f32_32x32x16_bf16 v[120:135], v[176:179], v[32:35], 0
    s_and_b32 s10, s10, 0x3c000
    v_cvt_pk_bf16_f32 v159, v142, v143
    v_exp_f32 v136, v104
    v_exp_f32 v137, v105
    v_exp_f32 v138, v106
    v_cvt_pk_bf16_f32 v144, v136, v137
    v_exp_f32 v139, v107
    v_mfma_f32_32x32x16_bf16 v[120:135], v[180:183], v[36:39], v[120:135]
    buffer_load_dwordx4 v[176:179], v241, s[4:7], s10 offen offset:0 sc1
    v_exp_f32 v140, v108
    v_cvt_pk_bf16_f32 v145, v138, v139
    v_exp_f32 v141, v109
    v_exp_f32 v142, v110
    v_cvt_pk_bf16_f32 v146, v140, v141
    v_exp_f32 v143, v111
    v_mfma_f32_32x32x16_bf16 v[56:71], v[184:187], v[152:155], v[56:71]
    v_exp_f32 v136, v112
    v_cvt_pk_bf16_f32 v147, v142, v143
    v_exp_f32 v137, v113
    v_exp_f32 v138, v114
    v_cvt_pk_bf16_f32 v148, v136, v137
    v_exp_f32 v139, v115
    v_mfma_f32_32x32x16_bf16 v[56:71], v[188:191], v[156:159], v[56:71]
    buffer_load_dwordx4 v[180:183], v241, s[4:7], s10 offen offset:1024 sc1
    s_waitcnt vmcnt(12)
    v_exp_f32 v140, v116
    v_cvt_pk_bf16_f32 v149, v138, v139
    v_exp_f32 v141, v117
    v_exp_f32 v142, v118
    v_cvt_pk_bf16_f32 v150, v140, v141
    v_exp_f32 v143, v119
    v_mfma_f32_32x32x16_bf16 v[104:119], v[192:195], v[8:11], 0
    v_cvt_pk_bf16_f32 v151, v142, v143
    v_exp_f32 v136, v120
    v_exp_f32 v137, v121
    v_exp_f32 v138, v122
    v_cvt_pk_bf16_f32 v152, v136, v137
    v_exp_f32 v139, v123
    v_mfma_f32_32x32x16_bf16 v[104:119], v[196:199], v[12:15], v[104:119]
    v_exp_f32 v140, v124
    v_cvt_pk_bf16_f32 v153, v138, v139
    v_exp_f32 v141, v125
    v_exp_f32 v142, v126
    v_cvt_pk_bf16_f32 v154, v140, v141
    v_exp_f32 v143, v127
    v_mfma_f32_32x32x16_bf16 v[72:87], v[184:187], v[144:147], v[72:87]
    v_exp_f32 v136, v128
    v_cvt_pk_bf16_f32 v155, v142, v143
    v_exp_f32 v137, v129
    v_exp_f32 v138, v130
    v_cvt_pk_bf16_f32 v156, v136, v137
    v_exp_f32 v139, v131
    v_mfma_f32_32x32x16_bf16 v[72:87], v[188:191], v[148:151], v[72:87]
    v_exp_f32 v140, v132
    v_cvt_pk_bf16_f32 v157, v138, v139
    v_exp_f32 v141, v133
    v_exp_f32 v142, v134
    v_cvt_pk_bf16_f32 v158, v140, v141
    v_exp_f32 v143, v135
    v_mfma_f32_32x32x16_bf16 v[120:135], v[192:195], v[16:19], 0
    v_cvt_pk_bf16_f32 v159, v142, v143
    v_exp_f32 v136, v104
    v_exp_f32 v137, v105
    v_exp_f32 v138, v106
    v_cvt_pk_bf16_f32 v144, v136, v137
    v_exp_f32 v139, v107
    v_mfma_f32_32x32x16_bf16 v[120:135], v[196:199], v[20:23], v[120:135]
    v_exp_f32 v140, v108
    v_cvt_pk_bf16_f32 v145, v138, v139
    v_exp_f32 v141, v109
    v_exp_f32 v142, v110
    v_cvt_pk_bf16_f32 v146, v140, v141
    v_exp_f32 v143, v111
    v_mfma_f32_32x32x16_bf16 v[88:103], v[184:187], v[152:155], v[88:103]
    v_exp_f32 v136, v112
    v_cvt_pk_bf16_f32 v147, v142, v143
    v_exp_f32 v137, v113
    v_exp_f32 v138, v114
    v_cvt_pk_bf16_f32 v148, v136, v137
    v_exp_f32 v139, v115
    v_mfma_f32_32x32x16_bf16 v[88:103], v[188:191], v[156:159], v[88:103]
    buffer_load_dwordx4 v[184:187], v241, s[4:7], s10 offen offset:2048 sc1
    v_exp_f32 v140, v116
    v_cvt_pk_bf16_f32 v149, v138, v139
    v_exp_f32 v141, v117
    v_exp_f32 v142, v118
    v_cvt_pk_bf16_f32 v150, v140, v141
    v_exp_f32 v143, v119
    v_mfma_f32_32x32x16_bf16 v[104:119], v[192:195], v[24:27], 0
    v_cvt_pk_bf16_f32 v151, v142, v143
    v_exp_f32 v136, v120
    v_exp_f32 v137, v121
    v_exp_f32 v138, v122
    v_cvt_pk_bf16_f32 v152, v136, v137
    v_exp_f32 v139, v123
    v_mfma_f32_32x32x16_bf16 v[104:119], v[196:199], v[28:31], v[104:119]
    buffer_load_dwordx4 v[188:191], v241, s[4:7], s10 offen offset:3072 sc1
    s_waitcnt vmcnt(12)
    v_exp_f32 v140, v124
    v_cvt_pk_bf16_f32 v153, v138, v139
    v_exp_f32 v141, v125
    v_exp_f32 v142, v126
    v_cvt_pk_bf16_f32 v154, v140, v141
    v_exp_f32 v143, v127
    v_mfma_f32_32x32x16_bf16 v[40:55], v[200:203], v[144:147], v[40:55]
    v_exp_f32 v136, v128
    v_cvt_pk_bf16_f32 v155, v142, v143
    v_exp_f32 v137, v129
    v_exp_f32 v138, v130
    v_cvt_pk_bf16_f32 v156, v136, v137
    v_exp_f32 v139, v131
    v_mfma_f32_32x32x16_bf16 v[40:55], v[204:207], v[148:151], v[40:55]
    s_add_u32 s9, s10, 16384
    v_exp_f32 v140, v132
    v_cvt_pk_bf16_f32 v157, v138, v139
    v_exp_f32 v141, v133
    v_exp_f32 v142, v134
    v_cvt_pk_bf16_f32 v158, v140, v141
    v_exp_f32 v143, v135
    v_mfma_f32_32x32x16_bf16 v[120:135], v[192:195], v[32:35], 0
    s_and_b32 s9, s9, 0x3c000
    v_cvt_pk_bf16_f32 v159, v142, v143
    v_exp_f32 v136, v104
    v_exp_f32 v137, v105
    v_exp_f32 v138, v106
    v_cvt_pk_bf16_f32 v144, v136, v137
    v_exp_f32 v139, v107
    v_mfma_f32_32x32x16_bf16 v[120:135], v[196:199], v[36:39], v[120:135]
    buffer_load_dwordx4 v[192:195], v241, s[4:7], s9 offen offset:0 sc1
    v_exp_f32 v140, v108
    v_cvt_pk_bf16_f32 v145, v138, v139
    v_exp_f32 v141, v109
    v_exp_f32 v142, v110
    v_cvt_pk_bf16_f32 v146, v140, v141
    v_exp_f32 v143, v111
    v_mfma_f32_32x32x16_bf16 v[56:71], v[200:203], v[152:155], v[56:71]
    s_waitcnt vmcnt(9)
    v_exp_f32 v136, v112
    v_cvt_pk_bf16_f32 v147, v142, v143
    v_exp_f32 v137, v113
    v_exp_f32 v138, v114
    v_cvt_pk_bf16_f32 v148, v136, v137
    v_exp_f32 v139, v115
    v_mfma_f32_32x32x16_bf16 v[56:71], v[204:207], v[156:159], v[56:71]
    buffer_load_dwordx4 v[196:199], v241, s[4:7], s9 offen offset:1024 sc1
    v_exp_f32 v140, v116
    v_cvt_pk_bf16_f32 v149, v138, v139
    v_exp_f32 v141, v117
    v_exp_f32 v142, v118
    v_cvt_pk_bf16_f32 v150, v140, v141
    v_exp_f32 v143, v119
    v_mfma_f32_32x32x16_bf16 v[104:119], v[208:211], v[8:11], 0
    v_cvt_pk_bf16_f32 v151, v142, v143
    v_exp_f32 v136, v120
    v_exp_f32 v137, v121
    v_exp_f32 v138, v122
    v_cvt_pk_bf16_f32 v152, v136, v137
    v_exp_f32 v139, v123
    v_mfma_f32_32x32x16_bf16 v[104:119], v[212:215], v[12:15], v[104:119]
    v_exp_f32 v140, v124
    v_cvt_pk_bf16_f32 v153, v138, v139
    v_exp_f32 v141, v125
    v_exp_f32 v142, v126
    v_cvt_pk_bf16_f32 v154, v140, v141
    v_exp_f32 v143, v127
    v_mfma_f32_32x32x16_bf16 v[72:87], v[200:203], v[144:147], v[72:87]
    v_exp_f32 v136, v128
    v_cvt_pk_bf16_f32 v155, v142, v143
    v_exp_f32 v137, v129
    v_exp_f32 v138, v130
    v_cvt_pk_bf16_f32 v156, v136, v137
    v_exp_f32 v139, v131
    v_mfma_f32_32x32x16_bf16 v[72:87], v[204:207], v[148:151], v[72:87]
    v_exp_f32 v140, v132
    v_cvt_pk_bf16_f32 v157, v138, v139
    v_exp_f32 v141, v133
    v_exp_f32 v142, v134
    v_cvt_pk_bf16_f32 v158, v140, v141
    v_exp_f32 v143, v135
    v_mfma_f32_32x32x16_bf16 v[120:135], v[208:211], v[16:19], 0
    v_cvt_pk_bf16_f32 v159, v142, v143
    v_exp_f32 v136, v104
    v_exp_f32 v137, v105
    v_exp_f32 v138, v106
    v_cvt_pk_bf16_f32 v144, v136, v137
    v_exp_f32 v139, v107
    v_mfma_f32_32x32x16_bf16 v[120:135], v[212:215], v[20:23], v[120:135]
    v_exp_f32 v140, v108
    v_cvt_pk_bf16_f32 v145, v138, v139
    v_exp_f32 v141, v109
    v_exp_f32 v142, v110
    v_cvt_pk_bf16_f32 v146, v140, v141
    v_exp_f32 v143, v111
    v_mfma_f32_32x32x16_bf16 v[88:103], v[200:203], v[152:155], v[88:103]
    v_exp_f32 v136, v112
    v_cvt_pk_bf16_f32 v147, v142, v143
    v_exp_f32 v137, v113
    v_exp_f32 v138, v114
    v_cvt_pk_bf16_f32 v148, v136, v137
    v_exp_f32 v139, v115
    v_mfma_f32_32x32x16_bf16 v[88:103], v[204:207], v[156:159], v[88:103]
    buffer_load_dwordx4 v[200:203], v241, s[4:7], s9 offen offset:2048 sc1
    v_exp_f32 v140, v116
    v_cvt_pk_bf16_f32 v149, v138, v139
    v_exp_f32 v141, v117
    v_exp_f32 v142, v118
    v_cvt_pk_bf16_f32 v150, v140, v141
    v_exp_f32 v143, v119
    v_mfma_f32_32x32x16_bf16 v[104:119], v[208:211], v[24:27], 0
    v_cvt_pk_bf16_f32 v151, v142, v143
    v_exp_f32 v136, v120
    v_exp_f32 v137, v121
    v_exp_f32 v138, v122
    v_cvt_pk_bf16_f32 v152, v136, v137
    v_exp_f32 v139, v123
    v_mfma_f32_32x32x16_bf16 v[104:119], v[212:215], v[28:31], v[104:119]
    buffer_load_dwordx4 v[204:207], v241, s[4:7], s9 offen offset:3072 sc1
    v_exp_f32 v140, v124
    v_cvt_pk_bf16_f32 v153, v138, v139
    v_exp_f32 v141, v125
    v_exp_f32 v142, v126
    v_cvt_pk_bf16_f32 v154, v140, v141
    v_exp_f32 v143, v127
    v_mfma_f32_32x32x16_bf16 v[40:55], v[216:219], v[144:147], v[40:55]
    v_exp_f32 v136, v128
    v_cvt_pk_bf16_f32 v155, v142, v143
    v_exp_f32 v137, v129
    v_exp_f32 v138, v130
    v_cvt_pk_bf16_f32 v156, v136, v137
    v_exp_f32 v139, v131
    v_mfma_f32_32x32x16_bf16 v[40:55], v[220:223], v[148:151], v[40:55]
    s_add_u32 s10, s9, 16384
    v_exp_f32 v140, v132
    v_cvt_pk_bf16_f32 v157, v138, v139
    v_exp_f32 v141, v133
    v_exp_f32 v142, v134
    v_cvt_pk_bf16_f32 v158, v140, v141
    v_exp_f32 v143, v135
    v_mfma_f32_32x32x16_bf16 v[120:135], v[208:211], v[32:35], 0
    s_and_b32 s10, s10, 0x3c000
    v_cvt_pk_bf16_f32 v159, v142, v143
    v_exp_f32 v136, v104
    v_exp_f32 v137, v105
    v_exp_f32 v138, v106
    v_cvt_pk_bf16_f32 v144, v136, v137
    v_exp_f32 v139, v107
    v_mfma_f32_32x32x16_bf16 v[120:135], v[212:215], v[36:39], v[120:135]
    buffer_load_dwordx4 v[208:211], v241, s[4:7], s10 offen offset:0 sc1
    v_exp_f32 v140, v108
    v_cvt_pk_bf16_f32 v145, v138, v139
    v_exp_f32 v141, v109
    v_exp_f32 v142, v110
    v_cvt_pk_bf16_f32 v146, v140, v141
    v_exp_f32 v143, v111
    v_mfma_f32_32x32x16_bf16 v[56:71], v[216:219], v[152:155], v[56:71]
    s_waitcnt vmcnt(9)
    v_exp_f32 v136, v112
    v_cvt_pk_bf16_f32 v147, v142, v143
    v_exp_f32 v137, v113
    v_exp_f32 v138, v114
    v_cvt_pk_bf16_f32 v148, v136, v137
    v_exp_f32 v139, v115
    v_mfma_f32_32x32x16_bf16 v[56:71], v[220:223], v[156:159], v[56:71]
    buffer_load_dwordx4 v[212:215], v241, s[4:7], s10 offen offset:1024 sc1
    v_exp_f32 v140, v116
    v_cvt_pk_bf16_f32 v149, v138, v139
    v_exp_f32 v141, v117
    v_exp_f32 v142, v118
    v_cvt_pk_bf16_f32 v150, v140, v141
    v_exp_f32 v143, v119
    v_mfma_f32_32x32x16_bf16 v[104:119], v[160:163], v[8:11], 0
    v_cvt_pk_bf16_f32 v151, v142, v143
    v_exp_f32 v136, v120
    v_exp_f32 v137, v121
    v_exp_f32 v138, v122
    v_cvt_pk_bf16_f32 v152, v136, v137
    v_exp_f32 v139, v123
    v_mfma_f32_32x32x16_bf16 v[104:119], v[164:167], v[12:15], v[104:119]
    v_exp_f32 v140, v124
    v_cvt_pk_bf16_f32 v153, v138, v139
    v_exp_f32 v141, v125
    v_exp_f32 v142, v126
    v_cvt_pk_bf16_f32 v154, v140, v141
    v_exp_f32 v143, v127
    v_mfma_f32_32x32x16_bf16 v[72:87], v[216:219], v[144:147], v[72:87]
    v_exp_f32 v136, v128
    v_cvt_pk_bf16_f32 v155, v142, v143
    v_exp_f32 v137, v129
    v_exp_f32 v138, v130
    v_cvt_pk_bf16_f32 v156, v136, v137
    v_exp_f32 v139, v131
    v_mfma_f32_32x32x16_bf16 v[72:87], v[220:223], v[148:151], v[72:87]
    v_exp_f32 v140, v132
    v_cvt_pk_bf16_f32 v157, v138, v139
    v_exp_f32 v141, v133
    v_exp_f32 v142, v134
    v_cvt_pk_bf16_f32 v158, v140, v141
    v_exp_f32 v143, v135
    v_mfma_f32_32x32x16_bf16 v[120:135], v[160:163], v[16:19], 0
    buffer_load_dwordx4 v242, s[12:15], 0 offen offset:0 sc1 lds
    v_cvt_pk_bf16_f32 v159, v142, v143
    v_exp_f32 v136, v104
    v_exp_f32 v137, v105
    v_exp_f32 v138, v106
    v_cvt_pk_bf16_f32 v144, v136, v137
    v_exp_f32 v139, v107
    v_mfma_f32_32x32x16_bf16 v[120:135], v[164:167], v[20:23], v[120:135]
    v_exp_f32 v140, v108
    v_cvt_pk_bf16_f32 v145, v138, v139
    v_exp_f32 v141, v109
    v_exp_f32 v142, v110
    v_cvt_pk_bf16_f32 v146, v140, v141
    v_exp_f32 v143, v111
    v_mfma_f32_32x32x16_bf16 v[88:103], v[216:219], v[152:155], v[88:103]
    buffer_load_dwordx4 v242, s[12:15], 0 offen offset:1024 sc1 lds
    v_exp_f32 v136, v112
    v_cvt_pk_bf16_f32 v147, v142, v143
    v_exp_f32 v137, v113
    v_exp_f32 v138, v114
    v_cvt_pk_bf16_f32 v148, v136, v137
    v_exp_f32 v139, v115
    v_mfma_f32_32x32x16_bf16 v[88:103], v[220:223], v[156:159], v[88:103]
    buffer_load_dwordx4 v[216:219], v241, s[4:7], s10 offen offset:2048 sc1
    v_exp_f32 v140, v116
    v_cvt_pk_bf16_f32 v149, v138, v139
    v_exp_f32 v141, v117
    v_exp_f32 v142, v118
    v_cvt_pk_bf16_f32 v150, v140, v141
    v_exp_f32 v143, v119
    v_mfma_f32_32x32x16_bf16 v[104:119], v[160:163], v[24:27], 0
    v_cvt_pk_bf16_f32 v151, v142, v143
    v_exp_f32 v136, v120
    v_exp_f32 v137, v121
    v_exp_f32 v138, v122
    v_cvt_pk_bf16_f32 v152, v136, v137
    v_exp_f32 v139, v123
    v_mfma_f32_32x32x16_bf16 v[104:119], v[164:167], v[28:31], v[104:119]
    buffer_load_dwordx4 v[220:223], v241, s[4:7], s10 offen offset:3072 sc1
    v_exp_f32 v140, v124
    v_cvt_pk_bf16_f32 v153, v138, v139
    v_exp_f32 v141, v125
    v_exp_f32 v142, v126
    v_cvt_pk_bf16_f32 v154, v140, v141
    v_exp_f32 v143, v127
    v_mfma_f32_32x32x16_bf16 v[40:55], v[168:171], v[144:147], v[40:55]
    buffer_load_dwordx4 v242, s[12:15], 0 offen offset:2048 sc1 lds
    v_exp_f32 v136, v128
    v_cvt_pk_bf16_f32 v155, v142, v143
    v_exp_f32 v137, v129
    v_exp_f32 v138, v130
    v_cvt_pk_bf16_f32 v156, v136, v137
    v_exp_f32 v139, v131
    v_mfma_f32_32x32x16_bf16 v[40:55], v[172:175], v[148:151], v[40:55]
    s_add_u32 s9, s10, 16384
    v_exp_f32 v140, v132
    v_cvt_pk_bf16_f32 v157, v138, v139
    v_exp_f32 v141, v133
    v_exp_f32 v142, v134
    v_cvt_pk_bf16_f32 v158, v140, v141
    v_exp_f32 v143, v135
    v_mfma_f32_32x32x16_bf16 v[120:135], v[160:163], v[32:35], 0
    s_and_b32 s9, s9, 0x3c000
    v_cvt_pk_bf16_f32 v159, v142, v143
    v_exp_f32 v136, v104
    v_exp_f32 v137, v105
    v_exp_f32 v138, v106
    v_cvt_pk_bf16_f32 v144, v136, v137
    v_exp_f32 v139, v107
    v_mfma_f32_32x32x16_bf16 v[120:135], v[164:167], v[36:39], v[120:135]
    buffer_load_dwordx4 v[160:163], v241, s[4:7], s9 offen offset:0 sc1
    v_exp_f32 v140, v108
    v_cvt_pk_bf16_f32 v145, v138, v139
    v_exp_f32 v141, v109
    v_exp_f32 v142, v110
    v_cvt_pk_bf16_f32 v146, v140, v141
    v_exp_f32 v143, v111
    v_mfma_f32_32x32x16_bf16 v[56:71], v[168:171], v[152:155], v[56:71]
    s_waitcnt vmcnt(12)
    v_exp_f32 v136, v112
    v_cvt_pk_bf16_f32 v147, v142, v143
    v_exp_f32 v137, v113
    v_exp_f32 v138, v114
    v_cvt_pk_bf16_f32 v148, v136, v137
    v_exp_f32 v139, v115
    v_mfma_f32_32x32x16_bf16 v[56:71], v[172:175], v[156:159], v[56:71]
    buffer_load_dwordx4 v[164:167], v241, s[4:7], s9 offen offset:1024 sc1
    v_exp_f32 v140, v116
    v_cvt_pk_bf16_f32 v149, v138, v139
    v_exp_f32 v141, v117
    v_exp_f32 v142, v118
    v_cvt_pk_bf16_f32 v150, v140, v141
    v_exp_f32 v143, v119
    v_mfma_f32_32x32x16_bf16 v[104:119], v[176:179], v[8:11], 0
    v_cvt_pk_bf16_f32 v151, v142, v143
    v_exp_f32 v136, v120
    v_exp_f32 v137, v121
    v_exp_f32 v138, v122
    v_cvt_pk_bf16_f32 v152, v136, v137
    v_exp_f32 v139, v123
    v_mfma_f32_32x32x16_bf16 v[104:119], v[180:183], v[12:15], v[104:119]
    buffer_load_dwordx4 v242, s[12:15], 0 offen offset:3072 sc1 lds
    v_exp_f32 v140, v124
    v_cvt_pk_bf16_f32 v153, v138, v139
    v_exp_f32 v141, v125
    v_exp_f32 v142, v126
    v_cvt_pk_bf16_f32 v154, v140, v141
    v_exp_f32 v143, v127
    v_mfma_f32_32x32x16_bf16 v[72:87], v[168:171], v[144:147], v[72:87]
    v_exp_f32 v136, v128
    v_cvt_pk_bf16_f32 v155, v142, v143
    v_exp_f32 v137, v129
    v_exp_f32 v138, v130
    v_cvt_pk_bf16_f32 v156, v136, v137
    v_exp_f32 v139, v131
    v_mfma_f32_32x32x16_bf16 v[72:87], v[172:175], v[148:151], v[72:87]
    s_add_u32 m0, m0, 4096
    v_exp_f32 v140, v132
    v_cvt_pk_bf16_f32 v157, v138, v139
    v_exp_f32 v141, v133
    v_exp_f32 v142, v134
    v_cvt_pk_bf16_f32 v158, v140, v141
    v_exp_f32 v143, v135
    v_mfma_f32_32x32x16_bf16 v[120:135], v[176:179], v[16:19], 0
    v_cvt_pk_bf16_f32 v159, v142, v143
    v_exp_f32 v136, v104
    v_exp_f32 v137, v105
    v_exp_f32 v138, v106
    v_cvt_pk_bf16_f32 v144, v136, v137
    v_exp_f32 v139, v107
    v_mfma_f32_32x32x16_bf16 v[120:135], v[180:183], v[20:23], v[120:135]
    buffer_load_dwordx4 v242, s[12:15], s42 offen offset:0 sc1 lds
    v_exp_f32 v140, v108
    v_cvt_pk_bf16_f32 v145, v138, v139
    v_exp_f32 v141, v109
    v_exp_f32 v142, v110
    v_cvt_pk_bf16_f32 v146, v140, v141
    v_exp_f32 v143, v111
    v_mfma_f32_32x32x16_bf16 v[88:103], v[168:171], v[152:155], v[88:103]
    v_exp_f32 v136, v112
    v_cvt_pk_bf16_f32 v147, v142, v143
    v_exp_f32 v137, v113
    v_exp_f32 v138, v114
    v_cvt_pk_bf16_f32 v148, v136, v137
    v_exp_f32 v139, v115
    v_mfma_f32_32x32x16_bf16 v[88:103], v[172:175], v[156:159], v[88:103]
    buffer_load_dwordx4 v[168:171], v241, s[4:7], s9 offen offset:2048 sc1
    v_exp_f32 v140, v116
    v_cvt_pk_bf16_f32 v149, v138, v139
    v_exp_f32 v141, v117
    v_exp_f32 v142, v118
    v_cvt_pk_bf16_f32 v150, v140, v141
    v_exp_f32 v143, v119
    v_mfma_f32_32x32x16_bf16 v[104:119], v[176:179], v[24:27], 0
    v_cvt_pk_bf16_f32 v151, v142, v143
    v_exp_f32 v136, v120
    v_exp_f32 v137, v121
    v_exp_f32 v138, v122
    v_cvt_pk_bf16_f32 v152, v136, v137
    v_exp_f32 v139, v123
    v_mfma_f32_32x32x16_bf16 v[104:119], v[180:183], v[28:31], v[104:119]
    buffer_load_dwordx4 v[172:175], v241, s[4:7], s9 offen offset:3072 sc1
    v_exp_f32 v140, v124
    v_cvt_pk_bf16_f32 v153, v138, v139
    v_exp_f32 v141, v125
    v_exp_f32 v142, v126
    v_cvt_pk_bf16_f32 v154, v140, v141
    v_exp_f32 v143, v127
    v_mfma_f32_32x32x16_bf16 v[40:55], v[184:187], v[144:147], v[40:55]
    buffer_load_dwordx4 v242, s[12:15], s42 offen offset:1024 sc1 lds
    v_exp_f32 v136, v128
    v_cvt_pk_bf16_f32 v155, v142, v143
    v_exp_f32 v137, v129
    v_exp_f32 v138, v130
    v_cvt_pk_bf16_f32 v156, v136, v137
    v_exp_f32 v139, v131
    v_mfma_f32_32x32x16_bf16 v[40:55], v[188:191], v[148:151], v[40:55]
    s_add_u32 s10, s9, 16384
    v_exp_f32 v140, v132
    v_cvt_pk_bf16_f32 v157, v138, v139
    v_exp_f32 v141, v133
    v_exp_f32 v142, v134
    v_cvt_pk_bf16_f32 v158, v140, v141
    v_exp_f32 v143, v135
    v_mfma_f32_32x32x16_bf16 v[120:135], v[176:179], v[32:35], 0
    s_and_b32 s10, s10, 0x3c000
    v_cvt_pk_bf16_f32 v159, v142, v143
    v_exp_f32 v136, v104
    v_exp_f32 v137, v105
    v_exp_f32 v138, v106
    v_cvt_pk_bf16_f32 v144, v136, v137
    v_exp_f32 v139, v107
    v_mfma_f32_32x32x16_bf16 v[120:135], v[180:183], v[36:39], v[120:135]
    buffer_load_dwordx4 v[176:179], v241, s[4:7], s10 offen offset:0 sc1
    v_exp_f32 v140, v108
    v_cvt_pk_bf16_f32 v145, v138, v139
    v_exp_f32 v141, v109
    v_exp_f32 v142, v110
    v_cvt_pk_bf16_f32 v146, v140, v141
    v_exp_f32 v143, v111
    v_mfma_f32_32x32x16_bf16 v[56:71], v[184:187], v[152:155], v[56:71]
    s_waitcnt vmcnt(15)
    v_exp_f32 v136, v112
    v_cvt_pk_bf16_f32 v147, v142, v143
    v_exp_f32 v137, v113
    v_exp_f32 v138, v114
    v_cvt_pk_bf16_f32 v148, v136, v137
    v_exp_f32 v139, v115
    v_mfma_f32_32x32x16_bf16 v[56:71], v[188:191], v[156:159], v[56:71]
    buffer_load_dwordx4 v[180:183], v241, s[4:7], s10 offen offset:1024 sc1
    v_exp_f32 v140, v116
    v_cvt_pk_bf16_f32 v149, v138, v139
    v_exp_f32 v141, v117
    v_exp_f32 v142, v118
    v_cvt_pk_bf16_f32 v150, v140, v141
    v_exp_f32 v143, v119
    v_mfma_f32_32x32x16_bf16 v[104:119], v[192:195], v[8:11], 0
    v_cvt_pk_bf16_f32 v151, v142, v143
    v_exp_f32 v136, v120
    v_exp_f32 v137, v121
    v_exp_f32 v138, v122
    v_cvt_pk_bf16_f32 v152, v136, v137
    v_exp_f32 v139, v123
    v_mfma_f32_32x32x16_bf16 v[104:119], v[196:199], v[12:15], v[104:119]
    buffer_load_dwordx4 v242, s[12:15], s42 offen offset:2048 sc1 lds
    v_exp_f32 v140, v124
    v_cvt_pk_bf16_f32 v153, v138, v139
    v_exp_f32 v141, v125
    v_exp_f32 v142, v126
    v_cvt_pk_bf16_f32 v154, v140, v141
    v_exp_f32 v143, v127
    v_mfma_f32_32x32x16_bf16 v[72:87], v[184:187], v[144:147], v[72:87]
    v_exp_f32 v136, v128
    v_cvt_pk_bf16_f32 v155, v142, v143
    v_exp_f32 v137, v129
    v_exp_f32 v138, v130
    v_cvt_pk_bf16_f32 v156, v136, v137
    v_exp_f32 v139, v131
    v_mfma_f32_32x32x16_bf16 v[72:87], v[188:191], v[148:151], v[72:87]
    buffer_load_dwordx4 v242, s[12:15], s42 offen offset:3072 sc1 lds
    v_exp_f32 v140, v132
    v_cvt_pk_bf16_f32 v157, v138, v139
    v_exp_f32 v141, v133
    v_exp_f32 v142, v134
    v_cvt_pk_bf16_f32 v158, v140, v141
    v_exp_f32 v143, v135
    v_mfma_f32_32x32x16_bf16 v[120:135], v[192:195], v[16:19], 0
    v_cvt_pk_bf16_f32 v159, v142, v143
    v_exp_f32 v136, v104
    v_exp_f32 v137, v105
    v_exp_f32 v138, v106
    v_cvt_pk_bf16_f32 v144, v136, v137
    v_exp_f32 v139, v107
    v_mfma_f32_32x32x16_bf16 v[120:135], v[196:199], v[20:23], v[120:135]
    s_add_u32 m0, m0, 4096
    v_exp_f32 v140, v108
    v_cvt_pk_bf16_f32 v145, v138, v139
    v_exp_f32 v141, v109
    v_exp_f32 v142, v110
    v_cvt_pk_bf16_f32 v146, v140, v141
    v_exp_f32 v143, v111
    v_mfma_f32_32x32x16_bf16 v[88:103], v[184:187], v[152:155], v[88:103]
    v_exp_f32 v136, v112
    v_cvt_pk_bf16_f32 v147, v142, v143
    v_exp_f32 v137, v113
    v_exp_f32 v138, v114
    v_cvt_pk_bf16_f32 v148, v136, v137
    v_exp_f32 v139, v115
    v_mfma_f32_32x32x16_bf16 v[88:103], v[188:191], v[156:159], v[88:103]
    buffer_load_dwordx4 v[184:187], v241, s[4:7], s10 offen offset:2048 sc1
    v_exp_f32 v140, v116
    v_cvt_pk_bf16_f32 v149, v138, v139
    v_exp_f32 v141, v117
    v_exp_f32 v142, v118
    v_cvt_pk_bf16_f32 v150, v140, v141
    v_exp_f32 v143, v119
    v_mfma_f32_32x32x16_bf16 v[104:119], v[192:195], v[24:27], 0
    buffer_load_dwordx4 v242, s[12:15], s43 offen offset:0 sc1 lds
    v_cvt_pk_bf16_f32 v151, v142, v143
    v_exp_f32 v136, v120
    v_exp_f32 v137, v121
    v_exp_f32 v138, v122
    v_cvt_pk_bf16_f32 v152, v136, v137
    v_exp_f32 v139, v123
    v_mfma_f32_32x32x16_bf16 v[104:119], v[196:199], v[28:31], v[104:119]
    buffer_load_dwordx4 v[188:191], v241, s[4:7], s10 offen offset:3072 sc1
    v_exp_f32 v140, v124
    v_cvt_pk_bf16_f32 v153, v138, v139
    v_exp_f32 v141, v125
    v_exp_f32 v142, v126
    v_cvt_pk_bf16_f32 v154, v140, v141
    v_exp_f32 v143, v127
    v_mfma_f32_32x32x16_bf16 v[40:55], v[200:203], v[144:147], v[40:55]
    v_exp_f32 v136, v128
    v_cvt_pk_bf16_f32 v155, v142, v143
    v_exp_f32 v137, v129
    v_exp_f32 v138, v130
    v_cvt_pk_bf16_f32 v156, v136, v137
    v_exp_f32 v139, v131
    v_mfma_f32_32x32x16_bf16 v[40:55], v[204:207], v[148:151], v[40:55]
    s_add_u32 s9, s10, 16384
    v_exp_f32 v140, v132
    v_cvt_pk_bf16_f32 v157, v138, v139
    v_exp_f32 v141, v133
    v_exp_f32 v142, v134
    v_cvt_pk_bf16_f32 v158, v140, v141
    v_exp_f32 v143, v135
    v_mfma_f32_32x32x16_bf16 v[120:135], v[192:195], v[32:35], 0
    s_and_b32 s9, s9, 0x3c000
    v_cvt_pk_bf16_f32 v159, v142, v143
    v_exp_f32 v136, v104
    v_exp_f32 v137, v105
    v_exp_f32 v138, v106
    v_cvt_pk_bf16_f32 v144, v136, v137
    v_exp_f32 v139, v107
    v_mfma_f32_32x32x16_bf16 v[120:135], v[196:199], v[36:39], v[120:135]
    buffer_load_dwordx4 v[192:195], v241, s[4:7], s9 offen offset:0 sc1
    v_exp_f32 v140, v108
    v_cvt_pk_bf16_f32 v145, v138, v139
    v_exp_f32 v141, v109
    v_exp_f32 v142, v110
    v_cvt_pk_bf16_f32 v146, v140, v141
    v_exp_f32 v143, v111
    v_mfma_f32_32x32x16_bf16 v[56:71], v[200:203], v[152:155], v[56:71]
    s_waitcnt vmcnt(16)
    v_exp_f32 v136, v112
    v_cvt_pk_bf16_f32 v147, v142, v143
    v_exp_f32 v137, v113
    v_exp_f32 v138, v114
    v_cvt_pk_bf16_f32 v148, v136, v137
    v_exp_f32 v139, v115
    v_mfma_f32_32x32x16_bf16 v[56:71], v[204:207], v[156:159], v[56:71]
    buffer_load_dwordx4 v[196:199], v241, s[4:7], s9 offen offset:1024 sc1
    v_exp_f32 v140, v116
    v_cvt_pk_bf16_f32 v149, v138, v139
    v_exp_f32 v141, v117
    v_exp_f32 v142, v118
    v_cvt_pk_bf16_f32 v150, v140, v141
    v_exp_f32 v143, v119
    v_mfma_f32_32x32x16_bf16 v[104:119], v[208:211], v[8:11], 0
    buffer_load_dwordx4 v242, s[12:15], s43 offen offset:1024 sc1 lds
    v_cvt_pk_bf16_f32 v151, v142, v143
    v_exp_f32 v136, v120
    v_exp_f32 v137, v121
    v_exp_f32 v138, v122
    v_cvt_pk_bf16_f32 v152, v136, v137
    v_exp_f32 v139, v123
    v_mfma_f32_32x32x16_bf16 v[104:119], v[212:215], v[12:15], v[104:119]
    v_exp_f32 v140, v124
    v_cvt_pk_bf16_f32 v153, v138, v139
    v_exp_f32 v141, v125
    v_exp_f32 v142, v126
    v_cvt_pk_bf16_f32 v154, v140, v141
    v_exp_f32 v143, v127
    v_mfma_f32_32x32x16_bf16 v[72:87], v[200:203], v[144:147], v[72:87]
    v_exp_f32 v136, v128
    v_cvt_pk_bf16_f32 v155, v142, v143
    v_exp_f32 v137, v129
    v_exp_f32 v138, v130
    v_cvt_pk_bf16_f32 v156, v136, v137
    v_exp_f32 v139, v131
    v_mfma_f32_32x32x16_bf16 v[72:87], v[204:207], v[148:151], v[72:87]
    buffer_load_dwordx4 v242, s[12:15], s43 offen offset:2048 sc1 lds
    v_exp_f32 v140, v132
    v_cvt_pk_bf16_f32 v157, v138, v139
    v_exp_f32 v141, v133
    v_exp_f32 v142, v134
    v_cvt_pk_bf16_f32 v158, v140, v141
    v_exp_f32 v143, v135
    v_mfma_f32_32x32x16_bf16 v[120:135], v[208:211], v[16:19], 0
    v_cvt_pk_bf16_f32 v159, v142, v143
    v_exp_f32 v136, v104
    v_exp_f32 v137, v105
    v_exp_f32 v138, v106
    v_cvt_pk_bf16_f32 v144, v136, v137
    v_exp_f32 v139, v107
    v_mfma_f32_32x32x16_bf16 v[120:135], v[212:215], v[20:23], v[120:135]
    buffer_load_dwordx4 v242, s[12:15], s43 offen offset:3072 sc1 lds
    v_exp_f32 v140, v108
    v_cvt_pk_bf16_f32 v145, v138, v139
    v_exp_f32 v141, v109
    v_exp_f32 v142, v110
    v_cvt_pk_bf16_f32 v146, v140, v141
    v_exp_f32 v143, v111
    v_mfma_f32_32x32x16_bf16 v[88:103], v[200:203], v[152:155], v[88:103]
    v_exp_f32 v136, v112
    v_cvt_pk_bf16_f32 v147, v142, v143
    v_exp_f32 v137, v113
    v_exp_f32 v138, v114
    v_cvt_pk_bf16_f32 v148, v136, v137
    v_exp_f32 v139, v115
    v_mfma_f32_32x32x16_bf16 v[88:103], v[204:207], v[156:159], v[88:103]
    buffer_load_dwordx4 v[200:203], v241, s[4:7], s9 offen offset:2048 sc1
    v_exp_f32 v140, v116
    v_cvt_pk_bf16_f32 v149, v138, v139
    v_exp_f32 v141, v117
    v_exp_f32 v142, v118
    v_cvt_pk_bf16_f32 v150, v140, v141
    v_exp_f32 v143, v119
    v_mfma_f32_32x32x16_bf16 v[104:119], v[208:211], v[24:27], 0
    s_add_u32 m0, m0, 4096
    v_cvt_pk_bf16_f32 v151, v142, v143
    v_exp_f32 v136, v120
    v_exp_f32 v137, v121
    v_exp_f32 v138, v122
    v_cvt_pk_bf16_f32 v152, v136, v137
    v_exp_f32 v139, v123
    v_mfma_f32_32x32x16_bf16 v[104:119], v[212:215], v[28:31], v[104:119]
    buffer_load_dwordx4 v[204:207], v241, s[4:7], s9 offen offset:3072 sc1
    v_exp_f32 v140, v124
    v_cvt_pk_bf16_f32 v153, v138, v139
    v_exp_f32 v141, v125
    v_exp_f32 v142, v126
    v_cvt_pk_bf16_f32 v154, v140, v141
    v_exp_f32 v143, v127
    v_mfma_f32_32x32x16_bf16 v[40:55], v[216:219], v[144:147], v[40:55]
    v_exp_f32 v136, v128
    v_cvt_pk_bf16_f32 v155, v142, v143
    v_exp_f32 v137, v129
    v_exp_f32 v138, v130
    v_cvt_pk_bf16_f32 v156, v136, v137
    v_exp_f32 v139, v131
    v_mfma_f32_32x32x16_bf16 v[40:55], v[220:223], v[148:151], v[40:55]
    s_add_u32 s10, s9, 16384
    v_exp_f32 v140, v132
    v_cvt_pk_bf16_f32 v157, v138, v139
    v_exp_f32 v141, v133
    v_exp_f32 v142, v134
    v_cvt_pk_bf16_f32 v158, v140, v141
    v_exp_f32 v143, v135
    v_mfma_f32_32x32x16_bf16 v[120:135], v[208:211], v[32:35], 0
    s_and_b32 s10, s10, 0x3c000
    v_cvt_pk_bf16_f32 v159, v142, v143
    v_exp_f32 v136, v104
    v_exp_f32 v137, v105
    v_exp_f32 v138, v106
    v_cvt_pk_bf16_f32 v144, v136, v137
    v_exp_f32 v139, v107
    v_mfma_f32_32x32x16_bf16 v[120:135], v[212:215], v[36:39], v[120:135]
    buffer_load_dwordx4 v[208:211], v241, s[4:7], s10 offen offset:0 sc1
    v_exp_f32 v140, v108
    v_cvt_pk_bf16_f32 v145, v138, v139
    v_exp_f32 v141, v109
    v_exp_f32 v142, v110
    v_cvt_pk_bf16_f32 v146, v140, v141
    v_exp_f32 v143, v111
    v_mfma_f32_32x32x16_bf16 v[56:71], v[216:219], v[152:155], v[56:71]
    s_waitcnt vmcnt(16)
    v_exp_f32 v136, v112
    v_cvt_pk_bf16_f32 v147, v142, v143
    v_exp_f32 v137, v113
    v_exp_f32 v138, v114
    v_cvt_pk_bf16_f32 v148, v136, v137
    v_exp_f32 v139, v115
    v_mfma_f32_32x32x16_bf16 v[56:71], v[220:223], v[156:159], v[56:71]
    buffer_load_dwordx4 v[212:215], v241, s[4:7], s10 offen offset:1024 sc1
    v_exp_f32 v140, v116
    v_cvt_pk_bf16_f32 v149, v138, v139
    v_exp_f32 v141, v117
    v_exp_f32 v142, v118
    v_cvt_pk_bf16_f32 v150, v140, v141
    v_exp_f32 v143, v119
    v_mfma_f32_32x32x16_bf16 v[104:119], v[160:163], v[8:11], 0
    buffer_load_dwordx4 v242, s[12:15], s44 offen offset:0 sc1 lds
    v_cvt_pk_bf16_f32 v151, v142, v143
    v_exp_f32 v136, v120
    v_exp_f32 v137, v121
    v_exp_f32 v138, v122
    v_cvt_pk_bf16_f32 v152, v136, v137
    v_exp_f32 v139, v123
    v_mfma_f32_32x32x16_bf16 v[104:119], v[164:167], v[12:15], v[104:119]
    v_exp_f32 v140, v124
    v_cvt_pk_bf16_f32 v153, v138, v139
    v_exp_f32 v141, v125
    v_exp_f32 v142, v126
    v_cvt_pk_bf16_f32 v154, v140, v141
    v_exp_f32 v143, v127
    v_mfma_f32_32x32x16_bf16 v[72:87], v[216:219], v[144:147], v[72:87]
    buffer_load_dwordx4 v242, s[12:15], s44 offen offset:1024 sc1 lds
    v_exp_f32 v136, v128
    v_cvt_pk_bf16_f32 v155, v142, v143
    v_exp_f32 v137, v129
    v_exp_f32 v138, v130
    v_cvt_pk_bf16_f32 v156, v136, v137
    v_exp_f32 v139, v131
    v_mfma_f32_32x32x16_bf16 v[72:87], v[220:223], v[148:151], v[72:87]
    v_exp_f32 v140, v132
    v_cvt_pk_bf16_f32 v157, v138, v139
    v_exp_f32 v141, v133
    v_exp_f32 v142, v134
    v_cvt_pk_bf16_f32 v158, v140, v141
    v_exp_f32 v143, v135
    v_mfma_f32_32x32x16_bf16 v[120:135], v[160:163], v[16:19], 0
    v_cvt_pk_bf16_f32 v159, v142, v143
    v_exp_f32 v136, v104
    v_exp_f32 v137, v105
    v_exp_f32 v138, v106
    v_cvt_pk_bf16_f32 v144, v136, v137
    v_exp_f32 v139, v107
    v_mfma_f32_32x32x16_bf16 v[120:135], v[164:167], v[20:23], v[120:135]
    buffer_load_dwordx4 v242, s[12:15], s44 offen offset:2048 sc1 lds
    v_exp_f32 v140, v108
    v_cvt_pk_bf16_f32 v145, v138, v139
    v_exp_f32 v141, v109
    v_exp_f32 v142, v110
    v_cvt_pk_bf16_f32 v146, v140, v141
    v_exp_f32 v143, v111
    v_mfma_f32_32x32x16_bf16 v[88:103], v[216:219], v[152:155], v[88:103]
    v_exp_f32 v136, v112
    v_cvt_pk_bf16_f32 v147, v142, v143
    v_exp_f32 v137, v113
    v_exp_f32 v138, v114
    v_cvt_pk_bf16_f32 v148, v136, v137
    v_exp_f32 v139, v115
    v_mfma_f32_32x32x16_bf16 v[88:103], v[220:223], v[156:159], v[88:103]
    buffer_load_dwordx4 v[216:219], v241, s[4:7], s10 offen offset:2048 sc1
    v_exp_f32 v140, v116
    v_cvt_pk_bf16_f32 v149, v138, v139
    v_exp_f32 v141, v117
    v_exp_f32 v142, v118
    v_cvt_pk_bf16_f32 v150, v140, v141
    v_exp_f32 v143, v119
    v_mfma_f32_32x32x16_bf16 v[104:119], v[160:163], v[24:27], 0
    buffer_load_dwordx4 v242, s[12:15], s44 offen offset:3072 sc1 lds
    v_cvt_pk_bf16_f32 v151, v142, v143
    v_exp_f32 v136, v120
    v_exp_f32 v137, v121
    v_exp_f32 v138, v122
    v_cvt_pk_bf16_f32 v152, v136, v137
    v_exp_f32 v139, v123
    v_mfma_f32_32x32x16_bf16 v[104:119], v[164:167], v[28:31], v[104:119]
    buffer_load_dwordx4 v[220:223], v241, s[4:7], s10 offen offset:3072 sc1
    v_exp_f32 v140, v124
    v_cvt_pk_bf16_f32 v153, v138, v139
    v_exp_f32 v141, v125
    v_exp_f32 v142, v126
    v_cvt_pk_bf16_f32 v154, v140, v141
    v_exp_f32 v143, v127
    v_mfma_f32_32x32x16_bf16 v[40:55], v[168:171], v[144:147], v[40:55]
    v_exp_f32 v136, v128
    v_cvt_pk_bf16_f32 v155, v142, v143
    v_exp_f32 v137, v129
    v_exp_f32 v138, v130
    v_cvt_pk_bf16_f32 v156, v136, v137
    v_exp_f32 v139, v131
    v_mfma_f32_32x32x16_bf16 v[40:55], v[172:175], v[148:151], v[40:55]
    s_add_u32 s9, s10, 16384
    v_exp_f32 v140, v132
    v_cvt_pk_bf16_f32 v157, v138, v139
    v_exp_f32 v141, v133
    v_exp_f32 v142, v134
    v_cvt_pk_bf16_f32 v158, v140, v141
    v_exp_f32 v143, v135
    v_mfma_f32_32x32x16_bf16 v[120:135], v[160:163], v[32:35], 0
    s_and_b32 s9, s9, 0x3c000
    v_cvt_pk_bf16_f32 v159, v142, v143
    v_exp_f32 v136, v104
    v_exp_f32 v137, v105
    v_exp_f32 v138, v106
    v_cvt_pk_bf16_f32 v144, v136, v137
    v_exp_f32 v139, v107
    v_mfma_f32_32x32x16_bf16 v[120:135], v[164:167], v[36:39], v[120:135]
    buffer_load_dwordx4 v[160:163], v241, s[4:7], s9 offen offset:0 sc1
    v_exp_f32 v140, v108
    v_cvt_pk_bf16_f32 v145, v138, v139
    v_exp_f32 v141, v109
    v_exp_f32 v142, v110
    v_cvt_pk_bf16_f32 v146, v140, v141
    v_exp_f32 v143, v111
    v_mfma_f32_32x32x16_bf16 v[56:71], v[168:171], v[152:155], v[56:71]
    s_waitcnt vmcnt(16)
    v_exp_f32 v136, v112
    v_cvt_pk_bf16_f32 v147, v142, v143
    v_exp_f32 v137, v113
    v_exp_f32 v138, v114
    v_cvt_pk_bf16_f32 v148, v136, v137
    v_exp_f32 v139, v115
    v_mfma_f32_32x32x16_bf16 v[56:71], v[172:175], v[156:159], v[56:71]
    buffer_load_dwordx4 v[164:167], v241, s[4:7], s9 offen offset:1024 sc1
    v_exp_f32 v140, v116
    v_cvt_pk_bf16_f32 v149, v138, v139
    v_exp_f32 v141, v117
    v_exp_f32 v142, v118
    v_cvt_pk_bf16_f32 v150, v140, v141
    v_exp_f32 v143, v119
    v_mfma_f32_32x32x16_bf16 v[104:119], v[176:179], v[8:11], 0
    s_add_u32 m0, m0, 4096
    v_cvt_pk_bf16_f32 v151, v142, v143
    v_exp_f32 v136, v120
    v_exp_f32 v137, v121
    v_exp_f32 v138, v122
    v_cvt_pk_bf16_f32 v152, v136, v137
    v_exp_f32 v139, v123
    v_mfma_f32_32x32x16_bf16 v[104:119], v[180:183], v[12:15], v[104:119]
    v_exp_f32 v140, v124
    v_cvt_pk_bf16_f32 v153, v138, v139
    v_exp_f32 v141, v125
    v_exp_f32 v142, v126
    v_cvt_pk_bf16_f32 v154, v140, v141
    v_exp_f32 v143, v127
    v_mfma_f32_32x32x16_bf16 v[72:87], v[168:171], v[144:147], v[72:87]
    buffer_load_dwordx4 v242, s[12:15], s45 offen offset:0 sc1 lds
    v_exp_f32 v136, v128
    v_cvt_pk_bf16_f32 v155, v142, v143
    v_exp_f32 v137, v129
    v_exp_f32 v138, v130
    v_cvt_pk_bf16_f32 v156, v136, v137
    v_exp_f32 v139, v131
    v_mfma_f32_32x32x16_bf16 v[72:87], v[172:175], v[148:151], v[72:87]
    v_exp_f32 v140, v132
    v_cvt_pk_bf16_f32 v157, v138, v139
    v_exp_f32 v141, v133
    v_exp_f32 v142, v134
    v_cvt_pk_bf16_f32 v158, v140, v141
    v_exp_f32 v143, v135
    v_mfma_f32_32x32x16_bf16 v[120:135], v[176:179], v[16:19], 0
    buffer_load_dwordx4 v242, s[12:15], s45 offen offset:1024 sc1 lds
    v_cvt_pk_bf16_f32 v159, v142, v143
    v_exp_f32 v136, v104
    v_exp_f32 v137, v105
    v_exp_f32 v138, v106
    v_cvt_pk_bf16_f32 v144, v136, v137
    v_exp_f32 v139, v107
    v_mfma_f32_32x32x16_bf16 v[120:135], v[180:183], v[20:23], v[120:135]
    v_exp_f32 v140, v108
    v_cvt_pk_bf16_f32 v145, v138, v139
    v_exp_f32 v141, v109
    v_exp_f32 v142, v110
    v_cvt_pk_bf16_f32 v146, v140, v141
    v_exp_f32 v143, v111
    v_mfma_f32_32x32x16_bf16 v[88:103], v[168:171], v[152:155], v[88:103]
    buffer_load_dwordx4 v242, s[12:15], s45 offen offset:2048 sc1 lds
    v_exp_f32 v136, v112
    v_cvt_pk_bf16_f32 v147, v142, v143
    v_exp_f32 v137, v113
    v_exp_f32 v138, v114
    v_cvt_pk_bf16_f32 v148, v136, v137
    v_exp_f32 v139, v115
    v_mfma_f32_32x32x16_bf16 v[88:103], v[172:175], v[156:159], v[88:103]
    buffer_load_dwordx4 v[168:171], v241, s[4:7], s9 offen offset:2048 sc1
    v_exp_f32 v140, v116
    v_cvt_pk_bf16_f32 v149, v138, v139
    v_exp_f32 v141, v117
    v_exp_f32 v142, v118
    v_cvt_pk_bf16_f32 v150, v140, v141
    v_exp_f32 v143, v119
    v_mfma_f32_32x32x16_bf16 v[104:119], v[176:179], v[24:27], 0
    v_cvt_pk_bf16_f32 v151, v142, v143
    v_exp_f32 v136, v120
    v_exp_f32 v137, v121
    v_exp_f32 v138, v122
    v_cvt_pk_bf16_f32 v152, v136, v137
    v_exp_f32 v139, v123
    v_mfma_f32_32x32x16_bf16 v[104:119], v[180:183], v[28:31], v[104:119]
    buffer_load_dwordx4 v[172:175], v241, s[4:7], s9 offen offset:3072 sc1
    v_exp_f32 v140, v124
    v_cvt_pk_bf16_f32 v153, v138, v139
    v_exp_f32 v141, v125
    v_exp_f32 v142, v126
    v_cvt_pk_bf16_f32 v154, v140, v141
    v_exp_f32 v143, v127
    v_mfma_f32_32x32x16_bf16 v[40:55], v[184:187], v[144:147], v[40:55]
    v_exp_f32 v136, v128
    v_cvt_pk_bf16_f32 v155, v142, v143
    v_exp_f32 v137, v129
    v_exp_f32 v138, v130
    v_cvt_pk_bf16_f32 v156, v136, v137
    v_exp_f32 v139, v131
    v_mfma_f32_32x32x16_bf16 v[40:55], v[188:191], v[148:151], v[40:55]
    s_add_u32 s10, s9, 16384
    v_exp_f32 v140, v132
    v_cvt_pk_bf16_f32 v157, v138, v139
    v_exp_f32 v141, v133
    v_exp_f32 v142, v134
    v_cvt_pk_bf16_f32 v158, v140, v141
    v_exp_f32 v143, v135
    v_mfma_f32_32x32x16_bf16 v[120:135], v[176:179], v[32:35], 0
    s_and_b32 s10, s10, 0x3c000
    v_cvt_pk_bf16_f32 v159, v142, v143
    v_exp_f32 v136, v104
    v_exp_f32 v137, v105
    v_exp_f32 v138, v106
    v_cvt_pk_bf16_f32 v144, v136, v137
    v_exp_f32 v139, v107
    v_mfma_f32_32x32x16_bf16 v[120:135], v[180:183], v[36:39], v[120:135]
    buffer_load_dwordx4 v[176:179], v241, s[4:7], s10 offen offset:0 sc1
    v_exp_f32 v140, v108
    v_cvt_pk_bf16_f32 v145, v138, v139
    v_exp_f32 v141, v109
    v_exp_f32 v142, v110
    v_cvt_pk_bf16_f32 v146, v140, v141
    v_exp_f32 v143, v111
    v_mfma_f32_32x32x16_bf16 v[56:71], v[184:187], v[152:155], v[56:71]
    s_waitcnt vmcnt(16)
    v_exp_f32 v136, v112
    v_cvt_pk_bf16_f32 v147, v142, v143
    v_exp_f32 v137, v113
    v_exp_f32 v138, v114
    v_cvt_pk_bf16_f32 v148, v136, v137
    v_exp_f32 v139, v115
    v_mfma_f32_32x32x16_bf16 v[56:71], v[188:191], v[156:159], v[56:71]
    buffer_load_dwordx4 v[180:183], v241, s[4:7], s10 offen offset:1024 sc1
    v_exp_f32 v140, v116
    v_cvt_pk_bf16_f32 v149, v138, v139
    v_exp_f32 v141, v117
    v_exp_f32 v142, v118
    v_cvt_pk_bf16_f32 v150, v140, v141
    v_exp_f32 v143, v119
    v_mfma_f32_32x32x16_bf16 v[104:119], v[192:195], v[8:11], 0
    buffer_load_dwordx4 v242, s[12:15], s45 offen offset:3072 sc1 lds
    v_cvt_pk_bf16_f32 v151, v142, v143
    v_exp_f32 v136, v120
    v_exp_f32 v137, v121
    v_exp_f32 v138, v122
    v_cvt_pk_bf16_f32 v152, v136, v137
    v_exp_f32 v139, v123
    v_mfma_f32_32x32x16_bf16 v[104:119], v[196:199], v[12:15], v[104:119]
    v_exp_f32 v140, v124
    v_cvt_pk_bf16_f32 v153, v138, v139
    v_exp_f32 v141, v125
    v_exp_f32 v142, v126
    v_cvt_pk_bf16_f32 v154, v140, v141
    v_exp_f32 v143, v127
    v_mfma_f32_32x32x16_bf16 v[72:87], v[184:187], v[144:147], v[72:87]
    s_add_u32 m0, m0, 4096
    v_exp_f32 v136, v128
    v_cvt_pk_bf16_f32 v155, v142, v143
    v_exp_f32 v137, v129
    v_exp_f32 v138, v130
    v_cvt_pk_bf16_f32 v156, v136, v137
    v_exp_f32 v139, v131
    v_mfma_f32_32x32x16_bf16 v[72:87], v[188:191], v[148:151], v[72:87]
    v_exp_f32 v140, v132
    v_cvt_pk_bf16_f32 v157, v138, v139
    v_exp_f32 v141, v133
    v_exp_f32 v142, v134
    v_cvt_pk_bf16_f32 v158, v140, v141
    v_exp_f32 v143, v135
    v_mfma_f32_32x32x16_bf16 v[120:135], v[192:195], v[16:19], 0
    buffer_load_dwordx4 v242, s[12:15], s46 offen offset:0 sc1 lds
    v_cvt_pk_bf16_f32 v159, v142, v143
    v_exp_f32 v136, v104
    v_exp_f32 v137, v105
    v_exp_f32 v138, v106
    v_cvt_pk_bf16_f32 v144, v136, v137
    v_exp_f32 v139, v107
    v_mfma_f32_32x32x16_bf16 v[120:135], v[196:199], v[20:23], v[120:135]
    v_exp_f32 v140, v108
    v_cvt_pk_bf16_f32 v145, v138, v139
    v_exp_f32 v141, v109
    v_exp_f32 v142, v110
    v_cvt_pk_bf16_f32 v146, v140, v141
    v_exp_f32 v143, v111
    v_mfma_f32_32x32x16_bf16 v[88:103], v[184:187], v[152:155], v[88:103]
    buffer_load_dwordx4 v242, s[12:15], s46 offen offset:1024 sc1 lds
    v_exp_f32 v136, v112
    v_cvt_pk_bf16_f32 v147, v142, v143
    v_exp_f32 v137, v113
    v_exp_f32 v138, v114
    v_cvt_pk_bf16_f32 v148, v136, v137
    v_exp_f32 v139, v115
    v_mfma_f32_32x32x16_bf16 v[88:103], v[188:191], v[156:159], v[88:103]
    buffer_load_dwordx4 v[184:187], v241, s[4:7], s10 offen offset:2048 sc1
    v_exp_f32 v140, v116
    v_cvt_pk_bf16_f32 v149, v138, v139
    v_exp_f32 v141, v117
    v_exp_f32 v142, v118
    v_cvt_pk_bf16_f32 v150, v140, v141
    v_exp_f32 v143, v119
    v_mfma_f32_32x32x16_bf16 v[104:119], v[192:195], v[24:27], 0
    v_cvt_pk_bf16_f32 v151, v142, v143
    v_exp_f32 v136, v120
    v_exp_f32 v137, v121
    v_exp_f32 v138, v122
    v_cvt_pk_bf16_f32 v152, v136, v137
    v_exp_f32 v139, v123
    v_mfma_f32_32x32x16_bf16 v[104:119], v[196:199], v[28:31], v[104:119]
    buffer_load_dwordx4 v[188:191], v241, s[4:7], s10 offen offset:3072 sc1
    v_exp_f32 v140, v124
    v_cvt_pk_bf16_f32 v153, v138, v139
    v_exp_f32 v141, v125
    v_exp_f32 v142, v126
    v_cvt_pk_bf16_f32 v154, v140, v141
    v_exp_f32 v143, v127
    v_mfma_f32_32x32x16_bf16 v[40:55], v[200:203], v[144:147], v[40:55]
    buffer_load_dwordx4 v242, s[12:15], s46 offen offset:2048 sc1 lds
    v_exp_f32 v136, v128
    v_cvt_pk_bf16_f32 v155, v142, v143
    v_exp_f32 v137, v129
    v_exp_f32 v138, v130
    v_cvt_pk_bf16_f32 v156, v136, v137
    v_exp_f32 v139, v131
    v_mfma_f32_32x32x16_bf16 v[40:55], v[204:207], v[148:151], v[40:55]
    s_add_u32 s9, s10, 16384
    v_exp_f32 v140, v132
    v_cvt_pk_bf16_f32 v157, v138, v139
    v_exp_f32 v141, v133
    v_exp_f32 v142, v134
    v_cvt_pk_bf16_f32 v158, v140, v141
    v_exp_f32 v143, v135
    v_mfma_f32_32x32x16_bf16 v[120:135], v[192:195], v[32:35], 0
    s_and_b32 s9, s9, 0x3c000
    v_cvt_pk_bf16_f32 v159, v142, v143
    v_exp_f32 v136, v104
    v_exp_f32 v137, v105
    v_exp_f32 v138, v106
    v_cvt_pk_bf16_f32 v144, v136, v137
    v_exp_f32 v139, v107
    v_mfma_f32_32x32x16_bf16 v[120:135], v[196:199], v[36:39], v[120:135]
    buffer_load_dwordx4 v[192:195], v241, s[4:7], s9 offen offset:0 sc1
    v_exp_f32 v140, v108
    v_cvt_pk_bf16_f32 v145, v138, v139
    v_exp_f32 v141, v109
    v_exp_f32 v142, v110
    v_cvt_pk_bf16_f32 v146, v140, v141
    v_exp_f32 v143, v111
    v_mfma_f32_32x32x16_bf16 v[56:71], v[200:203], v[152:155], v[56:71]
    s_waitcnt vmcnt(16)
    v_exp_f32 v136, v112
    v_cvt_pk_bf16_f32 v147, v142, v143
    v_exp_f32 v137, v113
    v_exp_f32 v138, v114
    v_cvt_pk_bf16_f32 v148, v136, v137
    v_exp_f32 v139, v115
    v_mfma_f32_32x32x16_bf16 v[56:71], v[204:207], v[156:159], v[56:71]
    buffer_load_dwordx4 v[196:199], v241, s[4:7], s9 offen offset:1024 sc1
    v_exp_f32 v140, v116
    v_cvt_pk_bf16_f32 v149, v138, v139
    v_exp_f32 v141, v117
    v_exp_f32 v142, v118
    v_cvt_pk_bf16_f32 v150, v140, v141
    v_exp_f32 v143, v119
    v_mfma_f32_32x32x16_bf16 v[104:119], v[208:211], v[8:11], 0
    v_cvt_pk_bf16_f32 v151, v142, v143
    v_exp_f32 v136, v120
    v_exp_f32 v137, v121
    v_exp_f32 v138, v122
    v_cvt_pk_bf16_f32 v152, v136, v137
    v_exp_f32 v139, v123
    v_mfma_f32_32x32x16_bf16 v[104:119], v[212:215], v[12:15], v[104:119]
    buffer_load_dwordx4 v242, s[12:15], s46 offen offset:3072 sc1 lds
    v_exp_f32 v140, v124
    v_cvt_pk_bf16_f32 v153, v138, v139
    v_exp_f32 v141, v125
    v_exp_f32 v142, v126
    v_cvt_pk_bf16_f32 v154, v140, v141
    v_exp_f32 v143, v127
    v_mfma_f32_32x32x16_bf16 v[72:87], v[200:203], v[144:147], v[72:87]
    v_exp_f32 v136, v128
    v_cvt_pk_bf16_f32 v155, v142, v143
    v_exp_f32 v137, v129
    v_exp_f32 v138, v130
    v_cvt_pk_bf16_f32 v156, v136, v137
    v_exp_f32 v139, v131
    v_mfma_f32_32x32x16_bf16 v[72:87], v[204:207], v[148:151], v[72:87]
    v_exp_f32 v140, v132
    v_cvt_pk_bf16_f32 v157, v138, v139
    v_exp_f32 v141, v133
    v_exp_f32 v142, v134
    v_cvt_pk_bf16_f32 v158, v140, v141
    v_exp_f32 v143, v135
    v_mfma_f32_32x32x16_bf16 v[120:135], v[208:211], v[16:19], 0
    buffer_load_dword v250, v252, s[4:7], s50 offen offset:0
    v_cvt_pk_bf16_f32 v159, v142, v143
    v_exp_f32 v136, v104
    v_exp_f32 v137, v105
    v_exp_f32 v138, v106
    v_cvt_pk_bf16_f32 v144, v136, v137
    v_exp_f32 v139, v107
    v_mfma_f32_32x32x16_bf16 v[120:135], v[212:215], v[20:23], v[120:135]
    s_add_u32 m0, m0, 4096
    v_exp_f32 v140, v108
    v_cvt_pk_bf16_f32 v145, v138, v139
    v_exp_f32 v141, v109
    v_exp_f32 v142, v110
    v_cvt_pk_bf16_f32 v146, v140, v141
    v_exp_f32 v143, v111
    v_mfma_f32_32x32x16_bf16 v[88:103], v[200:203], v[152:155], v[88:103]
    v_exp_f32 v136, v112
    v_cvt_pk_bf16_f32 v147, v142, v143
    v_exp_f32 v137, v113
    v_exp_f32 v138, v114
    v_cvt_pk_bf16_f32 v148, v136, v137
    v_exp_f32 v139, v115
    v_mfma_f32_32x32x16_bf16 v[88:103], v[204:207], v[156:159], v[88:103]
    buffer_load_dwordx4 v[200:203], v241, s[4:7], s9 offen offset:2048 sc1
    v_exp_f32 v140, v116
    v_cvt_pk_bf16_f32 v149, v138, v139
    v_exp_f32 v141, v117
    v_exp_f32 v142, v118
    v_cvt_pk_bf16_f32 v150, v140, v141
    v_exp_f32 v143, v119
    v_mfma_f32_32x32x16_bf16 v[104:119], v[208:211], v[24:27], 0
    buffer_load_dwordx4 v242, s[12:15], s47 offen offset:0 sc1 lds
    v_cvt_pk_bf16_f32 v151, v142, v143
    v_exp_f32 v136, v120
    v_exp_f32 v137, v121
    v_exp_f32 v138, v122
    v_cvt_pk_bf16_f32 v152, v136, v137
    v_exp_f32 v139, v123
    v_mfma_f32_32x32x16_bf16 v[104:119], v[212:215], v[28:31], v[104:119]
    buffer_load_dwordx4 v[204:207], v241, s[4:7], s9 offen offset:3072 sc1
    v_exp_f32 v140, v124
    v_cvt_pk_bf16_f32 v153, v138, v139
    v_exp_f32 v141, v125
    v_exp_f32 v142, v126
    v_cvt_pk_bf16_f32 v154, v140, v141
    v_exp_f32 v143, v127
    v_mfma_f32_32x32x16_bf16 v[40:55], v[216:219], v[144:147], v[40:55]
    s_lshl_b32 s11, s34, 10
    v_exp_f32 v136, v128
    v_cvt_pk_bf16_f32 v155, v142, v143
    v_exp_f32 v137, v129
    v_exp_f32 v138, v130
    v_cvt_pk_bf16_f32 v156, v136, v137
    v_exp_f32 v139, v131
    v_mfma_f32_32x32x16_bf16 v[40:55], v[220:223], v[148:151], v[40:55]
    s_add_u32 s10, s9, 16384
    v_exp_f32 v140, v132
    v_cvt_pk_bf16_f32 v157, v138, v139
    v_exp_f32 v141, v133
    v_exp_f32 v142, v134
    v_cvt_pk_bf16_f32 v158, v140, v141
    v_exp_f32 v143, v135
    v_mfma_f32_32x32x16_bf16 v[120:135], v[208:211], v[32:35], 0
    s_and_b32 s10, s10, 0x3c000
    v_cvt_pk_bf16_f32 v159, v142, v143
    v_exp_f32 v136, v104
    v_exp_f32 v137, v105
    v_exp_f32 v138, v106
    v_cvt_pk_bf16_f32 v144, v136, v137
    v_exp_f32 v139, v107
    v_mfma_f32_32x32x16_bf16 v[120:135], v[212:215], v[36:39], v[120:135]
    buffer_load_dwordx4 v[208:211], v241, s[4:7], s10 offen offset:0 sc1
    v_exp_f32 v140, v108
    v_cvt_pk_bf16_f32 v145, v138, v139
    v_exp_f32 v141, v109
    v_exp_f32 v142, v110
    v_cvt_pk_bf16_f32 v146, v140, v141
    v_exp_f32 v143, v111
    v_mfma_f32_32x32x16_bf16 v[56:71], v[216:219], v[152:155], v[56:71]
    s_waitcnt vmcnt(16)
    v_exp_f32 v136, v112
    v_cvt_pk_bf16_f32 v147, v142, v143
    v_exp_f32 v137, v113
    v_exp_f32 v138, v114
    v_cvt_pk_bf16_f32 v148, v136, v137
    v_exp_f32 v139, v115
    v_mfma_f32_32x32x16_bf16 v[56:71], v[220:223], v[156:159], v[56:71]
    buffer_load_dwordx4 v[212:215], v241, s[4:7], s10 offen offset:1024 sc1
    v_exp_f32 v140, v116
    v_cvt_pk_bf16_f32 v149, v138, v139
    v_exp_f32 v141, v117
    v_exp_f32 v142, v118
    v_cvt_pk_bf16_f32 v150, v140, v141
    v_exp_f32 v143, v119
    v_mfma_f32_32x32x16_bf16 v[104:119], v[160:163], v[8:11], 0
    v_cvt_pk_bf16_f32 v151, v142, v143
    v_exp_f32 v136, v120
    v_exp_f32 v137, v121
    v_exp_f32 v138, v122
    v_cvt_pk_bf16_f32 v152, v136, v137
    v_exp_f32 v139, v123
    v_mfma_f32_32x32x16_bf16 v[104:119], v[164:167], v[12:15], v[104:119]
    buffer_load_dwordx4 v242, s[12:15], s47 offen offset:1024 sc1 lds
    v_exp_f32 v140, v124
    v_cvt_pk_bf16_f32 v153, v138, v139
    v_exp_f32 v141, v125
    v_exp_f32 v142, v126
    v_cvt_pk_bf16_f32 v154, v140, v141
    v_exp_f32 v143, v127
    v_mfma_f32_32x32x16_bf16 v[72:87], v[216:219], v[144:147], v[72:87]
    v_exp_f32 v136, v128
    v_cvt_pk_bf16_f32 v155, v142, v143
    v_exp_f32 v137, v129
    v_exp_f32 v138, v130
    v_cvt_pk_bf16_f32 v156, v136, v137
    v_exp_f32 v139, v131
    v_mfma_f32_32x32x16_bf16 v[72:87], v[220:223], v[148:151], v[72:87]
    buffer_load_dwordx4 v242, s[12:15], s47 offen offset:2048 sc1 lds
    v_exp_f32 v140, v132
    v_cvt_pk_bf16_f32 v157, v138, v139
    v_exp_f32 v141, v133
    v_exp_f32 v142, v134
    v_cvt_pk_bf16_f32 v158, v140, v141
    v_exp_f32 v143, v135
    v_mfma_f32_32x32x16_bf16 v[120:135], v[160:163], v[16:19], 0
    s_add_u32 s11, s11, 13545472
    v_cvt_pk_bf16_f32 v159, v142, v143
    v_exp_f32 v136, v104
    v_exp_f32 v137, v105
    v_exp_f32 v138, v106
    v_cvt_pk_bf16_f32 v144, v136, v137
    v_exp_f32 v139, v107
    v_mfma_f32_32x32x16_bf16 v[120:135], v[164:167], v[20:23], v[120:135]
    v_exp_f32 v140, v108
    v_cvt_pk_bf16_f32 v145, v138, v139
    v_exp_f32 v141, v109
    v_exp_f32 v142, v110
    v_cvt_pk_bf16_f32 v146, v140, v141
    v_exp_f32 v143, v111
    v_mfma_f32_32x32x16_bf16 v[88:103], v[216:219], v[152:155], v[88:103]
    buffer_load_dwordx4 v242, s[12:15], s47 offen offset:3072 sc1 lds
    v_exp_f32 v136, v112
    v_cvt_pk_bf16_f32 v147, v142, v143
    v_exp_f32 v137, v113
    v_exp_f32 v138, v114
    v_cvt_pk_bf16_f32 v148, v136, v137
    v_exp_f32 v139, v115
    v_mfma_f32_32x32x16_bf16 v[88:103], v[220:223], v[156:159], v[88:103]
    buffer_load_dwordx4 v[216:219], v241, s[4:7], s10 offen offset:2048 sc1
    v_exp_f32 v140, v116
    v_cvt_pk_bf16_f32 v149, v138, v139
    v_exp_f32 v141, v117
    v_exp_f32 v142, v118
    v_cvt_pk_bf16_f32 v150, v140, v141
    v_exp_f32 v143, v119
    v_mfma_f32_32x32x16_bf16 v[104:119], v[160:163], v[24:27], 0
    v_cvt_pk_bf16_f32 v151, v142, v143
    v_exp_f32 v136, v120
    v_exp_f32 v137, v121
    v_exp_f32 v138, v122
    v_cvt_pk_bf16_f32 v152, v136, v137
    v_exp_f32 v139, v123
    v_mfma_f32_32x32x16_bf16 v[104:119], v[164:167], v[28:31], v[104:119]
    buffer_load_dwordx4 v[220:223], v241, s[4:7], s10 offen offset:3072 sc1
    v_exp_f32 v140, v124
    v_cvt_pk_bf16_f32 v153, v138, v139
    v_exp_f32 v141, v125
    v_exp_f32 v142, v126
    v_cvt_pk_bf16_f32 v154, v140, v141
    v_exp_f32 v143, v127
    v_mfma_f32_32x32x16_bf16 v[40:55], v[168:171], v[144:147], v[40:55]
    buffer_load_dword v250, v253, s[4:7], s11 offen offset:128
    v_exp_f32 v136, v128
    v_cvt_pk_bf16_f32 v155, v142, v143
    v_exp_f32 v137, v129
    v_exp_f32 v138, v130
    v_cvt_pk_bf16_f32 v156, v136, v137
    v_exp_f32 v139, v131
    v_mfma_f32_32x32x16_bf16 v[40:55], v[172:175], v[148:151], v[40:55]
    v_exp_f32 v140, v132
    v_cvt_pk_bf16_f32 v157, v138, v139
    v_exp_f32 v141, v133
    v_exp_f32 v142, v134
    v_cvt_pk_bf16_f32 v158, v140, v141
    v_exp_f32 v143, v135
    v_mfma_f32_32x32x16_bf16 v[120:135], v[160:163], v[32:35], 0
    v_cvt_pk_bf16_f32 v159, v142, v143
    v_exp_f32 v136, v104
    v_exp_f32 v137, v105
    v_exp_f32 v138, v106
    v_cvt_pk_bf16_f32 v144, v136, v137
    v_exp_f32 v139, v107
    v_mfma_f32_32x32x16_bf16 v[120:135], v[164:167], v[36:39], v[120:135]
    buffer_load_dwordx4 v[160:163], v245, s[12:15], 0 offen offset:0 sc1
    v_exp_f32 v140, v108
    v_cvt_pk_bf16_f32 v145, v138, v139
    v_exp_f32 v141, v109
    v_exp_f32 v142, v110
    v_cvt_pk_bf16_f32 v146, v140, v141
    v_exp_f32 v143, v111
    v_mfma_f32_32x32x16_bf16 v[56:71], v[168:171], v[152:155], v[56:71]
    s_waitcnt vmcnt(17)
    v_exp_f32 v136, v112
    v_cvt_pk_bf16_f32 v147, v142, v143
    v_exp_f32 v137, v113
    v_exp_f32 v138, v114
    v_cvt_pk_bf16_f32 v148, v136, v137
    v_exp_f32 v139, v115
    v_mfma_f32_32x32x16_bf16 v[56:71], v[172:175], v[156:159], v[56:71]
    buffer_load_dwordx4 v[164:167], v245, s[12:15], 0 offen offset:1024 sc1
    v_exp_f32 v140, v116
    v_cvt_pk_bf16_f32 v149, v138, v139
    v_exp_f32 v141, v117
    v_exp_f32 v142, v118
    v_cvt_pk_bf16_f32 v150, v140, v141
    v_exp_f32 v143, v119
    v_mfma_f32_32x32x16_bf16 v[104:119], v[176:179], v[8:11], 0
    v_cvt_pk_bf16_f32 v151, v142, v143
    v_exp_f32 v136, v120
    v_exp_f32 v137, v121
    v_exp_f32 v138, v122
    v_cvt_pk_bf16_f32 v152, v136, v137
    v_exp_f32 v139, v123
    v_mfma_f32_32x32x16_bf16 v[104:119], v[180:183], v[12:15], v[104:119]
    v_exp_f32 v140, v124
    v_cvt_pk_bf16_f32 v153, v138, v139
    v_exp_f32 v141, v125
    v_exp_f32 v142, v126
    v_cvt_pk_bf16_f32 v154, v140, v141
    v_exp_f32 v143, v127
    v_mfma_f32_32x32x16_bf16 v[72:87], v[168:171], v[144:147], v[72:87]
    s_add_u32 s11, s53, 15683584
    v_exp_f32 v136, v128
    v_cvt_pk_bf16_f32 v155, v142, v143
    v_exp_f32 v137, v129
    v_exp_f32 v138, v130
    v_cvt_pk_bf16_f32 v156, v136, v137
    v_exp_f32 v139, v131
    v_mfma_f32_32x32x16_bf16 v[72:87], v[172:175], v[148:151], v[72:87]
    v_exp_f32 v140, v132
    v_cvt_pk_bf16_f32 v157, v138, v139
    v_exp_f32 v141, v133
    v_exp_f32 v142, v134
    v_cvt_pk_bf16_f32 v158, v140, v141
    v_exp_f32 v143, v135
    v_mfma_f32_32x32x16_bf16 v[120:135], v[176:179], v[16:19], 0
    v_cvt_pk_bf16_f32 v159, v142, v143
    v_exp_f32 v136, v104
    v_exp_f32 v137, v105
    v_exp_f32 v138, v106
    v_cvt_pk_bf16_f32 v144, v136, v137
    v_exp_f32 v139, v107
    v_mfma_f32_32x32x16_bf16 v[120:135], v[180:183], v[20:23], v[120:135]
    v_exp_f32 v140, v108
    v_cvt_pk_bf16_f32 v145, v138, v139
    v_exp_f32 v141, v109
    v_exp_f32 v142, v110
    v_cvt_pk_bf16_f32 v146, v140, v141
    v_exp_f32 v143, v111
    v_mfma_f32_32x32x16_bf16 v[88:103], v[168:171], v[152:155], v[88:103]
    v_exp_f32 v136, v112
    v_cvt_pk_bf16_f32 v147, v142, v143
    v_exp_f32 v137, v113
    v_exp_f32 v138, v114
    v_cvt_pk_bf16_f32 v148, v136, v137
    v_exp_f32 v139, v115
    v_mfma_f32_32x32x16_bf16 v[88:103], v[172:175], v[156:159], v[88:103]
    buffer_load_dwordx4 v[168:171], v246, s[12:15], 0 offen offset:0 sc1
    v_exp_f32 v140, v116
    v_cvt_pk_bf16_f32 v149, v138, v139
    v_exp_f32 v141, v117
    v_exp_f32 v142, v118
    v_cvt_pk_bf16_f32 v150, v140, v141
    v_exp_f32 v143, v119
    v_mfma_f32_32x32x16_bf16 v[104:119], v[176:179], v[24:27], 0
    buffer_load_dword v250, v252, s[12:15], s11 offen offset:0
    v_cvt_pk_bf16_f32 v151, v142, v143
    v_exp_f32 v136, v120
    v_exp_f32 v137, v121
    v_exp_f32 v138, v122
    v_cvt_pk_bf16_f32 v152, v136, v137
    v_exp_f32 v139, v123
    v_mfma_f32_32x32x16_bf16 v[104:119], v[180:183], v[28:31], v[104:119]
    buffer_load_dwordx4 v[172:175], v246, s[12:15], 0 offen offset:1024 sc1
    v_exp_f32 v140, v124
    v_cvt_pk_bf16_f32 v153, v138, v139
    v_exp_f32 v141, v125
    v_exp_f32 v142, v126
    v_cvt_pk_bf16_f32 v154, v140, v141
    v_exp_f32 v143, v127
    v_mfma_f32_32x32x16_bf16 v[40:55], v[184:187], v[144:147], v[40:55]
    v_exp_f32 v136, v128
    v_cvt_pk_bf16_f32 v155, v142, v143
    v_exp_f32 v137, v129
    v_exp_f32 v138, v130
    v_cvt_pk_bf16_f32 v156, v136, v137
    v_exp_f32 v139, v131
    v_mfma_f32_32x32x16_bf16 v[40:55], v[188:191], v[148:151], v[40:55]
    v_exp_f32 v140, v132
    v_cvt_pk_bf16_f32 v157, v138, v139
    v_exp_f32 v141, v133
    v_exp_f32 v142, v134
    v_cvt_pk_bf16_f32 v158, v140, v141
    v_exp_f32 v143, v135
    v_mfma_f32_32x32x16_bf16 v[120:135], v[176:179], v[32:35], 0
    v_cvt_pk_bf16_f32 v159, v142, v143
    v_exp_f32 v136, v104
    v_exp_f32 v137, v105
    v_exp_f32 v138, v106
    v_cvt_pk_bf16_f32 v144, v136, v137
    v_exp_f32 v139, v107
    v_mfma_f32_32x32x16_bf16 v[120:135], v[180:183], v[36:39], v[120:135]
    buffer_load_dwordx4 v[176:179], v245, s[12:15], 0 offen offset:2048 sc1
    v_exp_f32 v140, v108
    v_cvt_pk_bf16_f32 v145, v138, v139
    v_exp_f32 v141, v109
    v_exp_f32 v142, v110
    v_cvt_pk_bf16_f32 v146, v140, v141
    v_exp_f32 v143, v111
    v_mfma_f32_32x32x16_bf16 v[56:71], v[184:187], v[152:155], v[56:71]
    s_waitcnt vmcnt(14)
    v_exp_f32 v136, v112
    v_cvt_pk_bf16_f32 v147, v142, v143
    v_exp_f32 v137, v113
    v_exp_f32 v138, v114
    v_cvt_pk_bf16_f32 v148, v136, v137
    v_exp_f32 v139, v115
    v_mfma_f32_32x32x16_bf16 v[56:71], v[188:191], v[156:159], v[56:71]
    buffer_load_dwordx4 v[180:183], v245, s[12:15], 0 offen offset:3072 sc1
    v_exp_f32 v140, v116
    v_cvt_pk_bf16_f32 v149, v138, v139
    v_exp_f32 v141, v117
    v_exp_f32 v142, v118
    v_cvt_pk_bf16_f32 v150, v140, v141
    v_exp_f32 v143, v119
    v_mfma_f32_32x32x16_bf16 v[104:119], v[192:195], v[8:11], 0
    s_add_u32 s11, s54, 17518592
    v_cvt_pk_bf16_f32 v151, v142, v143
    v_exp_f32 v136, v120
    v_exp_f32 v137, v121
    v_exp_f32 v138, v122
    v_cvt_pk_bf16_f32 v152, v136, v137
    v_exp_f32 v139, v123
    v_mfma_f32_32x32x16_bf16 v[104:119], v[196:199], v[12:15], v[104:119]
    v_exp_f32 v140, v124
    v_cvt_pk_bf16_f32 v153, v138, v139
    v_exp_f32 v141, v125
    v_exp_f32 v142, v126
    v_cvt_pk_bf16_f32 v154, v140, v141
    v_exp_f32 v143, v127
    v_mfma_f32_32x32x16_bf16 v[72:87], v[184:187], v[144:147], v[72:87]
    v_exp_f32 v136, v128
    v_cvt_pk_bf16_f32 v155, v142, v143
    v_exp_f32 v137, v129
    v_exp_f32 v138, v130
    v_cvt_pk_bf16_f32 v156, v136, v137
    v_exp_f32 v139, v131
    v_mfma_f32_32x32x16_bf16 v[72:87], v[188:191], v[148:151], v[72:87]
    v_exp_f32 v140, v132
    v_cvt_pk_bf16_f32 v157, v138, v139
    v_exp_f32 v141, v133
    v_exp_f32 v142, v134
    v_cvt_pk_bf16_f32 v158, v140, v141
    v_exp_f32 v143, v135
    v_mfma_f32_32x32x16_bf16 v[120:135], v[192:195], v[16:19], 0
    v_cvt_pk_bf16_f32 v159, v142, v143
    v_exp_f32 v136, v104
    v_exp_f32 v137, v105
    v_exp_f32 v138, v106
    v_cvt_pk_bf16_f32 v144, v136, v137
    v_exp_f32 v139, v107
    v_mfma_f32_32x32x16_bf16 v[120:135], v[196:199], v[20:23], v[120:135]
    buffer_load_dword v250, v254, s[12:15], s11 offen offset:0
    v_exp_f32 v140, v108
    v_cvt_pk_bf16_f32 v145, v138, v139
    v_exp_f32 v141, v109
    v_exp_f32 v142, v110
    v_cvt_pk_bf16_f32 v146, v140, v141
    v_exp_f32 v143, v111
    v_mfma_f32_32x32x16_bf16 v[88:103], v[184:187], v[152:155], v[88:103]
    v_exp_f32 v136, v112
    v_cvt_pk_bf16_f32 v147, v142, v143
    v_exp_f32 v137, v113
    v_exp_f32 v138, v114
    v_cvt_pk_bf16_f32 v148, v136, v137
    v_exp_f32 v139, v115
    v_mfma_f32_32x32x16_bf16 v[88:103], v[188:191], v[156:159], v[88:103]
    buffer_load_dwordx4 v[184:187], v246, s[12:15], 0 offen offset:2048 sc1
    v_exp_f32 v140, v116
    v_cvt_pk_bf16_f32 v149, v138, v139
    v_exp_f32 v141, v117
    v_exp_f32 v142, v118
    v_cvt_pk_bf16_f32 v150, v140, v141
    v_exp_f32 v143, v119
    v_mfma_f32_32x32x16_bf16 v[104:119], v[192:195], v[24:27], 0
    v_cvt_pk_bf16_f32 v151, v142, v143
    v_exp_f32 v136, v120
    v_exp_f32 v137, v121
    v_exp_f32 v138, v122
    v_cvt_pk_bf16_f32 v152, v136, v137
    v_exp_f32 v139, v123
    v_mfma_f32_32x32x16_bf16 v[104:119], v[196:199], v[28:31], v[104:119]
    buffer_load_dwordx4 v[188:191], v246, s[12:15], 0 offen offset:3072 sc1
    v_exp_f32 v140, v124
    v_cvt_pk_bf16_f32 v153, v138, v139
    v_exp_f32 v141, v125
    v_exp_f32 v142, v126
    v_cvt_pk_bf16_f32 v154, v140, v141
    v_exp_f32 v143, v127
    v_mfma_f32_32x32x16_bf16 v[40:55], v[200:203], v[144:147], v[40:55]
    v_exp_f32 v136, v128
    v_cvt_pk_bf16_f32 v155, v142, v143
    v_exp_f32 v137, v129
    v_exp_f32 v138, v130
    v_cvt_pk_bf16_f32 v156, v136, v137
    v_exp_f32 v139, v131
    v_mfma_f32_32x32x16_bf16 v[40:55], v[204:207], v[148:151], v[40:55]
    v_exp_f32 v140, v132
    v_cvt_pk_bf16_f32 v157, v138, v139
    v_exp_f32 v141, v133
    v_exp_f32 v142, v134
    v_cvt_pk_bf16_f32 v158, v140, v141
    v_exp_f32 v143, v135
    v_mfma_f32_32x32x16_bf16 v[120:135], v[192:195], v[32:35], 0
    v_cvt_pk_bf16_f32 v159, v142, v143
    v_exp_f32 v136, v104
    v_exp_f32 v137, v105
    v_exp_f32 v138, v106
    v_cvt_pk_bf16_f32 v144, v136, v137
    v_exp_f32 v139, v107
    v_mfma_f32_32x32x16_bf16 v[120:135], v[196:199], v[36:39], v[120:135]
    buffer_load_dwordx4 v[192:195], v245, s[12:15], s42 offen offset:0 sc1
    v_exp_f32 v140, v108
    v_cvt_pk_bf16_f32 v145, v138, v139
    v_exp_f32 v141, v109
    v_exp_f32 v142, v110
    v_cvt_pk_bf16_f32 v146, v140, v141
    v_exp_f32 v143, v111
    v_mfma_f32_32x32x16_bf16 v[56:71], v[200:203], v[152:155], v[56:71]
    s_waitcnt vmcnt(12)
    v_exp_f32 v136, v112
    v_cvt_pk_bf16_f32 v147, v142, v143
    v_exp_f32 v137, v113
    v_exp_f32 v138, v114
    v_cvt_pk_bf16_f32 v148, v136, v137
    v_exp_f32 v139, v115
    v_mfma_f32_32x32x16_bf16 v[56:71], v[204:207], v[156:159], v[56:71]
    buffer_load_dwordx4 v[196:199], v245, s[12:15], s42 offen offset:1024 sc1
    v_exp_f32 v140, v116
    v_cvt_pk_bf16_f32 v149, v138, v139
    v_exp_f32 v141, v117
    v_exp_f32 v142, v118
    v_cvt_pk_bf16_f32 v150, v140, v141
    v_exp_f32 v143, v119
    v_mfma_f32_32x32x16_bf16 v[104:119], v[208:211], v[8:11], 0
    v_cvt_pk_bf16_f32 v151, v142, v143
    v_exp_f32 v136, v120
    v_exp_f32 v137, v121
    v_exp_f32 v138, v122
    v_cvt_pk_bf16_f32 v152, v136, v137
    v_exp_f32 v139, v123
    v_mfma_f32_32x32x16_bf16 v[104:119], v[212:215], v[12:15], v[104:119]
    v_exp_f32 v140, v124
    v_cvt_pk_bf16_f32 v153, v138, v139
    v_exp_f32 v141, v125
    v_exp_f32 v142, v126
    v_cvt_pk_bf16_f32 v154, v140, v141
    v_exp_f32 v143, v127
    v_mfma_f32_32x32x16_bf16 v[72:87], v[200:203], v[144:147], v[72:87]
    v_exp_f32 v136, v128
    v_cvt_pk_bf16_f32 v155, v142, v143
    v_exp_f32 v137, v129
    v_exp_f32 v138, v130
    v_cvt_pk_bf16_f32 v156, v136, v137
    v_exp_f32 v139, v131
    v_mfma_f32_32x32x16_bf16 v[72:87], v[204:207], v[148:151], v[72:87]
    v_exp_f32 v140, v132
    v_cvt_pk_bf16_f32 v157, v138, v139
    v_exp_f32 v141, v133
    v_exp_f32 v142, v134
    v_cvt_pk_bf16_f32 v158, v140, v141
    v_exp_f32 v143, v135
    v_mfma_f32_32x32x16_bf16 v[120:135], v[208:211], v[16:19], 0
    v_cvt_pk_bf16_f32 v159, v142, v143
    v_exp_f32 v136, v104
    v_exp_f32 v137, v105
    v_exp_f32 v138, v106
    v_cvt_pk_bf16_f32 v144, v136, v137
    v_exp_f32 v139, v107
    v_mfma_f32_32x32x16_bf16 v[120:135], v[212:215], v[20:23], v[120:135]
    v_exp_f32 v140, v108
    v_cvt_pk_bf16_f32 v145, v138, v139
    v_exp_f32 v141, v109
    v_exp_f32 v142, v110
    v_cvt_pk_bf16_f32 v146, v140, v141
    v_exp_f32 v143, v111
    v_mfma_f32_32x32x16_bf16 v[88:103], v[200:203], v[152:155], v[88:103]
    v_exp_f32 v136, v112
    v_cvt_pk_bf16_f32 v147, v142, v143
    v_exp_f32 v137, v113
    v_exp_f32 v138, v114
    v_cvt_pk_bf16_f32 v148, v136, v137
    v_exp_f32 v139, v115
    v_mfma_f32_32x32x16_bf16 v[88:103], v[204:207], v[156:159], v[88:103]
    buffer_load_dwordx4 v[200:203], v246, s[12:15], s42 offen offset:0 sc1
    v_exp_f32 v140, v116
    v_cvt_pk_bf16_f32 v149, v138, v139
    v_exp_f32 v141, v117
    v_exp_f32 v142, v118
    v_cvt_pk_bf16_f32 v150, v140, v141
    v_exp_f32 v143, v119
    v_mfma_f32_32x32x16_bf16 v[104:119], v[208:211], v[24:27], 0
    v_cvt_pk_bf16_f32 v151, v142, v143
    v_exp_f32 v136, v120
    v_exp_f32 v137, v121
    v_exp_f32 v138, v122
    v_cvt_pk_bf16_f32 v152, v136, v137
    v_exp_f32 v139, v123
    v_mfma_f32_32x32x16_bf16 v[104:119], v[212:215], v[28:31], v[104:119]
    buffer_load_dwordx4 v[204:207], v246, s[12:15], s42 offen offset:1024 sc1
    v_exp_f32 v140, v124
    v_cvt_pk_bf16_f32 v153, v138, v139
    v_exp_f32 v141, v125
    v_exp_f32 v142, v126
    v_cvt_pk_bf16_f32 v154, v140, v141
    v_exp_f32 v143, v127
    v_mfma_f32_32x32x16_bf16 v[40:55], v[216:219], v[144:147], v[40:55]
    v_exp_f32 v136, v128
    v_cvt_pk_bf16_f32 v155, v142, v143
    v_exp_f32 v137, v129
    v_exp_f32 v138, v130
    v_cvt_pk_bf16_f32 v156, v136, v137
    v_exp_f32 v139, v131
    v_mfma_f32_32x32x16_bf16 v[40:55], v[220:223], v[148:151], v[40:55]
    v_exp_f32 v140, v132
    v_cvt_pk_bf16_f32 v157, v138, v139
    v_exp_f32 v141, v133
    v_exp_f32 v142, v134
    v_cvt_pk_bf16_f32 v158, v140, v141
    v_exp_f32 v143, v135
    v_mfma_f32_32x32x16_bf16 v[120:135], v[208:211], v[32:35], 0
    v_cvt_pk_bf16_f32 v159, v142, v143
    v_exp_f32 v136, v104
    v_exp_f32 v137, v105
    v_exp_f32 v138, v106
    v_cvt_pk_bf16_f32 v144, v136, v137
    v_exp_f32 v139, v107
    v_mfma_f32_32x32x16_bf16 v[120:135], v[212:215], v[36:39], v[120:135]
    buffer_load_dwordx4 v[208:211], v245, s[12:15], s42 offen offset:2048 sc1
    ds_write_b128 v6, v[40:43] offset:0
    v_exp_f32 v140, v108
    v_cvt_pk_bf16_f32 v145, v138, v139
    v_exp_f32 v141, v109
    v_exp_f32 v142, v110
    v_cvt_pk_bf16_f32 v146, v140, v141
    v_exp_f32 v143, v111
    v_mfma_f32_32x32x16_bf16 v[56:71], v[216:219], v[152:155], v[56:71]
    ds_write_b128 v6, v[44:47] offset:1024
    v_cndmask_b32 v53, v53, v224, s[36:37]
    v_exp_f32 v136, v112
    v_cvt_pk_bf16_f32 v147, v142, v143
    v_exp_f32 v137, v113
    v_exp_f32 v138, v114
    v_cvt_pk_bf16_f32 v148, v136, v137
    v_exp_f32 v139, v115
    v_mfma_f32_32x32x16_bf16 v[56:71], v[220:223], v[156:159], v[56:71]
    buffer_load_dwordx4 v[212:215], v245, s[12:15], s42 offen offset:3072 sc1
    ds_write_b128 v6, v[48:51] offset:2048
    v_exp_f32 v140, v116
    v_cvt_pk_bf16_f32 v149, v138, v139
    v_exp_f32 v141, v117
    v_exp_f32 v142, v118
    v_cvt_pk_bf16_f32 v150, v140, v141
    v_exp_f32 v143, v119
    ds_write_b128 v6, v[52:55] offset:3072
    v_cvt_pk_bf16_f32 v151, v142, v143
    v_exp_f32 v136, v120
    v_exp_f32 v137, v121
    v_exp_f32 v138, v122
    v_cvt_pk_bf16_f32 v152, v136, v137
    v_exp_f32 v139, v123
    ds_write_b128 v5, v[56:59] offset:0
    v_exp_f32 v140, v124
    v_cvt_pk_bf16_f32 v153, v138, v139
    v_exp_f32 v141, v125
    v_exp_f32 v142, v126
    v_cvt_pk_bf16_f32 v154, v140, v141
    v_exp_f32 v143, v127
    v_mfma_f32_32x32x16_bf16 v[72:87], v[216:219], v[144:147], v[72:87]
    ds_write_b128 v5, v[60:63] offset:1024
    v_cndmask_b32 v69, v69, v225, s[36:37]
    v_exp_f32 v136, v128
    v_cvt_pk_bf16_f32 v155, v142, v143
    v_exp_f32 v137, v129
    v_exp_f32 v138, v130
    v_cvt_pk_bf16_f32 v156, v136, v137
    v_exp_f32 v139, v131
    v_mfma_f32_32x32x16_bf16 v[72:87], v[220:223], v[148:151], v[72:87]
    ds_write_b128 v5, v[64:67] offset:2048
    v_exp_f32 v140, v132
    v_cvt_pk_bf16_f32 v157, v138, v139
    v_exp_f32 v141, v133
    v_exp_f32 v142, v134
    v_cvt_pk_bf16_f32 v158, v140, v141
    v_exp_f32 v143, v135
    ds_write_b128 v5, v[68:71] offset:3072
    v_cvt_pk_bf16_f32 v159, v142, v143
    v_mfma_f32_32x32x16_bf16 v[88:103], v[216:219], v[152:155], v[88:103]
    v_mov_b32 v228, 0x4e800000
    v_mfma_f32_32x32x16_bf16 v[88:103], v[220:223], v[156:159], v[88:103]
    v_cmp_nle_f32 s[62:63], v52, v228
    v_cmp_nle_f32 s[10:11], v68, v228
    v_cndmask_b32 v85, v85, v226, s[36:37]
    v_cmp_nle_f32 vcc, v84, v228
    ds_write_b128 v4, v[72:75] offset:0
    ds_write_b128 v4, v[76:79] offset:1024
    ds_write_b128 v4, v[80:83] offset:2048
    ds_write_b128 v4, v[84:87] offset:3072
    buffer_load_dwordx4 v[216:219], v246, s[12:15], s42 offen offset:2048 sc1
    buffer_load_dwordx4 v[220:223], v246, s[12:15], s42 offen offset:3072 sc1
    s_or_b32 s63, s63, s11
    s_or_b32 s63, s63, vcc_hi
    v_cmp_nle_f32 vcc, v100, v228
    v_min3_f32 v228, v52, v68, v84
    s_or_b32 s63, s63, vcc_hi
    v_min_f32 v228, v228, v100
    v_cmp_gt_f32 vcc, 0x30800000, v228
    s_or_b32 s63, s63, vcc_hi
    s_cmp_lg_u32 s63, 0
    s_cbranch_scc1 L_attn_fb_47
L_attn_merge_46:
    v_mov_b32 v235, v227
    s_waitcnt lgkmcnt(0)
    s_barrier
    ds_read_b128 v[52:55], v7 offset:3072
    ds_read_b128 v[68:71], v7 offset:7168
    ds_read_b128 v[84:87], v7 offset:11264
    ds_read_b128 v[40:43], v7 offset:0
    ds_read_b128 v[44:47], v7 offset:1024
    ds_read_b128 v[48:51], v7 offset:2048
    ds_read_b128 v[56:59], v7 offset:4096
    ds_read_b128 v[60:63], v7 offset:5120
    ds_read_b128 v[64:67], v7 offset:6144
    ds_read_b128 v[72:75], v7 offset:8192
    ds_read_b128 v[76:79], v7 offset:9216
    ds_read_b128 v[80:83], v7 offset:10240
    v_permlane32_swap_b32 v235, v227
    s_waitcnt lgkmcnt(9)
    v_mov_b32 v224, v53
    v_mov_b32 v232, v53
    v_mov_b32 v225, v69
    v_mov_b32 v233, v69
    v_mov_b32 v226, v85
    v_mov_b32 v234, v85
    s_nop 0
    v_permlane32_swap_b32 v232, v224
    v_permlane32_swap_b32 v233, v225
    v_permlane32_swap_b32 v234, v226
    v_min3_f32 v229, v224, v225, v227
    v_min_f32 v229, v229, v226
    v_sub_f32 v224, v229, v224
    v_sub_f32 v225, v229, v225
    v_sub_f32 v226, v229, v226
    v_sub_f32 v227, v229, v227
    v_exp_f32 v110, v227
    v_exp_f32 v104, v224
    v_exp_f32 v106, v225
    v_exp_f32 v108, v226
    v_mul_f32 v228, v100, v110
    v_fma_f32 v228, v52, v104, v228
    v_fma_f32 v228, v68, v106, v228
    v_fma_f32 v228, v84, v108, v228
    v_mov_b32 v229, v228
    v_pk_mul_f32 v[88:89], v[88:89], v[110:111] op_sel_hi:[1,0]
    v_pk_mul_f32 v[90:91], v[90:91], v[110:111] op_sel_hi:[1,0]
    v_permlane32_swap_b32 v228, v229
    v_rcp_f32 v230, v229
    v_pk_mul_f32 v[92:93], v[92:93], v[110:111] op_sel_hi:[1,0]
    v_pk_mul_f32 v[94:95], v[94:95], v[110:111] op_sel_hi:[1,0]
    v_pk_mul_f32 v[96:97], v[96:97], v[110:111] op_sel_hi:[1,0]
    v_pk_mul_f32 v[98:99], v[98:99], v[110:111] op_sel_hi:[1,0]
    v_pk_mul_f32 v[100:101], v[100:101], v[110:111] op_sel_hi:[1,0]
    v_pk_mul_f32 v[102:103], v[102:103], v[110:111] op_sel_hi:[1,0]
    s_waitcnt lgkmcnt(6)
    v_pk_fma_f32 v[88:89], v[40:41], v[104:105], v[88:89] op_sel_hi:[1,0,1]
    v_pk_fma_f32 v[90:91], v[42:43], v[104:105], v[90:91] op_sel_hi:[1,0,1]
    v_pk_fma_f32 v[92:93], v[44:45], v[104:105], v[92:93] op_sel_hi:[1,0,1]
    v_pk_fma_f32 v[94:95], v[46:47], v[104:105], v[94:95] op_sel_hi:[1,0,1]
    v_pk_fma_f32 v[96:97], v[48:49], v[104:105], v[96:97] op_sel_hi:[1,0,1]
    v_pk_fma_f32 v[98:99], v[50:51], v[104:105], v[98:99] op_sel_hi:[1,0,1]
    v_pk_fma_f32 v[100:101], v[52:53], v[104:105], v[100:101] op_sel_hi:[1,0,1]
    v_pk_fma_f32 v[102:103], v[54:55], v[104:105], v[102:103] op_sel_hi:[1,0,1]
    s_waitcnt lgkmcnt(3)
    v_pk_fma_f32 v[88:89], v[56:57], v[106:107], v[88:89] op_sel_hi:[1,0,1]
    v_pk_fma_f32 v[90:91], v[58:59], v[106:107], v[90:91] op_sel_hi:[1,0,1]
    v_pk_fma_f32 v[92:93], v[60:61], v[106:107], v[92:93] op_sel_hi:[1,0,1]
    v_pk_fma_f32 v[94:95], v[62:63], v[106:107], v[94:95] op_sel_hi:[1,0,1]
    v_pk_fma_f32 v[96:97], v[64:65], v[106:107], v[96:97] op_sel_hi:[1,0,1]
    v_pk_fma_f32 v[98:99], v[66:67], v[106:107], v[98:99] op_sel_hi:[1,0,1]
    v_pk_fma_f32 v[100:101], v[68:69], v[106:107], v[100:101] op_sel_hi:[1,0,1]
    v_pk_fma_f32 v[102:103], v[70:71], v[106:107], v[102:103] op_sel_hi:[1,0,1]
    s_waitcnt lgkmcnt(0)
    v_pk_fma_f32 v[88:89], v[72:73], v[108:109], v[88:89] op_sel_hi:[1,0,1]
    v_pk_fma_f32 v[90:91], v[74:75], v[108:109], v[90:91] op_sel_hi:[1,0,1]
    v_pk_fma_f32 v[92:93], v[76:77], v[108:109], v[92:93] op_sel_hi:[1,0,1]
    v_pk_fma_f32 v[94:95], v[78:79], v[108:109], v[94:95] op_sel_hi:[1,0,1]
    v_pk_fma_f32 v[96:97], v[80:81], v[108:109], v[96:97] op_sel_hi:[1,0,1]
    v_pk_fma_f32 v[98:99], v[82:83], v[108:109], v[98:99] op_sel_hi:[1,0,1]
    v_pk_fma_f32 v[100:101], v[84:85], v[108:109], v[100:101] op_sel_hi:[1,0,1]
    v_pk_fma_f32 v[102:103], v[86:87], v[108:109], v[102:103] op_sel_hi:[1,0,1]
    v_pk_mul_f32 v[88:89], v[88:89], v[230:231] op_sel_hi:[1,0]
    v_pk_mul_f32 v[90:91], v[90:91], v[230:231] op_sel_hi:[1,0]
    v_pk_mul_f32 v[92:93], v[92:93], v[230:231] op_sel_hi:[1,0]
    v_pk_mul_f32 v[94:95], v[94:95], v[230:231] op_sel_hi:[1,0]
    v_cvt_pk_bf16_f32 v144, v88, v89
    v_cvt_pk_bf16_f32 v145, v90, v91
    v_cvt_pk_bf16_f32 v146, v92, v93
    v_cvt_pk_bf16_f32 v147, v94, v95
    buffer_store_dwordx4 v[144:147], v1, s[4:7], s50 offen
    v_pk_mul_f32 v[96:97], v[96:97], v[230:231] op_sel_hi:[1,0]
    v_pk_mul_f32 v[98:99], v[98:99], v[230:231] op_sel_hi:[1,0]
    v_pk_mul_f32 v[100:101], v[100:101], v[230:231] op_sel_hi:[1,0]
    v_pk_mul_f32 v[102:103], v[102:103], v[230:231] op_sel_hi:[1,0]
    v_cvt_pk_bf16_f32 v148, v96, v97
    v_cvt_pk_bf16_f32 v149, v98, v99
    v_cvt_pk_bf16_f32 v150, v100, v101
    v_cvt_pk_bf16_f32 v151, v102, v103
    v_cndmask_b32 v150, v150, 0, s[36:37]
    v_cndmask_b32 v151, v151, 0, s[36:37]
    buffer_store_dwordx4 v[148:151], v1, s[4:7], s50 offen offset:1024
    v_mov_b32 v255, 1
    s_cmp_lg_u32 s24, 0
    s_mov_b64 exec, 1
    s_waitcnt vmcnt(0)
    s_cbranch_scc1 L_pub_slow_48
    buffer_store_dword v255, off, s[4:7], s51 offset:128
L_pub_done_49:
    s_mov_b64 exec, -1
    s_barrier
    s_cmp_eq_u32 s29, 0
    s_cbranch_scc1 L_end
    s_lshl_b32 s9, s30, 15
    s_lshl_b32 s10, s8, 13
    s_add_u32 s10, s10, 17747968
    s_add_u32 s11, s9, s10
    v_add_u32 v8, s11, v1
    s_xor_b32 s9, s9, 32768
    s_add_u32 s11, s9, s10
    v_add_u32 v9, s11, v1
    v_accvgpr_read_b32 v80, a240
    v_accvgpr_read_b32 v81, a241
    v_accvgpr_read_b32 v82, a242
    v_accvgpr_read_b32 v83, a243
    v_accvgpr_read_b32 v84, a244
    v_accvgpr_read_b32 v85, a245
    v_accvgpr_read_b32 v86, a246
    v_accvgpr_read_b32 v87, a247
    v_lshlrev_b32 v16, 16, v80
    v_and_b32 v17, 0xffff0000, v80
    v_lshlrev_b32 v18, 16, v81
    v_and_b32 v19, 0xffff0000, v81
    v_lshlrev_b32 v20, 16, v82
    v_and_b32 v21, 0xffff0000, v82
    v_lshlrev_b32 v22, 16, v83
    v_and_b32 v23, 0xffff0000, v83
    v_lshlrev_b32 v24, 16, v84
    v_and_b32 v25, 0xffff0000, v84
    v_lshlrev_b32 v26, 16, v85
    v_and_b32 v27, 0xffff0000, v85
    v_lshlrev_b32 v28, 16, v86
    v_and_b32 v29, 0xffff0000, v86
    v_lshlrev_b32 v30, 16, v87
    v_and_b32 v31, 0xffff0000, v87
    s_mov_b64 exec, s[38:39]
L_poll_50:
    buffer_load_dword v255, v3, s[4:7], s52 offen offset:128 sc1
    s_waitcnt vmcnt(0)
    v_cmp_eq_u32 vcc, 0, v255
    s_cbranch_vccz L_poll_done_51
    s_sub_u32 s25, s25, 1
    s_cmp_gt_i32 s25, 0
    s_cbranch_scc1 L_poll_50
    s_mov_b32 s25, 0
L_poll_done_51:
    s_mov_b64 exec, -1
    s_cmp_lg_u32 s24, 0
    s_cbranch_scc1 L_poll_slow_52
L_poll_ret_53:
    buffer_load_dwordx4 v[80:83], v8, s[4:7], 0 offen offset:0 sc1
    buffer_load_dwordx4 v[84:87], v9, s[4:7], 0 offen offset:0 sc1
    buffer_load_dwordx4 v[88:91], v8, s[4:7], 0 offen offset:1024 sc1
    buffer_load_dwordx4 v[92:95], v9, s[4:7], 0 offen offset:1024 sc1
    buffer_load_dwordx4 v[96:99], v8, s[4:7], 0 offen offset:2048 sc1
    buffer_load_dwordx4 v[100:103], v9, s[4:7], 0 offen offset:2048 sc1
    buffer_load_dwordx4 v[104:107], v8, s[4:7], 0 offen offset:3072 sc1
    buffer_load_dwordx4 v[108:111], v9, s[4:7], 0 offen offset:3072 sc1
    s_waitcnt vmcnt(7)
    v_mfma_f32_32x32x16_bf16 v[16:31], v[160:163], v[80:83], v[16:31]
    buffer_load_dwordx4 v[112:115], v8, s[4:7], s42 offen offset:0 sc1
    v_mfma_f32_32x32x16_bf16 v[32:47], v[168:171], v[80:83], 0
    s_waitcnt vmcnt(7)
    v_mfma_f32_32x32x16_bf16 v[48:63], v[160:163], v[84:87], 0
    buffer_load_dwordx4 v[116:119], v9, s[4:7], s42 offen offset:0 sc1
    v_mfma_f32_32x32x16_bf16 v[64:79], v[168:171], v[84:87], 0
    s_waitcnt vmcnt(7)
    v_mfma_f32_32x32x16_bf16 v[16:31], v[164:167], v[88:91], v[16:31]
    buffer_load_dwordx4 v[120:123], v8, s[4:7], s42 offen offset:1024 sc1
    v_mfma_f32_32x32x16_bf16 v[32:47], v[172:175], v[88:91], v[32:47]
    s_waitcnt vmcnt(7)
    v_mfma_f32_32x32x16_bf16 v[48:63], v[164:167], v[92:95], v[48:63]
    buffer_load_dwordx4 v[124:127], v9, s[4:7], s42 offen offset:1024 sc1
    v_mfma_f32_32x32x16_bf16 v[64:79], v[172:175], v[92:95], v[64:79]
    s_waitcnt vmcnt(7)
    v_mfma_f32_32x32x16_bf16 v[16:31], v[176:179], v[96:99], v[16:31]
    buffer_load_dwordx4 v[128:131], v8, s[4:7], s42 offen offset:2048 sc1
    v_mfma_f32_32x32x16_bf16 v[32:47], v[184:187], v[96:99], v[32:47]
    s_waitcnt vmcnt(7)
    v_mfma_f32_32x32x16_bf16 v[48:63], v[176:179], v[100:103], v[48:63]
    buffer_load_dwordx4 v[132:135], v9, s[4:7], s42 offen offset:2048 sc1
    v_mfma_f32_32x32x16_bf16 v[64:79], v[184:187], v[100:103], v[64:79]
    s_waitcnt vmcnt(7)
    v_mfma_f32_32x32x16_bf16 v[16:31], v[180:183], v[104:107], v[16:31]
    buffer_load_dwordx4 v[136:139], v8, s[4:7], s42 offen offset:3072 sc1
    v_mfma_f32_32x32x16_bf16 v[32:47], v[188:191], v[104:107], v[32:47]
    s_waitcnt vmcnt(7)
    v_mfma_f32_32x32x16_bf16 v[48:63], v[180:183], v[108:111], v[48:63]
    buffer_load_dwordx4 v[140:143], v9, s[4:7], s42 offen offset:3072 sc1
    v_mfma_f32_32x32x16_bf16 v[64:79], v[188:191], v[108:111], v[64:79]
    s_waitcnt vmcnt(7)
    v_mfma_f32_32x32x16_bf16 v[32:47], v[200:203], v[112:115], v[32:47]
    s_waitcnt vmcnt(5)
    v_mfma_f32_32x32x16_bf16 v[32:47], v[204:207], v[120:123], v[32:47]
    s_waitcnt vmcnt(3)
    v_mfma_f32_32x32x16_bf16 v[32:47], v[216:219], v[128:131], v[32:47]
    s_waitcnt vmcnt(1)
    v_mfma_f32_32x32x16_bf16 v[32:47], v[220:223], v[136:139], v[32:47]
    v_mfma_f32_32x32x16_bf16 v[64:79], v[200:203], v[116:119], v[64:79]
    s_nop 4
    v_mfma_f32_32x32x16_bf16 v[64:79], v[204:207], v[124:127], v[64:79]
    s_nop 4
    v_mfma_f32_32x32x16_bf16 v[64:79], v[216:219], v[132:135], v[64:79]
    ds_write_b128 v4, v[32:35] offset:0
    ds_write_b128 v4, v[36:39] offset:1024
    s_waitcnt vmcnt(0)
    v_mfma_f32_32x32x16_bf16 v[64:79], v[220:223], v[140:143], v[64:79]
    ds_write_b128 v4, v[40:43] offset:2048
    ds_write_b128 v4, v[44:47] offset:3072
    v_mfma_f32_32x32x16_bf16 v[48:63], v[192:195], v[116:119], v[48:63]
    s_nop 4
    v_mfma_f32_32x32x16_bf16 v[48:63], v[196:199], v[124:127], v[48:63]
    s_nop 4
    v_mfma_f32_32x32x16_bf16 v[48:63], v[208:211], v[132:135], v[48:63]
    ds_write_b128 v6, v[64:67] offset:0
    ds_write_b128 v6, v[68:71] offset:1024
    v_mfma_f32_32x32x16_bf16 v[48:63], v[212:215], v[140:143], v[48:63]
    ds_write_b128 v6, v[72:75] offset:2048
    ds_write_b128 v6, v[76:79] offset:3072
    v_mfma_f32_32x32x16_bf16 v[16:31], v[192:195], v[112:115], v[16:31]
    s_nop 4
    v_mfma_f32_32x32x16_bf16 v[16:31], v[196:199], v[120:123], v[16:31]
    s_nop 4
    v_mfma_f32_32x32x16_bf16 v[16:31], v[208:211], v[128:131], v[16:31]
    ds_write_b128 v5, v[48:51] offset:0
    ds_write_b128 v5, v[52:55] offset:1024
    v_mfma_f32_32x32x16_bf16 v[16:31], v[212:215], v[136:139], v[16:31]
    ds_write_b128 v5, v[56:59] offset:2048
    ds_write_b128 v5, v[60:63] offset:3072
    s_waitcnt lgkmcnt(0)
    s_barrier
    ds_read_b128 v[32:35], v7 offset:0
    ds_read_b128 v[36:39], v7 offset:1024
    ds_read_b128 v[40:43], v7 offset:2048
    ds_read_b128 v[44:47], v7 offset:3072
    ds_read_b128 v[48:51], v7 offset:4096
    ds_read_b128 v[52:55], v7 offset:5120
    ds_read_b128 v[56:59], v7 offset:6144
    ds_read_b128 v[60:63], v7 offset:7168
    ds_read_b128 v[64:67], v7 offset:8192
    ds_read_b128 v[68:71], v7 offset:9216
    ds_read_b128 v[72:75], v7 offset:10240
    ds_read_b128 v[76:79], v7 offset:11264
    v_mov_b32 v9, 0x3f803f80
    v_mov_b32 v10, 0
    v_mov_b32 v11, 0
    v_lshlrev_b32 v12, 3, v0
    s_add_u32 s9, s53, 15683584
    s_add_u32 s10, s54, 17518592
    s_add_u32 s11, s55, 13561856
    s_waitcnt lgkmcnt(8)
    v_pk_add_f32 v[16:17], v[16:17], v[32:33]
    v_pk_add_f32 v[18:19], v[18:19], v[34:35]
    v_pk_add_f32 v[20:21], v[20:21], v[36:37]
    v_pk_add_f32 v[22:23], v[22:23], v[38:39]
    v_pk_add_f32 v[24:25], v[24:25], v[40:41]
    v_pk_add_f32 v[26:27], v[26:27], v[42:43]
    v_pk_add_f32 v[28:29], v[28:29], v[44:45]
    v_pk_add_f32 v[30:31], v[30:31], v[46:47]
    s_waitcnt lgkmcnt(4)
    v_pk_add_f32 v[16:17], v[16:17], v[48:49]
    v_pk_add_f32 v[18:19], v[18:19], v[50:51]
    v_pk_add_f32 v[20:21], v[20:21], v[52:53]
    v_pk_add_f32 v[22:23], v[22:23], v[54:55]
    v_pk_add_f32 v[24:25], v[24:25], v[56:57]
    v_pk_add_f32 v[26:27], v[26:27], v[58:59]
    v_pk_add_f32 v[28:29], v[28:29], v[60:61]
    v_pk_add_f32 v[30:31], v[30:31], v[62:63]
    s_waitcnt lgkmcnt(0)
    v_pk_add_f32 v[16:17], v[16:17], v[64:65]
    v_pk_add_f32 v[18:19], v[18:19], v[66:67]
    v_pk_add_f32 v[20:21], v[20:21], v[68:69]
    v_pk_add_f32 v[22:23], v[22:23], v[70:71]
    v_pk_add_f32 v[24:25], v[24:25], v[72:73]
    v_pk_add_f32 v[26:27], v[26:27], v[74:75]
    v_pk_add_f32 v[28:29], v[28:29], v[76:77]
    v_pk_add_f32 v[30:31], v[30:31], v[78:79]
    v_cvt_pk_bf16_f32 v80, v16, v17
    v_cvt_pk_bf16_f32 v81, v18, v19
    v_cvt_pk_bf16_f32 v82, v20, v21
    v_cvt_pk_bf16_f32 v83, v22, v23
    buffer_store_dwordx4 v[80:83], v1, s[4:7], s9 offen
    v_cvt_pk_bf16_f32 v84, v24, v25
    v_cvt_pk_bf16_f32 v85, v26, v27
    v_cvt_pk_bf16_f32 v86, v28, v29
    v_cvt_pk_bf16_f32 v87, v30, v31
    buffer_store_dwordx4 v[84:87], v1, s[4:7], s9 offen offset:1024
    v_dot2_f32_bf16 v10, v80, v9, v10
    v_dot2_f32_bf16 v11, v80, v80, v11
    v_dot2_f32_bf16 v10, v81, v9, v10
    v_dot2_f32_bf16 v11, v81, v81, v11
    v_dot2_f32_bf16 v10, v82, v9, v10
    v_dot2_f32_bf16 v11, v82, v82, v11
    v_dot2_f32_bf16 v10, v83, v9, v10
    v_dot2_f32_bf16 v11, v83, v83, v11
    v_dot2_f32_bf16 v10, v84, v9, v10
    v_dot2_f32_bf16 v11, v84, v84, v11
    v_dot2_f32_bf16 v10, v85, v9, v10
    v_dot2_f32_bf16 v11, v85, v85, v11
    v_dot2_f32_bf16 v10, v86, v9, v10
    v_dot2_f32_bf16 v11, v86, v86, v11
    v_dot2_f32_bf16 v10, v87, v9, v10
    v_dot2_f32_bf16 v11, v87, v87, v11
    v_accvgpr_write_b32 a240, v80
    v_accvgpr_write_b32 a241, v81
    v_accvgpr_write_b32 a242, v82
    v_permlane32_swap_b32 v10, v11
    v_add_f32 v10, v10, v11
    buffer_store_dword v10, v12, s[4:7], s10 offen
    v_accvgpr_write_b32 a243, v83
    v_accvgpr_write_b32 a244, v84
    v_accvgpr_write_b32 a245, v85
    v_accvgpr_write_b32 a246, v86
    v_accvgpr_write_b32 a247, v87
    v_mov_b32 v255, 1
    s_cmp_lg_u32 s24, 0
    s_mov_b64 exec, 1
    s_waitcnt vmcnt(0)
    s_cbranch_scc1 L_pub_slow_54
    buffer_store_dword v255, off, s[4:7], s11 offset:128
L_pub_done_55:
    s_mov_b64 exec, -1
    s_mul_i32 s9, s32, 28672
    s_add_u32 s9, s9, 15683584
    v_add_u32 v252, s9, v1
    s_mul_i32 s9, s32, 3584
    s_add_u32 s9, s9, 17518592
    v_lshl_add_u32 v253, v0, 3, s9
    ds_read_b128 v[192:195], v1 offset:0
    ds_read_b128 v[196:199], v1 offset:1024
    ds_read_b128 v[200:203], v1 offset:2048
    ds_read_b128 v[204:207], v1 offset:3072
    ds_read_b128 v[208:211], v1 offset:4096
    ds_read_b128 v[212:215], v1 offset:5120
    ds_read_b128 v[216:219], v1 offset:6144
    ds_read_b128 v[220:223], v1 offset:7168
    s_mov_b64 exec, 0x3fff
L_poll_56:
    buffer_load_dword v255, v3, s[4:7], s56 offen offset:128 sc1
    s_waitcnt vmcnt(0)
    v_cmp_eq_u32 vcc, 0, v255
    s_cbranch_vccz L_poll_done_57
    s_sub_u32 s25, s25, 1
    s_cmp_gt_i32 s25, 0
    s_cbranch_scc1 L_poll_56
    s_mov_b32 s25, 0
L_poll_done_57:
    s_mov_b64 exec, -1
    s_cmp_lg_u32 s24, 0
    s_cbranch_scc1 L_poll_slow_58
L_poll_ret_59:
    buffer_load_dwordx4 v[16:19], v252, s[4:7], 0 offen offset:0 sc1
    buffer_load_dwordx4 v[20:23], v252, s[4:7], 0 offen offset:1024 sc1
    buffer_load_dwordx4 v[24:27], v252, s[4:7], 0 offen offset:2048 sc1
    buffer_load_dwordx4 v[28:31], v252, s[4:7], 0 offen offset:3072 sc1
    buffer_load_dwordx4 v[32:35], v252, s[4:7], s42 offen offset:0 sc1
    s_waitcnt vmcnt(4) lgkmcnt(7)
    v_mfma_f32_32x32x16_bf16 v[128:143], v[192:195], v[16:19], 0
    buffer_load_dwordx4 v[36:39], v252, s[4:7], s42 offen offset:1024 sc1
    ds_read_b128 v[224:227], v1 offset:8192
    s_waitcnt lgkmcnt(7)
    v_mfma_f32_32x32x16_bf16 v[144:159], v[196:199], v[16:19], 0
    ds_read_b128 v[228:231], v1 offset:9216
    s_waitcnt lgkmcnt(7)
    v_mfma_f32_32x32x16_bf16 v[160:175], v[200:203], v[16:19], 0
    ds_read_b128 v[232:235], v1 offset:10240
    s_waitcnt lgkmcnt(7)
    v_mfma_f32_32x32x16_bf16 v[176:191], v[204:207], v[16:19], 0
    buffer_load_dwordx4 v[40:43], v252, s[4:7], s42 offen offset:2048 sc1
    ds_read_b128 v[236:239], v1 offset:11264
    s_waitcnt vmcnt(5) lgkmcnt(7)
    v_mfma_f32_32x32x16_bf16 v[128:143], v[208:211], v[20:23], v[128:143]
    ds_read_b128 v[192:195], v1 offset:12288
    s_waitcnt lgkmcnt(7)
    v_mfma_f32_32x32x16_bf16 v[144:159], v[212:215], v[20:23], v[144:159]
    ds_read_b128 v[196:199], v1 offset:13312
    s_waitcnt lgkmcnt(7)
    v_mfma_f32_32x32x16_bf16 v[160:175], v[216:219], v[20:23], v[160:175]
    buffer_load_dwordx4 v[44:47], v252, s[4:7], s42 offen offset:3072 sc1
    ds_read_b128 v[200:203], v1 offset:14336
    s_waitcnt lgkmcnt(7)
    v_mfma_f32_32x32x16_bf16 v[176:191], v[220:223], v[20:23], v[176:191]
    ds_read_b128 v[204:207], v1 offset:15360
    s_waitcnt vmcnt(5) lgkmcnt(7)
    v_mfma_f32_32x32x16_bf16 v[128:143], v[224:227], v[24:27], v[128:143]
    buffer_load_dwordx2 v[8:9], v253, s[4:7], 0 offen offset:0 sc1
    ds_read_b128 v[208:211], v1 offset:16384
    s_waitcnt lgkmcnt(7)
    v_mfma_f32_32x32x16_bf16 v[144:159], v[228:231], v[24:27], v[144:159]
    buffer_load_dwordx4 v[48:51], v252, s[4:7], s43 offen offset:0 sc1
    ds_read_b128 v[212:215], v1 offset:17408
    s_waitcnt lgkmcnt(7)
    v_mfma_f32_32x32x16_bf16 v[160:175], v[232:235], v[24:27], v[160:175]
    buffer_load_dwordx2 v[10:11], v253, s[4:7], 0 offen offset:512 sc1
    ds_read_b128 v[216:219], v1 offset:18432
    s_waitcnt lgkmcnt(7)
    v_mfma_f32_32x32x16_bf16 v[176:191], v[236:239], v[24:27], v[176:191]
    buffer_load_dwordx2 v[12:13], v253, s[4:7], 0 offen offset:1024 sc1
    ds_read_b128 v[220:223], v1 offset:19456
    s_waitcnt vmcnt(8) lgkmcnt(7)
    v_mfma_f32_32x32x16_bf16 v[128:143], v[192:195], v[28:31], v[128:143]
    buffer_load_dwordx4 v[52:55], v252, s[4:7], s43 offen offset:1024 sc1
    ds_read_b128 v[224:227], v1 offset:20480
    s_waitcnt lgkmcnt(7)
    v_mfma_f32_32x32x16_bf16 v[144:159], v[196:199], v[28:31], v[144:159]
    buffer_load_dwordx2 v[14:15], v253, s[4:7], 0 offen offset:1536 sc1
    ds_read_b128 v[228:231], v1 offset:21504
    s_waitcnt lgkmcnt(7)
    v_mfma_f32_32x32x16_bf16 v[160:175], v[200:203], v[28:31], v[160:175]
    buffer_load_dwordx2 v[246:247], v253, s[4:7], 0 offen offset:2048 sc1
    ds_read_b128 v[232:235], v1 offset:22528
    s_waitcnt lgkmcnt(7)
    v_mfma_f32_32x32x16_bf16 v[176:191], v[204:207], v[28:31], v[176:191]
    buffer_load_dwordx4 v[56:59], v252, s[4:7], s43 offen offset:2048 sc1
    ds_read_b128 v[236:239], v1 offset:23552
    s_waitcnt vmcnt(11) lgkmcnt(7)
    v_mfma_f32_32x32x16_bf16 v[128:143], v[208:211], v[32:35], v[128:143]
    buffer_load_dwordx2 v[248:249], v253, s[4:7], 0 offen offset:2560 sc1
    ds_read_b128 v[192:195], v1 offset:24576
    s_waitcnt lgkmcnt(7)
    v_mfma_f32_32x32x16_bf16 v[144:159], v[212:215], v[32:35], v[144:159]
    buffer_load_dwordx2 v[250:251], v253, s[4:7], 0 offen offset:3072 sc1
    ds_read_b128 v[196:199], v1 offset:25600
    s_waitcnt lgkmcnt(7)
    v_mfma_f32_32x32x16_bf16 v[160:175], v[216:219], v[32:35], v[160:175]
    buffer_load_dwordx4 v[60:63], v252, s[4:7], s43 offen offset:3072 sc1
    ds_read_b128 v[200:203], v1 offset:26624
    s_waitcnt lgkmcnt(7)
    v_mfma_f32_32x32x16_bf16 v[176:191], v[220:223], v[32:35], v[176:191]
    ds_read_b128 v[204:207], v1 offset:27648
    s_waitcnt vmcnt(13) lgkmcnt(7)
    v_mfma_f32_32x32x16_bf16 v[128:143], v[224:227], v[36:39], v[128:143]
    ds_read_b128 v[208:211], v1 offset:28672
    s_waitcnt lgkmcnt(7)
    v_mfma_f32_32x32x16_bf16 v[144:159], v[228:231], v[36:39], v[144:159]
    buffer_load_dwordx4 v[64:67], v252, s[4:7], s44 offen offset:0 sc1
    ds_read_b128 v[212:215], v1 offset:29696
    s_waitcnt lgkmcnt(7)
    v_mfma_f32_32x32x16_bf16 v[160:175], v[232:235], v[36:39], v[160:175]
    ds_read_b128 v[216:219], v1 offset:30720
    s_waitcnt lgkmcnt(7)
    v_mfma_f32_32x32x16_bf16 v[176:191], v[236:239], v[36:39], v[176:191]
    ds_read_b128 v[220:223], v1 offset:31744
    s_waitcnt vmcnt(13) lgkmcnt(7)
    v_mfma_f32_32x32x16_bf16 v[128:143], v[192:195], v[40:43], v[128:143]
    buffer_load_dwordx4 v[68:71], v252, s[4:7], s44 offen offset:1024 sc1
    ds_read_b128 v[224:227], v1 offset:32768
    s_waitcnt lgkmcnt(7)
    v_mfma_f32_32x32x16_bf16 v[144:159], v[196:199], v[40:43], v[144:159]
    ds_read_b128 v[228:231], v1 offset:33792
    s_waitcnt lgkmcnt(7)
    v_mfma_f32_32x32x16_bf16 v[160:175], v[200:203], v[40:43], v[160:175]
    ds_read_b128 v[232:235], v1 offset:34816
    s_waitcnt lgkmcnt(7)
    v_mfma_f32_32x32x16_bf16 v[176:191], v[204:207], v[40:43], v[176:191]
    buffer_load_dwordx4 v[72:75], v252, s[4:7], s44 offen offset:2048 sc1
    ds_read_b128 v[236:239], v1 offset:35840
    s_waitcnt vmcnt(14) lgkmcnt(7)
    v_mfma_f32_32x32x16_bf16 v[128:143], v[208:211], v[44:47], v[128:143]
    ds_read_b128 v[192:195], v1 offset:36864
    s_waitcnt lgkmcnt(7)
    v_mfma_f32_32x32x16_bf16 v[144:159], v[212:215], v[44:47], v[144:159]
    ds_read_b128 v[196:199], v1 offset:37888
    s_waitcnt lgkmcnt(7)
    v_mfma_f32_32x32x16_bf16 v[160:175], v[216:219], v[44:47], v[160:175]
    buffer_load_dwordx4 v[76:79], v252, s[4:7], s44 offen offset:3072 sc1
    ds_read_b128 v[200:203], v1 offset:38912
    s_waitcnt lgkmcnt(7)
    v_mfma_f32_32x32x16_bf16 v[176:191], v[220:223], v[44:47], v[176:191]
    ds_read_b128 v[204:207], v1 offset:39936
    s_waitcnt vmcnt(13) lgkmcnt(7)
    v_mfma_f32_32x32x16_bf16 v[128:143], v[224:227], v[48:51], v[128:143]
    ds_read_b128 v[208:211], v1 offset:40960
    s_waitcnt lgkmcnt(7)
    v_mfma_f32_32x32x16_bf16 v[144:159], v[228:231], v[48:51], v[144:159]
    buffer_load_dwordx4 v[80:83], v252, s[4:7], s45 offen offset:0 sc1
    ds_read_b128 v[212:215], v1 offset:41984
    s_waitcnt lgkmcnt(7)
    v_mfma_f32_32x32x16_bf16 v[160:175], v[232:235], v[48:51], v[160:175]
    ds_read_b128 v[216:219], v1 offset:43008
    s_waitcnt lgkmcnt(7)
    v_mfma_f32_32x32x16_bf16 v[176:191], v[236:239], v[48:51], v[176:191]
    ds_read_b128 v[220:223], v1 offset:44032
    s_waitcnt vmcnt(11) lgkmcnt(7)
    v_mfma_f32_32x32x16_bf16 v[128:143], v[192:195], v[52:55], v[128:143]
    buffer_load_dwordx4 v[84:87], v252, s[4:7], s45 offen offset:1024 sc1
    ds_read_b128 v[224:227], v1 offset:45056
    s_waitcnt lgkmcnt(7)
    v_mfma_f32_32x32x16_bf16 v[144:159], v[196:199], v[52:55], v[144:159]
    ds_read_b128 v[228:231], v1 offset:46080
    s_waitcnt lgkmcnt(7)
    v_mfma_f32_32x32x16_bf16 v[160:175], v[200:203], v[52:55], v[160:175]
    ds_read_b128 v[232:235], v1 offset:47104
    s_waitcnt lgkmcnt(7)
    v_mfma_f32_32x32x16_bf16 v[176:191], v[204:207], v[52:55], v[176:191]
    buffer_load_dwordx4 v[88:91], v252, s[4:7], s45 offen offset:2048 sc1
    ds_read_b128 v[236:239], v1 offset:48128
    s_waitcnt vmcnt(10) lgkmcnt(7)
    v_mfma_f32_32x32x16_bf16 v[128:143], v[208:211], v[56:59], v[128:143]
    s_waitcnt vmcnt(8)
    v_add_f32 v8, v8, v9
    ds_read_b128 v[192:195], v1 offset:49152
    s_waitcnt lgkmcnt(7)
    v_mfma_f32_32x32x16_bf16 v[144:159], v[212:215], v[56:59], v[144:159]
    v_add_f32 v10, v10, v11
    v_add_f32 v12, v12, v13
    ds_read_b128 v[196:199], v1 offset:50176
    s_waitcnt lgkmcnt(7)
    v_mfma_f32_32x32x16_bf16 v[160:175], v[216:219], v[56:59], v[160:175]
    buffer_load_dwordx4 v[92:95], v252, s[4:7], s45 offen offset:3072 sc1
    ds_read_b128 v[200:203], v1 offset:51200
    s_waitcnt lgkmcnt(7)
    v_mfma_f32_32x32x16_bf16 v[176:191], v[220:223], v[56:59], v[176:191]
    v_add_f32 v14, v14, v15
    v_add_f32 v246, v246, v247
    ds_read_b128 v[204:207], v1 offset:52224
    s_waitcnt vmcnt(8) lgkmcnt(7)
    v_mfma_f32_32x32x16_bf16 v[128:143], v[224:227], v[60:63], v[128:143]
    v_add_f32 v248, v248, v249
    v_add_f32 v250, v250, v251
    ds_read_b128 v[208:211], v1 offset:53248
    s_waitcnt lgkmcnt(7)
    v_mfma_f32_32x32x16_bf16 v[144:159], v[228:231], v[60:63], v[144:159]
    buffer_load_dwordx4 v[96:99], v252, s[4:7], s46 offen offset:0 sc1
    ds_read_b128 v[212:215], v1 offset:54272
    s_waitcnt lgkmcnt(7)
    v_mfma_f32_32x32x16_bf16 v[160:175], v[232:235], v[60:63], v[160:175]
    v_add_f32 v8, v8, v10
    v_add_f32 v12, v12, v14
    ds_read_b128 v[216:219], v1 offset:55296
    s_waitcnt lgkmcnt(7)
    v_mfma_f32_32x32x16_bf16 v[176:191], v[236:239], v[60:63], v[176:191]
    v_add_f32 v246, v246, v248
    v_add_f32 v8, v8, v12
    ds_read_b128 v[220:223], v1 offset:56320
    s_waitcnt vmcnt(8) lgkmcnt(7)
    v_mfma_f32_32x32x16_bf16 v[128:143], v[192:195], v[64:67], v[128:143]
    buffer_load_dwordx4 v[100:103], v252, s[4:7], s46 offen offset:1024 sc1
    ds_read_b128 v[224:227], v1 offset:57344
    s_waitcnt lgkmcnt(7)
    v_mfma_f32_32x32x16_bf16 v[144:159], v[196:199], v[64:67], v[144:159]
    v_add_f32 v246, v246, v250
    v_add_f32 v8, v8, v246
    ds_read_b128 v[228:231], v1 offset:58368
    s_waitcnt lgkmcnt(7)
    v_mfma_f32_32x32x16_bf16 v[160:175], v[200:203], v[64:67], v[160:175]
    v_mul_f32 v8, 0x3b124925, v8
    v_mov_b32 v9, v8
    s_nop 1
    ds_read_b128 v[232:235], v1 offset:59392
    s_waitcnt lgkmcnt(7)
    v_mfma_f32_32x32x16_bf16 v[176:191], v[204:207], v[64:67], v[176:191]
    buffer_load_dwordx4 v[104:107], v252, s[4:7], s46 offen offset:2048 sc1
    ds_read_b128 v[236:239], v1 offset:60416
    s_waitcnt vmcnt(9) lgkmcnt(7)
    v_mfma_f32_32x32x16_bf16 v[128:143], v[208:211], v[68:71], v[128:143]
    v_permlane32_swap_b32 v8, v9
    v_fma_f32 v10, -v8, v8, v9
    ds_read_b128 v[192:195], v1 offset:61440
    s_waitcnt lgkmcnt(7)
    v_mfma_f32_32x32x16_bf16 v[144:159], v[212:215], v[68:71], v[144:159]
    v_max_f32 v10, 0, v10
    v_add_f32 v10, 0x3727c5ac, v10
    ds_read_b128 v[196:199], v1 offset:62464
    s_waitcnt lgkmcnt(7)
    v_mfma_f32_32x32x16_bf16 v[160:175], v[216:219], v[68:71], v[160:175]
    buffer_load_dwordx4 v[108:111], v252, s[4:7], s46 offen offset:3072 sc1
    ds_read_b128 v[200:203], v1 offset:63488
    s_waitcnt lgkmcnt(7)
    v_mfma_f32_32x32x16_bf16 v[176:191], v[220:223], v[68:71], v[176:191]
    v_rsq_f32 v244, v10
    v_cvt_pk_bf16_f32 v240, -v8, -v8
    ds_read_b128 v[204:207], v1 offset:64512
    s_waitcnt vmcnt(9) lgkmcnt(7)
    v_mfma_f32_32x32x16_bf16 v[128:143], v[224:227], v[72:75], v[128:143]
    v_mul_f32 v10, v10, v244
    v_lshlrev_b32 v11, 16, v240
    ds_read_b128 v[208:211], v2 offset:0
    s_waitcnt lgkmcnt(7)
    v_mfma_f32_32x32x16_bf16 v[144:159], v[228:231], v[72:75], v[144:159]
    buffer_load_dwordx4 v[112:115], v252, s[4:7], s47 offen offset:0 sc1
    ds_read_b128 v[212:215], v2 offset:1024
    s_waitcnt lgkmcnt(7)
    v_mfma_f32_32x32x16_bf16 v[160:175], v[232:235], v[72:75], v[160:175]
    v_add_f32 v11, v8, v11
    v_cvt_pk_bf16_f32 v241, -v11, -v11
    ds_read_b128 v[216:219], v2 offset:2048
    s_waitcnt lgkmcnt(7)
    v_mfma_f32_32x32x16_bf16 v[176:191], v[236:239], v[72:75], v[176:191]
    v_cvt_pk_bf16_f32 v12, v10, v10
    v_lshlrev_b32 v12, 16, v12
    ds_read_b128 v[220:223], v2 offset:3072
    s_waitcnt vmcnt(9) lgkmcnt(7)
    v_mfma_f32_32x32x16_bf16 v[128:143], v[192:195], v[76:79], v[128:143]
    buffer_load_dwordx4 v[116:119], v252, s[4:7], s47 offen offset:1024 sc1
    ds_read_b128 v[224:227], v2 offset:4096
    s_waitcnt lgkmcnt(7)
    v_mfma_f32_32x32x16_bf16 v[144:159], v[196:199], v[76:79], v[144:159]
    v_sub_f32 v12, v10, v12
    v_cvt_pk_bf16_f32 v242, v10, v12
    ds_read_b128 v[228:231], v2 offset:5120
    s_waitcnt lgkmcnt(7)
    v_mfma_f32_32x32x16_bf16 v[160:175], v[200:203], v[76:79], v[160:175]
    v_mov_b32 v243, 0
    ds_read_b128 v[232:235], v2 offset:6144
    s_waitcnt lgkmcnt(7)
    v_mfma_f32_32x32x16_bf16 v[176:191], v[204:207], v[76:79], v[176:191]
    buffer_load_dwordx4 v[120:123], v252, s[4:7], s47 offen offset:2048 sc1
    ds_read_b128 v[236:239], v2 offset:7168
    s_waitcnt vmcnt(10) lgkmcnt(7)
    v_mfma_f32_32x32x16_bf16 v[128:143], v[208:211], v[80:83], v[128:143]
    ds_read_b128 v[192:195], v2 offset:8192
    s_waitcnt lgkmcnt(7)
    v_mfma_f32_32x32x16_bf16 v[144:159], v[212:215], v[80:83], v[144:159]
    ds_read_b128 v[196:199], v2 offset:9216
    s_waitcnt lgkmcnt(7)
    v_mfma_f32_32x32x16_bf16 v[160:175], v[216:219], v[80:83], v[160:175]
    buffer_load_dwordx4 v[124:127], v252, s[4:7], s47 offen offset:3072 sc1
    ds_read_b128 v[200:203], v2 offset:10240
    s_waitcnt lgkmcnt(7)
    v_mfma_f32_32x32x16_bf16 v[176:191], v[220:223], v[80:83], v[176:191]
    ds_read_b128 v[204:207], v2 offset:11264
    s_waitcnt vmcnt(10) lgkmcnt(7)
    v_mfma_f32_32x32x16_bf16 v[128:143], v[224:227], v[84:87], v[128:143]
    ds_read_b128 v[208:211], v2 offset:12288
    s_waitcnt lgkmcnt(7)
    v_mfma_f32_32x32x16_bf16 v[144:159], v[228:231], v[84:87], v[144:159]
    v_lshlrev_b32 v245, 7, v0
    buffer_load_dword v253, v245, s[4:7], s57 offen
    ds_read_b128 v[212:215], v2 offset:13312
    s_waitcnt lgkmcnt(7)
    v_mfma_f32_32x32x16_bf16 v[160:175], v[232:235], v[84:87], v[160:175]
    ds_read_b128 v[216:219], v2 offset:14336
    s_waitcnt lgkmcnt(7)
    v_mfma_f32_32x32x16_bf16 v[176:191], v[236:239], v[84:87], v[176:191]
    ds_read_b128 v[220:223], v2 offset:15360
    s_waitcnt vmcnt(10) lgkmcnt(7)
    v_mfma_f32_32x32x16_bf16 v[128:143], v[192:195], v[88:91], v[128:143]
    ds_read_b128 v[224:227], v2 offset:16384
    s_waitcnt lgkmcnt(7)
    v_mfma_f32_32x32x16_bf16 v[144:159], v[196:199], v[88:91], v[144:159]
    ds_read_b128 v[228:231], v2 offset:20480
    s_waitcnt lgkmcnt(7)
    v_mfma_f32_32x32x16_bf16 v[160:175], v[200:203], v[88:91], v[160:175]
    ds_read_b128 v[232:235], v2 offset:24576
    s_waitcnt lgkmcnt(7)
    v_mfma_f32_32x32x16_bf16 v[176:191], v[204:207], v[88:91], v[176:191]
    ds_read_b128 v[236:239], v2 offset:28672
    s_waitcnt vmcnt(9) lgkmcnt(7)
    v_mfma_f32_32x32x16_bf16 v[128:143], v[208:211], v[92:95], v[128:143]
    ds_read_b128 v[192:195], v2 offset:32768
    s_waitcnt lgkmcnt(7)
    v_mfma_f32_32x32x16_bf16 v[144:159], v[212:215], v[92:95], v[144:159]
    ds_read_b128 v[196:199], v2 offset:36864
    s_waitcnt lgkmcnt(7)
    v_mfma_f32_32x32x16_bf16 v[160:175], v[216:219], v[92:95], v[160:175]
    ds_read_b128 v[200:203], v2 offset:40960
    s_waitcnt lgkmcnt(7)
    v_mfma_f32_32x32x16_bf16 v[176:191], v[220:223], v[92:95], v[176:191]
    ds_read_b128 v[204:207], v2 offset:45056
    s_add_u32 s9, s57, 4096
    s_waitcnt vmcnt(8) lgkmcnt(7)
    v_mfma_f32_32x32x16_bf16 v[128:143], v[224:227], v[96:99], v[128:143]
    ds_read_b128 v[208:211], v2 offset:17408
    s_waitcnt vmcnt(7) lgkmcnt(7)
    v_mfma_f32_32x32x16_bf16 v[128:143], v[228:231], v[100:103], v[128:143]
    ds_read_b128 v[212:215], v2 offset:21504
    s_waitcnt vmcnt(6) lgkmcnt(7)
    v_mfma_f32_32x32x16_bf16 v[128:143], v[232:235], v[104:107], v[128:143]
    ds_read_b128 v[216:219], v2 offset:25600
    s_waitcnt vmcnt(5) lgkmcnt(7)
    v_mfma_f32_32x32x16_bf16 v[128:143], v[236:239], v[108:111], v[128:143]
    ds_read_b128 v[220:223], v2 offset:29696
    s_waitcnt vmcnt(4) lgkmcnt(7)
    v_mfma_f32_32x32x16_bf16 v[128:143], v[192:195], v[112:115], v[128:143]
    ds_read_b128 v[224:227], v2 offset:33792
    s_waitcnt vmcnt(3) lgkmcnt(7)
    v_mfma_f32_32x32x16_bf16 v[128:143], v[196:199], v[116:119], v[128:143]
    ds_read_b128 v[228:231], v2 offset:37888
    s_waitcnt vmcnt(2) lgkmcnt(7)
    v_mfma_f32_32x32x16_bf16 v[128:143], v[200:203], v[120:123], v[128:143]
    ds_read_b128 v[232:235], v2 offset:41984
    s_waitcnt vmcnt(1) lgkmcnt(7)
    v_mfma_f32_32x32x16_bf16 v[128:143], v[204:207], v[124:127], v[128:143]
    ds_read_b128 v[236:239], v2 offset:46080
    v_mfma_f32_32x32x16_bf16 v[128:143], a[224:227], v[240:243], v[128:143]
    s_waitcnt lgkmcnt(7)
    v_mfma_f32_32x32x16_bf16 v[144:159], v[208:211], v[96:99], v[144:159]
    s_nop 3
    ds_read_b128 v[192:195], v2 offset:18432
    s_waitcnt lgkmcnt(7)
    v_mfma_f32_32x32x16_bf16 v[144:159], v[212:215], v[100:103], v[144:159]
    s_nop 2
    ds_read_b128 v[196:199], v2 offset:22528
    s_waitcnt lgkmcnt(7)
    v_mfma_f32_32x32x16_bf16 v[144:159], v[216:219], v[104:107], v[144:159]
    v_max_f32 v128, 0, v128
    v_max_f32 v129, 0, v129
    v_max_f32 v130, 0, v130
    v_max_f32 v131, 0, v131
    v_max_f32 v132, 0, v132
    v_max_f32 v133, 0, v133
    ds_read_b128 v[200:203], v2 offset:26624
    s_waitcnt lgkmcnt(7)
    v_mfma_f32_32x32x16_bf16 v[144:159], v[220:223], v[108:111], v[144:159]
    v_max_f32 v134, 0, v134
    v_max_f32 v135, 0, v135
    v_max_f32 v136, 0, v136
    v_max_f32 v137, 0, v137
    v_max_f32 v138, 0, v138
    v_max_f32 v139, 0, v139
    ds_read_b128 v[204:207], v2 offset:30720
    s_waitcnt lgkmcnt(7)
    v_mfma_f32_32x32x16_bf16 v[144:159], v[224:227], v[112:115], v[144:159]
    v_max_f32 v140, 0, v140
    v_max_f32 v141, 0, v141
    v_max_f32 v142, 0, v142
    v_max_f32 v143, 0, v143
    v_mul_f32 v128, v128, v244
    v_mul_f32 v129, v129, v244
    ds_read_b128 v[208:211], v2 offset:34816
    s_waitcnt lgkmcnt(7)
    v_mfma_f32_32x32x16_bf16 v[144:159], v[228:231], v[116:119], v[144:159]
    v_mul_f32 v130, v130, v244
    v_mul_f32 v131, v131, v244
    v_mul_f32 v132, v132, v244
    v_mul_f32 v133, v133, v244
    v_mul_f32 v134, v134, v244
    v_mul_f32 v135, v135, v244
    ds_read_b128 v[212:215], v2 offset:38912
    s_waitcnt lgkmcnt(7)
    v_mfma_f32_32x32x16_bf16 v[144:159], v[232:235], v[120:123], v[144:159]
    v_mul_f32 v136, v136, v244
    v_mul_f32 v137, v137, v244
    v_mul_f32 v138, v138, v244
    v_mul_f32 v139, v139, v244
    v_mul_f32 v140, v140, v244
    v_mul_f32 v141, v141, v244
    ds_read_b128 v[216:219], v2 offset:43008
    s_waitcnt lgkmcnt(7)
    v_mfma_f32_32x32x16_bf16 v[144:159], v[236:239], v[124:127], v[144:159]
    v_mul_f32 v142, v142, v244
    v_mul_f32 v143, v143, v244
    v_mul_f32 v128, v128, v128
    v_mul_f32 v129, v129, v129
    v_mul_f32 v130, v130, v130
    v_mul_f32 v131, v131, v131
    ds_read_b128 v[220:223], v2 offset:47104
    v_mfma_f32_32x32x16_bf16 v[144:159], a[228:231], v[240:243], v[144:159]
    v_mul_f32 v132, v132, v132
    v_mul_f32 v133, v133, v133
    v_mul_f32 v134, v134, v134
    v_mul_f32 v135, v135, v135
    v_mul_f32 v136, v136, v136
    v_mul_f32 v137, v137, v137
    s_waitcnt lgkmcnt(7)
    v_mfma_f32_32x32x16_bf16 v[160:175], v[192:195], v[96:99], v[160:175]
    s_nop 3
    ds_read_b128 v[224:227], v2 offset:19456
    s_waitcnt lgkmcnt(7)
    v_mfma_f32_32x32x16_bf16 v[160:175], v[196:199], v[100:103], v[160:175]
    s_nop 2
    ds_read_b128 v[228:231], v2 offset:23552
    s_waitcnt lgkmcnt(7)
    v_mfma_f32_32x32x16_bf16 v[160:175], v[200:203], v[104:107], v[160:175]
    v_mul_f32 v138, v138, v138
    v_mul_f32 v139, v139, v139
    v_mul_f32 v140, v140, v140
    v_mul_f32 v141, v141, v141
    v_mul_f32 v142, v142, v142
    v_mul_f32 v143, v143, v143
    ds_read_b128 v[232:235], v2 offset:27648
    s_waitcnt lgkmcnt(7)
    v_mfma_f32_32x32x16_bf16 v[160:175], v[204:207], v[108:111], v[160:175]
    v_cvt_pk_bf16_f32 v16, v128, v129
    v_cvt_pk_bf16_f32 v17, v130, v131
    v_cvt_pk_bf16_f32 v18, v132, v133
    v_cvt_pk_bf16_f32 v19, v134, v135
    buffer_store_dwordx4 v[16:19], v1, s[4:7], s57 offen offset:0
    v_cvt_pk_bf16_f32 v20, v136, v137
    ds_read_b128 v[236:239], v2 offset:31744
    s_waitcnt lgkmcnt(7)
    v_mfma_f32_32x32x16_bf16 v[160:175], v[208:211], v[112:115], v[160:175]
    v_cvt_pk_bf16_f32 v21, v138, v139
    v_cvt_pk_bf16_f32 v22, v140, v141
    v_cvt_pk_bf16_f32 v23, v142, v143
    buffer_store_dwordx4 v[20:23], v1, s[4:7], s57 offen offset:1024
    v_max_f32 v144, 0, v144
    v_max_f32 v145, 0, v145
    ds_read_b128 v[192:195], v2 offset:35840
    s_waitcnt lgkmcnt(7)
    v_mfma_f32_32x32x16_bf16 v[160:175], v[212:215], v[116:119], v[160:175]
    v_max_f32 v146, 0, v146
    v_max_f32 v147, 0, v147
    v_max_f32 v148, 0, v148
    v_max_f32 v149, 0, v149
    v_max_f32 v150, 0, v150
    v_max_f32 v151, 0, v151
    ds_read_b128 v[196:199], v2 offset:39936
    s_waitcnt lgkmcnt(7)
    v_mfma_f32_32x32x16_bf16 v[160:175], v[216:219], v[120:123], v[160:175]
    v_max_f32 v152, 0, v152
    v_max_f32 v153, 0, v153
    v_max_f32 v154, 0, v154
    v_max_f32 v155, 0, v155
    v_max_f32 v156, 0, v156
    v_max_f32 v157, 0, v157
    ds_read_b128 v[200:203], v2 offset:44032
    s_waitcnt lgkmcnt(7)
    v_mfma_f32_32x32x16_bf16 v[160:175], v[220:223], v[124:127], v[160:175]
    v_max_f32 v158, 0, v158
    v_max_f32 v159, 0, v159
    v_mul_f32 v144, v144, v244
    v_mul_f32 v145, v145, v244
    v_mul_f32 v146, v146, v244
    v_mul_f32 v147, v147, v244
    ds_read_b128 v[204:207], v2 offset:48128
    v_mfma_f32_32x32x16_bf16 v[160:175], a[232:235], v[240:243], v[160:175]
    v_mul_f32 v148, v148, v244
    v_mul_f32 v149, v149, v244
    v_mul_f32 v150, v150, v244
    v_mul_f32 v151, v151, v244
    v_mul_f32 v152, v152, v244
    v_mul_f32 v153, v153, v244
    s_waitcnt lgkmcnt(7)
    v_mfma_f32_32x32x16_bf16 v[176:191], v[224:227], v[96:99], v[176:191]
    s_nop 3
    s_waitcnt lgkmcnt(6)
    v_mfma_f32_32x32x16_bf16 v[176:191], v[228:231], v[100:103], v[176:191]
    s_nop 2
    s_waitcnt lgkmcnt(5)
    v_mfma_f32_32x32x16_bf16 v[176:191], v[232:235], v[104:107], v[176:191]
    v_mul_f32 v154, v154, v244
    v_mul_f32 v155, v155, v244
    v_mul_f32 v156, v156, v244
    v_mul_f32 v157, v157, v244
    v_mul_f32 v158, v158, v244
    v_mul_f32 v159, v159, v244
    s_waitcnt lgkmcnt(4)
    v_mfma_f32_32x32x16_bf16 v[176:191], v[236:239], v[108:111], v[176:191]
    v_mul_f32 v144, v144, v144
    v_mul_f32 v145, v145, v145
    v_mul_f32 v146, v146, v146
    v_mul_f32 v147, v147, v147
    v_mul_f32 v148, v148, v148
    v_mul_f32 v149, v149, v149
    s_waitcnt lgkmcnt(3)
    v_mfma_f32_32x32x16_bf16 v[176:191], v[192:195], v[112:115], v[176:191]
    v_mul_f32 v150, v150, v150
    v_mul_f32 v151, v151, v151
    v_mul_f32 v152, v152, v152
    v_mul_f32 v153, v153, v153
    v_mul_f32 v154, v154, v154
    v_mul_f32 v155, v155, v155
    s_waitcnt lgkmcnt(2)
    v_mfma_f32_32x32x16_bf16 v[176:191], v[196:199], v[116:119], v[176:191]
    v_mul_f32 v156, v156, v156
    v_mul_f32 v157, v157, v157
    v_mul_f32 v158, v158, v158
    v_mul_f32 v159, v159, v159
    v_cvt_pk_bf16_f32 v24, v144, v145
    v_cvt_pk_bf16_f32 v25, v146, v147
    s_waitcnt lgkmcnt(1)
    v_mfma_f32_32x32x16_bf16 v[176:191], v[200:203], v[120:123], v[176:191]
    v_cvt_pk_bf16_f32 v26, v148, v149
    v_cvt_pk_bf16_f32 v27, v150, v151
    buffer_store_dwordx4 v[24:27], v1, s[4:7], s57 offen offset:2048
    v_cvt_pk_bf16_f32 v28, v152, v153
    v_cvt_pk_bf16_f32 v29, v154, v155
    v_cvt_pk_bf16_f32 v30, v156, v157
    s_waitcnt lgkmcnt(0)
    v_mfma_f32_32x32x16_bf16 v[176:191], v[204:207], v[124:127], v[176:191]
    v_cvt_pk_bf16_f32 v31, v158, v159
    buffer_store_dwordx4 v[28:31], v1, s[4:7], s57 offen offset:3072
    v_max_f32 v160, 0, v160
    v_max_f32 v161, 0, v161
    v_max_f32 v162, 0, v162
    v_max_f32 v163, 0, v163
    v_mfma_f32_32x32x16_bf16 v[176:191], a[236:239], v[240:243], v[176:191]
    v_max_f32 v164, 0, v164
    v_max_f32 v165, 0, v165
    v_max_f32 v166, 0, v166
    v_max_f32 v167, 0, v167
    v_max_f32 v168, 0, v168
    v_max_f32 v169, 0, v169
    v_max_f32 v170, 0, v170
    v_max_f32 v171, 0, v171
    v_max_f32 v172, 0, v172
    v_max_f32 v173, 0, v173
    v_max_f32 v174, 0, v174
    v_max_f32 v175, 0, v175
    v_mul_f32 v160, v160, v244
    v_mul_f32 v161, v161, v244
    v_mul_f32 v162, v162, v244
    v_mul_f32 v163, v163, v244
    v_mul_f32 v164, v164, v244
    v_mul_f32 v165, v165, v244
    v_mul_f32 v166, v166, v244
    v_mul_f32 v167, v167, v244
    v_mul_f32 v168, v168, v244
    v_mul_f32 v169, v169, v244
    v_mul_f32 v170, v170, v244
    v_mul_f32 v171, v171, v244
    v_mul_f32 v172, v172, v244
    v_mul_f32 v173, v173, v244
    v_mul_f32 v174, v174, v244
    v_mul_f32 v175, v175, v244
    v_mul_f32 v160, v160, v160
    v_mul_f32 v161, v161, v161
    v_mul_f32 v162, v162, v162
    v_mul_f32 v163, v163, v163
    v_mul_f32 v164, v164, v164
    v_mul_f32 v165, v165, v165
    v_mul_f32 v166, v166, v166
    v_mul_f32 v167, v167, v167
    v_mul_f32 v168, v168, v168
    v_mul_f32 v169, v169, v169
    v_mul_f32 v170, v170, v170
    v_mul_f32 v171, v171, v171
    v_mul_f32 v172, v172, v172
    v_mul_f32 v173, v173, v173
    v_mul_f32 v174, v174, v174
    v_mul_f32 v175, v175, v175
    v_cvt_pk_bf16_f32 v32, v160, v161
    v_cvt_pk_bf16_f32 v33, v162, v163
    v_cvt_pk_bf16_f32 v34, v164, v165
    v_cvt_pk_bf16_f32 v35, v166, v167
    buffer_store_dwordx4 v[32:35], v1, s[4:7], s9 offen offset:0
    v_cvt_pk_bf16_f32 v36, v168, v169
    v_cvt_pk_bf16_f32 v37, v170, v171
    v_cvt_pk_bf16_f32 v38, v172, v173
    v_cvt_pk_bf16_f32 v39, v174, v175
    buffer_store_dwordx4 v[36:39], v1, s[4:7], s9 offen offset:1024
    v_max_f32 v176, 0, v176
    v_max_f32 v177, 0, v177
    v_max_f32 v178, 0, v178
    v_max_f32 v179, 0, v179
    v_max_f32 v180, 0, v180
    v_max_f32 v181, 0, v181
    v_max_f32 v182, 0, v182
    v_max_f32 v183, 0, v183
    v_max_f32 v184, 0, v184
    v_max_f32 v185, 0, v185
    v_max_f32 v186, 0, v186
    v_max_f32 v187, 0, v187
    v_max_f32 v188, 0, v188
    v_max_f32 v189, 0, v189
    v_max_f32 v190, 0, v190
    v_max_f32 v191, 0, v191
    v_pk_mul_f32 v[176:177], v[176:177], v[244:245] op_sel_hi:[1,0]
    v_pk_mul_f32 v[178:179], v[178:179], v[244:245] op_sel_hi:[1,0]
    v_pk_mul_f32 v[180:181], v[180:181], v[244:245] op_sel_hi:[1,0]
    v_pk_mul_f32 v[182:183], v[182:183], v[244:245] op_sel_hi:[1,0]
    v_pk_mul_f32 v[184:185], v[184:185], v[244:245] op_sel_hi:[1,0]
    v_pk_mul_f32 v[186:187], v[186:187], v[244:245] op_sel_hi:[1,0]
    v_pk_mul_f32 v[188:189], v[188:189], v[244:245] op_sel_hi:[1,0]
    v_pk_mul_f32 v[190:191], v[190:191], v[244:245] op_sel_hi:[1,0]
    v_pk_mul_f32 v[176:177], v[176:177], v[176:177]
    v_pk_mul_f32 v[178:179], v[178:179], v[178:179]
    v_pk_mul_f32 v[180:181], v[180:181], v[180:181]
    v_pk_mul_f32 v[182:183], v[182:183], v[182:183]
    v_pk_mul_f32 v[184:185], v[184:185], v[184:185]
    v_pk_mul_f32 v[186:187], v[186:187], v[186:187]
    v_pk_mul_f32 v[188:189], v[188:189], v[188:189]
    v_pk_mul_f32 v[190:191], v[190:191], v[190:191]
    v_cvt_pk_bf16_f32 v40, v176, v177
    v_cvt_pk_bf16_f32 v41, v178, v179
    v_cvt_pk_bf16_f32 v42, v180, v181
    v_cvt_pk_bf16_f32 v43, v182, v183
    buffer_store_dwordx4 v[40:43], v1, s[4:7], s9 offen offset:2048
    v_cvt_pk_bf16_f32 v44, v184, v185
    v_cvt_pk_bf16_f32 v45, v186, v187
    v_cvt_pk_bf16_f32 v46, v188, v189
    v_cvt_pk_bf16_f32 v47, v190, v191
    buffer_store_dwordx4 v[44:47], v1, s[4:7], s9 offen offset:3072
    v_mov_b32 v255, 1
    s_cmp_lg_u32 s24, 0
    s_mov_b64 exec, 1
    s_waitcnt vmcnt(0)
    s_cbranch_scc1 L_pub_slow_60
    buffer_store_dword v255, off, s[4:7], s58 offset:128
L_pub_done_61:
    s_mov_b64 exec, -1
    s_barrier
    s_mul_i32 s9, s30, 114688
    s_mul_i32 s10, s8, 28672
    s_add_u32 s10, s10, 19845120
    s_add_u32 s11, s9, s10
    v_add_u32 v8, s11, v1
    s_xor_b32 s9, s30, 1
    s_mul_i32 s9, s9, 114688
    s_add_u32 s11, s9, s10
    v_add_u32 v9, s11, v1
    v_accvgpr_read_b32 v80, a240
    v_accvgpr_read_b32 v81, a241
    v_accvgpr_read_b32 v82, a242
    v_accvgpr_read_b32 v83, a243
    v_accvgpr_read_b32 v84, a244
    v_accvgpr_read_b32 v85, a245
    v_accvgpr_read_b32 v86, a246
    v_accvgpr_read_b32 v87, a247
    v_lshlrev_b32 v16, 16, v80
    v_and_b32 v17, 0xffff0000, v80
    v_lshlrev_b32 v18, 16, v81
    v_and_b32 v19, 0xffff0000, v81
    v_lshlrev_b32 v20, 16, v82
    v_and_b32 v21, 0xffff0000, v82
    v_lshlrev_b32 v22, 16, v83
    v_and_b32 v23, 0xffff0000, v83
    v_lshlrev_b32 v24, 16, v84
    v_and_b32 v25, 0xffff0000, v84
    v_lshlrev_b32 v26, 16, v85
    v_and_b32 v27, 0xffff0000, v85
    v_lshlrev_b32 v28, 16, v86
    v_and_b32 v29, 0xffff0000, v86
    v_lshlrev_b32 v30, 16, v87
    v_and_b32 v31, 0xffff0000, v87
    v_accvgpr_read_b32 v80, a248
    v_accvgpr_read_b32 v81, a249
    v_accvgpr_read_b32 v82, a250
    v_accvgpr_read_b32 v83, a251
    v_accvgpr_read_b32 v84, a252
    v_accvgpr_read_b32 v85, a253
    v_accvgpr_read_b32 v86, a254
    v_accvgpr_read_b32 v87, a255
    v_lshlrev_b32 v88, 16, v80
    v_and_b32 v89, 0xffff0000, v80
    v_lshlrev_b32 v90, 16, v81
    v_and_b32 v91, 0xffff0000, v81
    v_lshlrev_b32 v92, 16, v82
    v_and_b32 v93, 0xffff0000, v82
    v_lshlrev_b32 v94, 16, v83
    v_and_b32 v95, 0xffff0000, v83
    v_lshlrev_b32 v96, 16, v84
    v_and_b32 v97, 0xffff0000, v84
    v_lshlrev_b32 v98, 16, v85
    v_and_b32 v99, 0xffff0000, v85
    v_lshlrev_b32 v100, 16, v86
    v_and_b32 v101, 0xffff0000, v86
    v_lshlrev_b32 v102, 16, v87
    v_and_b32 v103, 0xffff0000, v87
    v_pk_add_f32 v[16:17], v[16:17], v[88:89]
    v_pk_add_f32 v[18:19], v[18:19], v[90:91]
    v_pk_add_f32 v[20:21], v[20:21], v[92:93]
    v_pk_add_f32 v[22:23], v[22:23], v[94:95]
    v_pk_add_f32 v[24:25], v[24:25], v[96:97]
    v_pk_add_f32 v[26:27], v[26:27], v[98:99]
    v_pk_add_f32 v[28:29], v[28:29], v[100:101]
    v_pk_add_f32 v[30:31], v[30:31], v[102:103]
    s_mov_b64 exec, s[40:41]
L_poll_62:
    buffer_load_dword v255, v3, s[4:7], s59 offen offset:128 sc1
    s_waitcnt vmcnt(0)
    v_cmp_eq_u32 vcc, 0, v255
    s_cbranch_vccz L_poll_done_63
    s_sub_u32 s25, s25, 1
    s_cmp_gt_i32 s25, 0
    s_cbranch_scc1 L_poll_62
    s_mov_b32 s25, 0
L_poll_done_63:
    s_mov_b64 exec, -1
    s_cmp_lg_u32 s24, 0
    s_cbranch_scc1 L_poll_slow_64
L_poll_ret_65:
    buffer_load_dwordx4 v[80:83], v8, s[4:7], 0 offen offset:0 sc1
    buffer_load_dwordx4 v[84:87], v9, s[4:7], 0 offen offset:0 sc1
    buffer_load_dwordx4 v[88:91], v8, s[4:7], 0 offen offset:1024 sc1
    buffer_load_dwordx4 v[92:95], v9, s[4:7], 0 offen offset:1024 sc1
    buffer_load_dwordx4 v[96:99], v8, s[4:7], 0 offen offset:2048 sc1
    buffer_load_dwordx4 v[100:103], v9, s[4:7], 0 offen offset:2048 sc1
    buffer_load_dwordx4 v[104:107], v8, s[4:7], 0 offen offset:3072 sc1
    buffer_load_dwordx4 v[108:111], v9, s[4:7], 0 offen offset:3072 sc1
    buffer_load_dwordx4 v[112:115], v8, s[4:7], s42 offen offset:0 sc1
    buffer_load_dwordx4 v[116:119], v9, s[4:7], s42 offen offset:0 sc1
    s_waitcnt vmcnt(9)
    v_mfma_f32_32x32x16_bf16 v[16:31], a[0:3], v[80:83], v[16:31]
    buffer_load_dwordx4 v[120:123], v8, s[4:7], s42 offen offset:1024 sc1
    v_mfma_f32_32x32x16_bf16 v[32:47], a[112:115], v[80:83], 0
    s_waitcnt vmcnt(9)
    v_mfma_f32_32x32x16_bf16 v[48:63], a[0:3], v[84:87], 0
    buffer_load_dwordx4 v[124:127], v9, s[4:7], s42 offen offset:1024 sc1
    v_mfma_f32_32x32x16_bf16 v[64:79], a[112:115], v[84:87], 0
    s_waitcnt vmcnt(9)
    v_mfma_f32_32x32x16_bf16 v[16:31], a[4:7], v[88:91], v[16:31]
    buffer_load_dwordx4 v[128:131], v8, s[4:7], s42 offen offset:2048 sc1
    v_mfma_f32_32x32x16_bf16 v[32:47], a[116:119], v[88:91], v[32:47]
    s_waitcnt vmcnt(9)
    v_mfma_f32_32x32x16_bf16 v[48:63], a[4:7], v[92:95], v[48:63]
    buffer_load_dwordx4 v[132:135], v9, s[4:7], s42 offen offset:2048 sc1
    v_mfma_f32_32x32x16_bf16 v[64:79], a[116:119], v[92:95], v[64:79]
    s_waitcnt vmcnt(9)
    v_mfma_f32_32x32x16_bf16 v[16:31], a[8:11], v[96:99], v[16:31]
    buffer_load_dwordx4 v[136:139], v8, s[4:7], s42 offen offset:3072 sc1
    v_mfma_f32_32x32x16_bf16 v[32:47], a[120:123], v[96:99], v[32:47]
    s_waitcnt vmcnt(9)
    v_mfma_f32_32x32x16_bf16 v[48:63], a[8:11], v[100:103], v[48:63]
    buffer_load_dwordx4 v[140:143], v9, s[4:7], s42 offen offset:3072 sc1
    v_mfma_f32_32x32x16_bf16 v[64:79], a[120:123], v[100:103], v[64:79]
    s_waitcnt vmcnt(9)
    v_mfma_f32_32x32x16_bf16 v[16:31], a[12:15], v[104:107], v[16:31]
    buffer_load_dwordx4 v[144:147], v8, s[4:7], s43 offen offset:0 sc1
    v_mfma_f32_32x32x16_bf16 v[32:47], a[124:127], v[104:107], v[32:47]
    s_waitcnt vmcnt(9)
    v_mfma_f32_32x32x16_bf16 v[48:63], a[12:15], v[108:111], v[48:63]
    buffer_load_dwordx4 v[148:151], v9, s[4:7], s43 offen offset:0 sc1
    v_mfma_f32_32x32x16_bf16 v[64:79], a[124:127], v[108:111], v[64:79]
    s_waitcnt vmcnt(9)
    v_mfma_f32_32x32x16_bf16 v[16:31], a[16:19], v[112:115], v[16:31]
    buffer_load_dwordx4 v[152:155], v8, s[4:7], s43 offen offset:1024 sc1
    v_mfma_f32_32x32x16_bf16 v[32:47], a[128:131], v[112:115], v[32:47]
    s_waitcnt vmcnt(9)
    v_mfma_f32_32x32x16_bf16 v[48:63], a[16:19], v[116:119], v[48:63]
    buffer_load_dwordx4 v[156:159], v9, s[4:7], s43 offen offset:1024 sc1
    v_mfma_f32_32x32x16_bf16 v[64:79], a[128:131], v[116:119], v[64:79]
    s_waitcnt vmcnt(9)
    v_mfma_f32_32x32x16_bf16 v[16:31], a[20:23], v[120:123], v[16:31]
    buffer_load_dwordx4 v[160:163], v8, s[4:7], s43 offen offset:2048 sc1
    v_mfma_f32_32x32x16_bf16 v[32:47], a[132:135], v[120:123], v[32:47]
    s_waitcnt vmcnt(9)
    v_mfma_f32_32x32x16_bf16 v[48:63], a[20:23], v[124:127], v[48:63]
    buffer_load_dwordx4 v[164:167], v9, s[4:7], s43 offen offset:2048 sc1
    v_mfma_f32_32x32x16_bf16 v[64:79], a[132:135], v[124:127], v[64:79]
    s_waitcnt vmcnt(9)
    v_mfma_f32_32x32x16_bf16 v[16:31], a[24:27], v[128:131], v[16:31]
    buffer_load_dwordx4 v[168:171], v8, s[4:7], s43 offen offset:3072 sc1
    v_mfma_f32_32x32x16_bf16 v[32:47], a[136:139], v[128:131], v[32:47]
    s_waitcnt vmcnt(9)
    v_mfma_f32_32x32x16_bf16 v[48:63], a[24:27], v[132:135], v[48:63]
    buffer_load_dwordx4 v[172:175], v9, s[4:7], s43 offen offset:3072 sc1
    v_mfma_f32_32x32x16_bf16 v[64:79], a[136:139], v[132:135], v[64:79]
    s_waitcnt vmcnt(9)
    v_mfma_f32_32x32x16_bf16 v[16:31], a[28:31], v[136:139], v[16:31]
    buffer_load_dwordx4 v[176:179], v8, s[4:7], s44 offen offset:0 sc1
    v_mfma_f32_32x32x16_bf16 v[32:47], a[140:143], v[136:139], v[32:47]
    s_waitcnt vmcnt(9)
    v_mfma_f32_32x32x16_bf16 v[48:63], a[28:31], v[140:143], v[48:63]
    buffer_load_dwordx4 v[180:183], v9, s[4:7], s44 offen offset:0 sc1
    v_mfma_f32_32x32x16_bf16 v[64:79], a[140:143], v[140:143], v[64:79]
    s_waitcnt vmcnt(9)
    v_mfma_f32_32x32x16_bf16 v[16:31], a[32:35], v[144:147], v[16:31]
    buffer_load_dwordx4 v[184:187], v8, s[4:7], s44 offen offset:1024 sc1
    v_mfma_f32_32x32x16_bf16 v[32:47], a[144:147], v[144:147], v[32:47]
    s_waitcnt vmcnt(9)
    v_mfma_f32_32x32x16_bf16 v[48:63], a[32:35], v[148:151], v[48:63]
    buffer_load_dwordx4 v[188:191], v9, s[4:7], s44 offen offset:1024 sc1
    v_mfma_f32_32x32x16_bf16 v[64:79], a[144:147], v[148:151], v[64:79]
    s_waitcnt vmcnt(9)
    v_mfma_f32_32x32x16_bf16 v[16:31], a[36:39], v[152:155], v[16:31]
    buffer_load_dwordx4 v[192:195], v8, s[4:7], s44 offen offset:2048 sc1
    v_mfma_f32_32x32x16_bf16 v[32:47], a[148:151], v[152:155], v[32:47]
    s_waitcnt vmcnt(9)
    v_mfma_f32_32x32x16_bf16 v[48:63], a[36:39], v[156:159], v[48:63]
    buffer_load_dwordx4 v[196:199], v9, s[4:7], s44 offen offset:2048 sc1
    v_mfma_f32_32x32x16_bf16 v[64:79], a[148:151], v[156:159], v[64:79]
    s_waitcnt vmcnt(9)
    v_mfma_f32_32x32x16_bf16 v[16:31], a[40:43], v[160:163], v[16:31]
    buffer_load_dwordx4 v[200:203], v8, s[4:7], s44 offen offset:3072 sc1
    v_mfma_f32_32x32x16_bf16 v[32:47], a[152:155], v[160:163], v[32:47]
    s_waitcnt vmcnt(9)
    v_mfma_f32_32x32x16_bf16 v[48:63], a[40:43], v[164:167], v[48:63]
    buffer_load_dwordx4 v[204:207], v9, s[4:7], s44 offen offset:3072 sc1
    v_mfma_f32_32x32x16_bf16 v[64:79], a[152:155], v[164:167], v[64:79]
    s_waitcnt vmcnt(9)
    v_mfma_f32_32x32x16_bf16 v[16:31], a[44:47], v[168:171], v[16:31]
    buffer_load_dwordx4 v[80:83], v8, s[4:7], s45 offen offset:0 sc1
    v_mfma_f32_32x32x16_bf16 v[32:47], a[156:159], v[168:171], v[32:47]
    s_waitcnt vmcnt(9)
    v_mfma_f32_32x32x16_bf16 v[48:63], a[44:47], v[172:175], v[48:63]
    buffer_load_dwordx4 v[84:87], v9, s[4:7], s45 offen offset:0 sc1
    v_mfma_f32_32x32x16_bf16 v[64:79], a[156:159], v[172:175], v[64:79]
    s_waitcnt vmcnt(9)
    v_mfma_f32_32x32x16_bf16 v[16:31], a[48:51], v[176:179], v[16:31]
    buffer_load_dwordx4 v[88:91], v8, s[4:7], s45 offen offset:1024 sc1
    v_mfma_f32_32x32x16_bf16 v[32:47], a[160:163], v[176:179], v[32:47]
    s_waitcnt vmcnt(9)
    v_mfma_f32_32x32x16_bf16 v[48:63], a[48:51], v[180:183], v[48:63]
    buffer_load_dwordx4 v[92:95], v9, s[4:7], s45 offen offset:1024 sc1
    v_mfma_f32_32x32x16_bf16 v[64:79], a[160:163], v[180:183], v[64:79]
    s_waitcnt vmcnt(9)
    v_mfma_f32_32x32x16_bf16 v[16:31], a[52:55], v[184:187], v[16:31]
    buffer_load_dwordx4 v[96:99], v8, s[4:7], s45 offen offset:2048 sc1
    v_mfma_f32_32x32x16_bf16 v[32:47], a[164:167], v[184:187], v[32:47]
    s_waitcnt vmcnt(9)
    v_mfma_f32_32x32x16_bf16 v[48:63], a[52:55], v[188:191], v[48:63]
    buffer_load_dwordx4 v[100:103], v9, s[4:7], s45 offen offset:2048 sc1
    v_mfma_f32_32x32x16_bf16 v[64:79], a[164:167], v[188:191], v[64:79]
    s_waitcnt vmcnt(9)
    v_mfma_f32_32x32x16_bf16 v[16:31], a[56:59], v[192:195], v[16:31]
    buffer_load_dwordx4 v[104:107], v8, s[4:7], s45 offen offset:3072 sc1
    v_mfma_f32_32x32x16_bf16 v[32:47], a[168:171], v[192:195], v[32:47]
    s_waitcnt vmcnt(9)
    v_mfma_f32_32x32x16_bf16 v[48:63], a[56:59], v[196:199], v[48:63]
    buffer_load_dwordx4 v[108:111], v9, s[4:7], s45 offen offset:3072 sc1
    v_mfma_f32_32x32x16_bf16 v[64:79], a[168:171], v[196:199], v[64:79]
    s_waitcnt vmcnt(9)
    v_mfma_f32_32x32x16_bf16 v[16:31], a[60:63], v[200:203], v[16:31]
    buffer_load_dwordx4 v[112:115], v8, s[4:7], s46 offen offset:0 sc1
    v_mfma_f32_32x32x16_bf16 v[32:47], a[172:175], v[200:203], v[32:47]
    s_waitcnt vmcnt(9)
    v_mfma_f32_32x32x16_bf16 v[48:63], a[60:63], v[204:207], v[48:63]
    buffer_load_dwordx4 v[116:119], v9, s[4:7], s46 offen offset:0 sc1
    v_mfma_f32_32x32x16_bf16 v[64:79], a[172:175], v[204:207], v[64:79]
    s_waitcnt vmcnt(9)
    v_mfma_f32_32x32x16_bf16 v[16:31], a[64:67], v[80:83], v[16:31]
    buffer_load_dwordx4 v[120:123], v8, s[4:7], s46 offen offset:1024 sc1
    v_mfma_f32_32x32x16_bf16 v[32:47], a[176:179], v[80:83], v[32:47]
    s_waitcnt vmcnt(9)
    v_mfma_f32_32x32x16_bf16 v[48:63], a[64:67], v[84:87], v[48:63]
    buffer_load_dwordx4 v[124:127], v9, s[4:7], s46 offen offset:1024 sc1
    v_mfma_f32_32x32x16_bf16 v[64:79], a[176:179], v[84:87], v[64:79]
    s_waitcnt vmcnt(9)
    v_mfma_f32_32x32x16_bf16 v[16:31], a[68:71], v[88:91], v[16:31]
    buffer_load_dwordx4 v[128:131], v8, s[4:7], s46 offen offset:2048 sc1
    v_mfma_f32_32x32x16_bf16 v[32:47], a[180:183], v[88:91], v[32:47]
    s_waitcnt vmcnt(9)
    v_mfma_f32_32x32x16_bf16 v[48:63], a[68:71], v[92:95], v[48:63]
    buffer_load_dwordx4 v[132:135], v9, s[4:7], s46 offen offset:2048 sc1
    v_mfma_f32_32x32x16_bf16 v[64:79], a[180:183], v[92:95], v[64:79]
    s_waitcnt vmcnt(9)
    v_mfma_f32_32x32x16_bf16 v[16:31], a[72:75], v[96:99], v[16:31]
    buffer_load_dwordx4 v[136:139], v8, s[4:7], s46 offen offset:3072 sc1
    v_mfma_f32_32x32x16_bf16 v[32:47], a[184:187], v[96:99], v[32:47]
    s_waitcnt vmcnt(9)
    v_mfma_f32_32x32x16_bf16 v[48:63], a[72:75], v[100:103], v[48:63]
    buffer_load_dwordx4 v[140:143], v9, s[4:7], s46 offen offset:3072 sc1
    v_mfma_f32_32x32x16_bf16 v[64:79], a[184:187], v[100:103], v[64:79]
    s_waitcnt vmcnt(9)
    v_mfma_f32_32x32x16_bf16 v[16:31], a[76:79], v[104:107], v[16:31]
    buffer_load_dwordx4 v[144:147], v8, s[4:7], s47 offen offset:0 sc1
    v_mfma_f32_32x32x16_bf16 v[32:47], a[188:191], v[104:107], v[32:47]
    s_waitcnt vmcnt(9)
    v_mfma_f32_32x32x16_bf16 v[48:63], a[76:79], v[108:111], v[48:63]
    buffer_load_dwordx4 v[148:151], v9, s[4:7], s47 offen offset:0 sc1
    v_mfma_f32_32x32x16_bf16 v[64:79], a[188:191], v[108:111], v[64:79]
    s_waitcnt vmcnt(9)
    v_mfma_f32_32x32x16_bf16 v[16:31], a[80:83], v[112:115], v[16:31]
    buffer_load_dwordx4 v[152:155], v8, s[4:7], s47 offen offset:1024 sc1
    v_mfma_f32_32x32x16_bf16 v[32:47], a[192:195], v[112:115], v[32:47]
    s_waitcnt vmcnt(9)
    v_mfma_f32_32x32x16_bf16 v[48:63], a[80:83], v[116:119], v[48:63]
    buffer_load_dwordx4 v[156:159], v9, s[4:7], s47 offen offset:1024 sc1
    v_mfma_f32_32x32x16_bf16 v[64:79], a[192:195], v[116:119], v[64:79]
    s_waitcnt vmcnt(9)
    v_mfma_f32_32x32x16_bf16 v[16:31], a[84:87], v[120:123], v[16:31]
    buffer_load_dwordx4 v[160:163], v8, s[4:7], s47 offen offset:2048 sc1
    v_mfma_f32_32x32x16_bf16 v[32:47], a[196:199], v[120:123], v[32:47]
    s_waitcnt vmcnt(9)
    v_mfma_f32_32x32x16_bf16 v[48:63], a[84:87], v[124:127], v[48:63]
    buffer_load_dwordx4 v[164:167], v9, s[4:7], s47 offen offset:2048 sc1
    v_mfma_f32_32x32x16_bf16 v[64:79], a[196:199], v[124:127], v[64:79]
    s_waitcnt vmcnt(9)
    v_mfma_f32_32x32x16_bf16 v[16:31], a[88:91], v[128:131], v[16:31]
    buffer_load_dwordx4 v[168:171], v8, s[4:7], s47 offen offset:3072 sc1
    v_mfma_f32_32x32x16_bf16 v[32:47], a[200:203], v[128:131], v[32:47]
    s_waitcnt vmcnt(9)
    v_mfma_f32_32x32x16_bf16 v[48:63], a[88:91], v[132:135], v[48:63]
    buffer_load_dwordx4 v[172:175], v9, s[4:7], s47 offen offset:3072 sc1
    v_mfma_f32_32x32x16_bf16 v[64:79], a[200:203], v[132:135], v[64:79]
    s_waitcnt vmcnt(9)
    v_mfma_f32_32x32x16_bf16 v[16:31], a[92:95], v[136:139], v[16:31]
    v_mfma_f32_32x32x16_bf16 v[32:47], a[204:207], v[136:139], v[32:47]
    s_waitcnt vmcnt(8)
    v_mfma_f32_32x32x16_bf16 v[48:63], a[92:95], v[140:143], v[48:63]
    v_mfma_f32_32x32x16_bf16 v[64:79], a[204:207], v[140:143], v[64:79]
    s_waitcnt vmcnt(7)
    v_mfma_f32_32x32x16_bf16 v[32:47], a[208:211], v[144:147], v[32:47]
    s_waitcnt vmcnt(5)
    v_mfma_f32_32x32x16_bf16 v[32:47], a[212:215], v[152:155], v[32:47]
    s_waitcnt vmcnt(3)
    v_mfma_f32_32x32x16_bf16 v[32:47], a[216:219], v[160:163], v[32:47]
    s_waitcnt vmcnt(1)
    v_mfma_f32_32x32x16_bf16 v[32:47], a[220:223], v[168:171], v[32:47]
    v_mfma_f32_32x32x16_bf16 v[64:79], a[208:211], v[148:151], v[64:79]
    s_nop 4
    v_mfma_f32_32x32x16_bf16 v[64:79], a[212:215], v[156:159], v[64:79]
    s_nop 4
    v_mfma_f32_32x32x16_bf16 v[64:79], a[216:219], v[164:167], v[64:79]
    ds_write_b128 v4, v[32:35] offset:0
    ds_write_b128 v4, v[36:39] offset:1024
    s_waitcnt vmcnt(0)
    v_mfma_f32_32x32x16_bf16 v[64:79], a[220:223], v[172:175], v[64:79]
    ds_write_b128 v4, v[40:43] offset:2048
    ds_write_b128 v4, v[44:47] offset:3072
    v_mfma_f32_32x32x16_bf16 v[48:63], a[96:99], v[148:151], v[48:63]
    s_nop 4
    v_mfma_f32_32x32x16_bf16 v[48:63], a[100:103], v[156:159], v[48:63]
    s_nop 4
    v_mfma_f32_32x32x16_bf16 v[48:63], a[104:107], v[164:167], v[48:63]
    ds_write_b128 v6, v[64:67] offset:0
    ds_write_b128 v6, v[68:71] offset:1024
    v_mfma_f32_32x32x16_bf16 v[48:63], a[108:111], v[172:175], v[48:63]
    ds_write_b128 v6, v[72:75] offset:2048
    ds_write_b128 v6, v[76:79] offset:3072
    v_mfma_f32_32x32x16_bf16 v[16:31], a[96:99], v[144:147], v[16:31]
    s_nop 4
    v_mfma_f32_32x32x16_bf16 v[16:31], a[100:103], v[152:155], v[16:31]
    s_nop 4
    v_mfma_f32_32x32x16_bf16 v[16:31], a[104:107], v[160:163], v[16:31]
    ds_write_b128 v5, v[48:51] offset:0
    ds_write_b128 v5, v[52:55] offset:1024
    v_mfma_f32_32x32x16_bf16 v[16:31], a[108:111], v[168:171], v[16:31]
    ds_write_b128 v5, v[56:59] offset:2048
    ds_write_b128 v5, v[60:63] offset:3072
    s_waitcnt lgkmcnt(0)
    s_barrier
    ds_read_b128 v[32:35], v7 offset:0
    ds_read_b128 v[36:39], v7 offset:1024
    ds_read_b128 v[40:43], v7 offset:2048
    ds_read_b128 v[44:47], v7 offset:3072
    ds_read_b128 v[48:51], v7 offset:4096
    ds_read_b128 v[52:55], v7 offset:5120
    ds_read_b128 v[56:59], v7 offset:6144
    ds_read_b128 v[60:63], v7 offset:7168
    ds_read_b128 v[64:67], v7 offset:8192
    ds_read_b128 v[68:71], v7 offset:9216
    ds_read_b128 v[72:75], v7 offset:10240
    ds_read_b128 v[76:79], v7 offset:11264
    v_and_b32 v8, 31, v0
    v_mul_u32_u24 v8, 896, v8
    v_lshrrev_b32 v9, 5, v0
    v_lshl_add_u32 v8, v9, 4, v8
    s_mul_i32 s9, s30, 28672
    s_lshl_b32 s10, s31, 6
    s_add_u32 s9, s9, s10
    s_waitcnt lgkmcnt(8)
    v_pk_add_f32 v[16:17], v[16:17], v[32:33]
    v_pk_add_f32 v[18:19], v[18:19], v[34:35]
    v_pk_add_f32 v[20:21], v[20:21], v[36:37]
    v_pk_add_f32 v[22:23], v[22:23], v[38:39]
    v_pk_add_f32 v[24:25], v[24:25], v[40:41]
    v_pk_add_f32 v[26:27], v[26:27], v[42:43]
    v_pk_add_f32 v[28:29], v[28:29], v[44:45]
    v_pk_add_f32 v[30:31], v[30:31], v[46:47]
    s_waitcnt lgkmcnt(4)
    v_pk_add_f32 v[16:17], v[16:17], v[48:49]
    v_pk_add_f32 v[18:19], v[18:19], v[50:51]
    v_pk_add_f32 v[20:21], v[20:21], v[52:53]
    v_pk_add_f32 v[22:23], v[22:23], v[54:55]
    v_pk_add_f32 v[24:25], v[24:25], v[56:57]
    v_pk_add_f32 v[26:27], v[26:27], v[58:59]
    v_pk_add_f32 v[28:29], v[28:29], v[60:61]
    v_pk_add_f32 v[30:31], v[30:31], v[62:63]
    s_waitcnt lgkmcnt(0)
    v_pk_add_f32 v[16:17], v[16:17], v[64:65]
    v_pk_add_f32 v[18:19], v[18:19], v[66:67]
    v_pk_add_f32 v[20:21], v[20:21], v[68:69]
    v_pk_add_f32 v[22:23], v[22:23], v[70:71]
    v_pk_add_f32 v[24:25], v[24:25], v[72:73]
    v_pk_add_f32 v[26:27], v[26:27], v[74:75]
    v_pk_add_f32 v[28:29], v[28:29], v[76:77]
    v_pk_add_f32 v[30:31], v[30:31], v[78:79]
    v_cvt_pk_bf16_f32 v80, v16, v17
    v_cvt_pk_bf16_f32 v81, v18, v19
    v_cvt_pk_bf16_f32 v82, v20, v21
    v_cvt_pk_bf16_f32 v83, v22, v23
    v_cvt_pk_bf16_f32 v84, v24, v25
    v_cvt_pk_bf16_f32 v85, v26, v27
    v_cvt_pk_bf16_f32 v86, v28, v29
    v_cvt_pk_bf16_f32 v87, v30, v31
    s_nop 0
    v_permlane32_swap_b32 v80, v82
    v_permlane32_swap_b32 v81, v83
    buffer_store_dwordx4 v[80:83], v8, s[16:19], s9 offen offset:0
    v_permlane32_swap_b32 v84, v86
    v_permlane32_swap_b32 v85, v87
    buffer_store_dwordx4 v[84:87], v8, s[16:19], s9 offen offset:32
L_end:
    s_endpgm
L_init_spin_7:
    buffer_load_dword v10, v3, s[20:23], 0 offen sc1
    s_waitcnt vmcnt(0)
    v_and_b32 v14, 0xff, v10
    v_cmp_gt_u32 vcc, 4, v14
    s_cbranch_vccz L_init_ok_8
    s_sub_u32 s25, s25, 1
    s_cmp_gt_i32 s25, 0
    s_cbranch_scc1 L_init_spin_7
    s_mov_b32 s25, 0
    s_branch L_init_ok_8
L_pk_spin_14:
    buffer_load_dword v240, v244, s[4:7], 0 offen sc1
    s_waitcnt vmcnt(0)
    v_cmp_eq_u32 vcc, 0, v240
    s_cbranch_vccz L_pk_ok_15
    s_sub_u32 s25, s25, 1
    s_cmp_gt_i32 s25, 0
    s_cbranch_scc1 L_pk_spin_14
    s_mov_b32 s25, 0
    s_branch L_pk_ok_15
L_attn_fb_17:
    s_cmp_lg_u32 s61, 0
    s_cbranch_scc1 L_attn_merge_16
    s_mov_b32 s61, 1
    s_waitcnt vmcnt(0) lgkmcnt(0)
    s_mov_b32 exec_lo, 0
    v_mov_b32 v14, 0
    v_mov_b32 v22, 0
    v_mov_b32 v30, 0
    v_mov_b32 v38, 0
    s_mov_b32 exec_lo, -1
    v_mov_b32 v224, 0xff800000
    v_mov_b32 v225, 0xff800000
    v_mov_b32 v226, 0xff800000
    v_mov_b32 v227, 0xff800000
    s_mov_b32 s9, 0
    s_mov_b32 s10, 16
L_attn_fbl_66:
    buffer_load_dwordx4 v[160:163], v241, s[4:7], s9 offen sc1
    buffer_load_dwordx4 v[164:167], v241, s[4:7], s9 offen offset:1024 sc1
    s_waitcnt vmcnt(0)
    v_mfma_f32_32x32x16_bf16 v[104:119], v[160:163], v[8:11], 0
    v_mfma_f32_32x32x16_bf16 v[104:119], v[164:167], v[12:15], v[104:119]
    s_nop 7
    s_nop 3
    v_max3_f32 v224, v224, v104, v105
    v_max3_f32 v224, v224, v106, v107
    v_max3_f32 v224, v224, v108, v109
    v_max3_f32 v224, v224, v110, v111
    v_max3_f32 v224, v224, v112, v113
    v_max3_f32 v224, v224, v114, v115
    v_max3_f32 v224, v224, v116, v117
    v_max3_f32 v224, v224, v118, v119
    v_mfma_f32_32x32x16_bf16 v[104:119], v[160:163], v[16:19], 0
    v_mfma_f32_32x32x16_bf16 v[104:119], v[164:167], v[20:23], v[104:119]
    s_nop 7
    s_nop 3
    v_max3_f32 v225, v225, v104, v105
    v_max3_f32 v225, v225, v106, v107
    v_max3_f32 v225, v225, v108, v109
    v_max3_f32 v225, v225, v110, v111
    v_max3_f32 v225, v225, v112, v113
    v_max3_f32 v225, v225, v114, v115
    v_max3_f32 v225, v225, v116, v117
    v_max3_f32 v225, v225, v118, v119
    v_mfma_f32_32x32x16_bf16 v[104:119], v[160:163], v[24:27], 0
    v_mfma_f32_32x32x16_bf16 v[104:119], v[164:167], v[28:31], v[104:119]
    s_nop 7
    s_nop 3
    v_max3_f32 v226, v226, v104, v105
    v_max3_f32 v226, v226, v106, v107
    v_max3_f32 v226, v226, v108, v109
    v_max3_f32 v226, v226, v110, v111
    v_max3_f32 v226, v226, v112, v113
    v_max3_f32 v226, v226, v114, v115
    v_max3_f32 v226, v226, v116, v117
    v_max3_f32 v226, v226, v118, v119
    v_mfma_f32_32x32x16_bf16 v[104:119], v[160:163], v[32:35], 0
    v_mfma_f32_32x32x16_bf16 v[104:119], v[164:167], v[36:39], v[104:119]
    s_nop 7
    s_nop 3
    v_max3_f32 v227, v227, v104, v105
    v_max3_f32 v227, v227, v106, v107
    v_max3_f32 v227, v227, v108, v109
    v_max3_f32 v227, v227, v110, v111
    v_max3_f32 v227, v227, v112, v113
    v_max3_f32 v227, v227, v114, v115
    v_max3_f32 v227, v227, v116, v117
    v_max3_f32 v227, v227, v118, v119
    s_add_u32 s9, s9, 16384
    s_sub_u32 s10, s10, 1
    s_cmp_lg_u32 s10, 0
    s_cbranch_scc1 L_attn_fbl_66
    v_mov_b32 v228, v224
    s_nop 1
    v_permlane32_swap_b32 v224, v228
    v_max_f32 v224, v224, v228
    s_mov_b32 exec_lo, 0
    v_sub_f32 v224, 0, v224
    v_cvt_pk_bf16_f32 v228, v224, v224
    v_lshlrev_b32 v228, 16, v228
    v_sub_f32 v229, v224, v228
    v_cvt_pk_bf16_f32 v14, v224, v229
    v_and_b32 v230, 0xffff0000, v14
    v_sub_f32 v229, v229, v230
    v_cvt_pk_bf16_f32 v15, v229, 0
    v_lshlrev_b32 v229, 16, v15
    v_add_f32 v230, v230, v229
    v_add_f32 v224, v228, v230
    s_mov_b32 exec_lo, -1
    v_mov_b32 v228, v225
    s_nop 1
    v_permlane32_swap_b32 v225, v228
    v_max_f32 v225, v225, v228
    s_mov_b32 exec_lo, 0
    v_sub_f32 v225, 0, v225
    v_cvt_pk_bf16_f32 v228, v225, v225
    v_lshlrev_b32 v228, 16, v228
    v_sub_f32 v229, v225, v228
    v_cvt_pk_bf16_f32 v22, v225, v229
    v_and_b32 v230, 0xffff0000, v22
    v_sub_f32 v229, v229, v230
    v_cvt_pk_bf16_f32 v23, v229, 0
    v_lshlrev_b32 v229, 16, v23
    v_add_f32 v230, v230, v229
    v_add_f32 v225, v228, v230
    s_mov_b32 exec_lo, -1
    v_mov_b32 v228, v226
    s_nop 1
    v_permlane32_swap_b32 v226, v228
    v_max_f32 v226, v226, v228
    s_mov_b32 exec_lo, 0
    v_sub_f32 v226, 0, v226
    v_cvt_pk_bf16_f32 v228, v226, v226
    v_lshlrev_b32 v228, 16, v228
    v_sub_f32 v229, v226, v228
    v_cvt_pk_bf16_f32 v30, v226, v229
    v_and_b32 v230, 0xffff0000, v30
    v_sub_f32 v229, v229, v230
    v_cvt_pk_bf16_f32 v31, v229, 0
    v_lshlrev_b32 v229, 16, v31
    v_add_f32 v230, v230, v229
    v_add_f32 v226, v228, v230
    s_mov_b32 exec_lo, -1
    v_mov_b32 v228, v227
    s_nop 1
    v_permlane32_swap_b32 v227, v228
    v_max_f32 v227, v227, v228
    s_mov_b32 exec_lo, 0
    v_sub_f32 v227, 0, v227
    v_cvt_pk_bf16_f32 v228, v227, v227
    v_lshlrev_b32 v228, 16, v228
    v_sub_f32 v229, v227, v228
    v_cvt_pk_bf16_f32 v38, v227, v229
    v_and_b32 v230, 0xffff0000, v38
    v_sub_f32 v229, v229, v230
    v_cvt_pk_bf16_f32 v39, v229, 0
    v_lshlrev_b32 v229, 16, v39
    v_add_f32 v230, v230, v229
    v_add_f32 v227, v228, v230
    s_mov_b32 exec_lo, -1
    s_lshl_b32 s9, s27, 14
    buffer_load_dwordx4 v[160:163], v241, s[4:7], s9 offen offset:0 sc1
    buffer_load_dwordx4 v[164:167], v241, s[4:7], s9 offen offset:1024 sc1
    buffer_load_dwordx4 v[168:171], v241, s[4:7], s9 offen offset:2048 sc1
    buffer_load_dwordx4 v[172:175], v241, s[4:7], s9 offen offset:3072 sc1
    s_mul_i32 s62, s33, 118784
    s_add_u32 s62, s62, 10391552
    s_mul_i32 s63, s8, 28672
    s_lshl_b32 s9, s27, 14
    s_mov_b32 m0, s63
    s_add_u32 s10, s9, 16384
    s_and_b32 s10, s10, 0x3c000
    buffer_load_dwordx4 v[176:179], v241, s[4:7], s10 offen offset:0 sc1
    buffer_load_dwordx4 v[180:183], v241, s[4:7], s10 offen offset:1024 sc1
    buffer_load_dwordx4 v[184:187], v241, s[4:7], s10 offen offset:2048 sc1
    buffer_load_dwordx4 v[188:191], v241, s[4:7], s10 offen offset:3072 sc1
    s_add_u32 s9, s10, 16384
    s_and_b32 s9, s9, 0x3c000
    buffer_load_dwordx4 v[192:195], v241, s[4:7], s9 offen offset:0 sc1
    buffer_load_dwordx4 v[196:199], v241, s[4:7], s9 offen offset:1024 sc1
    s_waitcnt vmcnt(0)
    s_branch L_attn_restart_12
L_pub_slow_18:
    buffer_wbl2 sc1
    s_waitcnt vmcnt(0)
    buffer_store_dword v255, off, s[4:7], s51 offset:0 sc1
    s_branch L_pub_done_19
L_poll_slow_22:
    buffer_inv sc1
    s_waitcnt vmcnt(0)
    s_branch L_poll_ret_23
L_pub_slow_24:
    buffer_wbl2 sc1
    s_waitcnt vmcnt(0)
    buffer_store_dword v255, off, s[4:7], s11 offset:0 sc1
    s_branch L_pub_done_25
L_poll_slow_28:
    buffer_inv sc1
    s_waitcnt vmcnt(0)
    s_branch L_poll_ret_29
L_pub_slow_30:
    buffer_wbl2 sc1
    s_waitcnt vmcnt(0)
    buffer_store_dword v255, off, s[4:7], s58 offset:0 sc1
    s_branch L_pub_done_31
L_poll_slow_34:
    buffer_inv sc1
    s_waitcnt vmcnt(0)
    s_branch L_poll_ret_35
L_pub_slow_36:
    buffer_wbl2 sc1
    s_waitcnt vmcnt(0)
    buffer_store_dword v255, off, s[4:7], s11 offset:0 sc1
    s_branch L_pub_done_37
L_poll_slow_40:
    buffer_inv sc1
    s_waitcnt vmcnt(0)
    s_branch L_poll_ret_41
L_attn_fb_47:
    s_cmp_lg_u32 s61, 0
    s_cbranch_scc1 L_attn_merge_46
    s_mov_b32 s61, 1
    s_waitcnt vmcnt(0) lgkmcnt(0)
    s_mov_b32 exec_lo, 0
    v_mov_b32 v14, 0
    v_mov_b32 v22, 0
    v_mov_b32 v30, 0
    v_mov_b32 v38, 0
    s_mov_b32 exec_lo, -1
    v_mov_b32 v224, 0xff800000
    v_mov_b32 v225, 0xff800000
    v_mov_b32 v226, 0xff800000
    v_mov_b32 v227, 0xff800000
    s_mov_b32 s9, 0
    s_mov_b32 s10, 16
L_attn_fbl_67:
    buffer_load_dwordx4 v[160:163], v241, s[4:7], s9 offen sc1
    buffer_load_dwordx4 v[164:167], v241, s[4:7], s9 offen offset:1024 sc1
    s_waitcnt vmcnt(0)
    v_mfma_f32_32x32x16_bf16 v[104:119], v[160:163], v[8:11], 0
    v_mfma_f32_32x32x16_bf16 v[104:119], v[164:167], v[12:15], v[104:119]
    s_nop 7
    s_nop 3
    v_max3_f32 v224, v224, v104, v105
    v_max3_f32 v224, v224, v106, v107
    v_max3_f32 v224, v224, v108, v109
    v_max3_f32 v224, v224, v110, v111
    v_max3_f32 v224, v224, v112, v113
    v_max3_f32 v224, v224, v114, v115
    v_max3_f32 v224, v224, v116, v117
    v_max3_f32 v224, v224, v118, v119
    v_mfma_f32_32x32x16_bf16 v[104:119], v[160:163], v[16:19], 0
    v_mfma_f32_32x32x16_bf16 v[104:119], v[164:167], v[20:23], v[104:119]
    s_nop 7
    s_nop 3
    v_max3_f32 v225, v225, v104, v105
    v_max3_f32 v225, v225, v106, v107
    v_max3_f32 v225, v225, v108, v109
    v_max3_f32 v225, v225, v110, v111
    v_max3_f32 v225, v225, v112, v113
    v_max3_f32 v225, v225, v114, v115
    v_max3_f32 v225, v225, v116, v117
    v_max3_f32 v225, v225, v118, v119
    v_mfma_f32_32x32x16_bf16 v[104:119], v[160:163], v[24:27], 0
    v_mfma_f32_32x32x16_bf16 v[104:119], v[164:167], v[28:31], v[104:119]
    s_nop 7
    s_nop 3
    v_max3_f32 v226, v226, v104, v105
    v_max3_f32 v226, v226, v106, v107
    v_max3_f32 v226, v226, v108, v109
    v_max3_f32 v226, v226, v110, v111
    v_max3_f32 v226, v226, v112, v113
    v_max3_f32 v226, v226, v114, v115
    v_max3_f32 v226, v226, v116, v117
    v_max3_f32 v226, v226, v118, v119
    v_mfma_f32_32x32x16_bf16 v[104:119], v[160:163], v[32:35], 0
    v_mfma_f32_32x32x16_bf16 v[104:119], v[164:167], v[36:39], v[104:119]
    s_nop 7
    s_nop 3
    v_max3_f32 v227, v227, v104, v105
    v_max3_f32 v227, v227, v106, v107
    v_max3_f32 v227, v227, v108, v109
    v_max3_f32 v227, v227, v110, v111
    v_max3_f32 v227, v227, v112, v113
    v_max3_f32 v227, v227, v114, v115
    v_max3_f32 v227, v227, v116, v117
    v_max3_f32 v227, v227, v118, v119
    s_add_u32 s9, s9, 16384
    s_sub_u32 s10, s10, 1
    s_cmp_lg_u32 s10, 0
    s_cbranch_scc1 L_attn_fbl_67
    v_mov_b32 v228, v224
    s_nop 1
    v_permlane32_swap_b32 v224, v228
    v_max_f32 v224, v224, v228
    s_mov_b32 exec_lo, 0
    v_sub_f32 v224, 0, v224
    v_cvt_pk_bf16_f32 v228, v224, v224
    v_lshlrev_b32 v228, 16, v228
    v_sub_f32 v229, v224, v228
    v_cvt_pk_bf16_f32 v14, v224, v229
    v_and_b32 v230, 0xffff0000, v14
    v_sub_f32 v229, v229, v230
    v_cvt_pk_bf16_f32 v15, v229, 0
    v_lshlrev_b32 v229, 16, v15
    v_add_f32 v230, v230, v229
    v_add_f32 v224, v228, v230
    s_mov_b32 exec_lo, -1
    v_mov_b32 v228, v225
    s_nop 1
    v_permlane32_swap_b32 v225, v228
    v_max_f32 v225, v225, v228
    s_mov_b32 exec_lo, 0
    v_sub_f32 v225, 0, v225
    v_cvt_pk_bf16_f32 v228, v225, v225
    v_lshlrev_b32 v228, 16, v228
    v_sub_f32 v229, v225, v228
    v_cvt_pk_bf16_f32 v22, v225, v229
    v_and_b32 v230, 0xffff0000, v22
    v_sub_f32 v229, v229, v230
    v_cvt_pk_bf16_f32 v23, v229, 0
    v_lshlrev_b32 v229, 16, v23
    v_add_f32 v230, v230, v229
    v_add_f32 v225, v228, v230
    s_mov_b32 exec_lo, -1
    v_mov_b32 v228, v226
    s_nop 1
    v_permlane32_swap_b32 v226, v228
    v_max_f32 v226, v226, v228
    s_mov_b32 exec_lo, 0
    v_sub_f32 v226, 0, v226
    v_cvt_pk_bf16_f32 v228, v226, v226
    v_lshlrev_b32 v228, 16, v228
    v_sub_f32 v229, v226, v228
    v_cvt_pk_bf16_f32 v30, v226, v229
    v_and_b32 v230, 0xffff0000, v30
    v_sub_f32 v229, v229, v230
    v_cvt_pk_bf16_f32 v31, v229, 0
    v_lshlrev_b32 v229, 16, v31
    v_add_f32 v230, v230, v229
    v_add_f32 v226, v228, v230
    s_mov_b32 exec_lo, -1
    v_mov_b32 v228, v227
    s_nop 1
    v_permlane32_swap_b32 v227, v228
    v_max_f32 v227, v227, v228
    s_mov_b32 exec_lo, 0
    v_sub_f32 v227, 0, v227
    v_cvt_pk_bf16_f32 v228, v227, v227
    v_lshlrev_b32 v228, 16, v228
    v_sub_f32 v229, v227, v228
    v_cvt_pk_bf16_f32 v38, v227, v229
    v_and_b32 v230, 0xffff0000, v38
    v_sub_f32 v229, v229, v230
    v_cvt_pk_bf16_f32 v39, v229, 0
    v_lshlrev_b32 v229, 16, v39
    v_add_f32 v230, v230, v229
    v_add_f32 v227, v228, v230
    s_mov_b32 exec_lo, -1
    s_lshl_b32 s9, s27, 14
    buffer_load_dwordx4 v[160:163], v241, s[4:7], s9 offen offset:0 sc1
    buffer_load_dwordx4 v[164:167], v241, s[4:7], s9 offen offset:1024 sc1
    buffer_load_dwordx4 v[168:171], v241, s[4:7], s9 offen offset:2048 sc1
    buffer_load_dwordx4 v[172:175], v241, s[4:7], s9 offen offset:3072 sc1
    s_mul_i32 s62, s33, 118784
    s_add_u32 s62, s62, 10391552
    s_mul_i32 s63, s8, 28672
    s_lshl_b32 s9, s27, 14
    s_mov_b32 m0, s63
    s_add_u32 s10, s9, 16384
    s_and_b32 s10, s10, 0x3c000
    buffer_load_dwordx4 v[176:179], v241, s[4:7], s10 offen offset:0 sc1
    buffer_load_dwordx4 v[180:183], v241, s[4:7], s10 offen offset:1024 sc1
    buffer_load_dwordx4 v[184:187], v241, s[4:7], s10 offen offset:2048 sc1
    buffer_load_dwordx4 v[188:191], v241, s[4:7], s10 offen offset:3072 sc1
    s_add_u32 s9, s10, 16384
    s_and_b32 s9, s9, 0x3c000
    buffer_load_dwordx4 v[192:195], v241, s[4:7], s9 offen offset:0 sc1
    buffer_load_dwordx4 v[196:199], v241, s[4:7], s9 offen offset:1024 sc1
    s_waitcnt vmcnt(0)
    s_branch L_attn_restart_45
L_pub_slow_48:
    buffer_wbl2 sc1
    s_waitcnt vmcnt(0)
    buffer_store_dword v255, off, s[4:7], s51 offset:128 sc1
    s_branch L_pub_done_49
L_poll_slow_52:
    buffer_inv sc1
    s_waitcnt vmcnt(0)
    s_branch L_poll_ret_53
L_pub_slow_54:
    buffer_wbl2 sc1
    s_waitcnt vmcnt(0)
    buffer_store_dword v255, off, s[4:7], s11 offset:128 sc1
    s_branch L_pub_done_55
L_poll_slow_58:
    buffer_inv sc1
    s_waitcnt vmcnt(0)
    s_branch L_poll_ret_59
L_pub_slow_60:
    buffer_wbl2 sc1
    s_waitcnt vmcnt(0)
    buffer_store_dword v255, off, s[4:7], s58 offset:128 sc1
    s_branch L_pub_done_61
L_poll_slow_64:
    buffer_inv sc1
    s_waitcnt vmcnt(0)
    s_branch L_poll_ret_65
L_norole:
    s_mul_i32 s9, s8, 22528
    s_add_u32 s9, s9, 0
    s_mul_i32 s10, s26, 89088
    s_add_u32 s10, s10, s9
    s_add_u32 s10, s10, 8388608
    s_mov_b32 m0, s9
    v_add_u32 v13, s10, v1
    buffer_load_dwordx4 v13, s[4:7], 0 offen offset:0 sc1 lds
    buffer_load_dwordx4 v13, s[4:7], 0 offen offset:1024 sc1 lds
    buffer_load_dwordx4 v13, s[4:7], 0 offen offset:2048 sc1 lds
    buffer_load_dwordx4 v13, s[4:7], 0 offen offset:3072 sc1 lds
    s_add_u32 m0, m0, 4096
    s_nop 0
    buffer_load_dwordx4 v13, s[4:7], s42 offen offset:0 sc1 lds
    buffer_load_dwordx4 v13, s[4:7], s42 offen offset:1024 sc1 lds
    buffer_load_dwordx4 v13, s[4:7], s42 offen offset:2048 sc1 lds
    buffer_load_dwordx4 v13, s[4:7], s42 offen offset:3072 sc1 lds
    s_add_u32 m0, m0, 4096
    s_nop 0
    buffer_load_dwordx4 v13, s[4:7], s43 offen offset:0 sc1 lds
    buffer_load_dwordx4 v13, s[4:7], s43 offen offset:1024 sc1 lds
    buffer_load_dwordx4 v13, s[4:7], s43 offen offset:2048 sc1 lds
    buffer_load_dwordx4 v13, s[4:7], s43 offen offset:3072 sc1 lds
    s_add_u32 m0, m0, 4096
    s_nop 0
    buffer_load_dwordx4 v13, s[4:7], s44 offen offset:0 sc1 lds
    buffer_load_dwordx4 v13, s[4:7], s44 offen offset:1024 sc1 lds
    buffer_load_dwordx4 v13, s[4:7], s44 offen offset:2048 sc1 lds
    buffer_load_dwordx4 v13, s[4:7], s44 offen offset:3072 sc1 lds
    s_add_u32 m0, m0, 4096
    s_nop 0
    buffer_load_dwordx4 v13, s[4:7], s45 offen offset:0 sc1 lds
    buffer_load_dwordx4 v13, s[4:7], s45 offen offset:1024 sc1 lds
    buffer_load_dwordx4 v13, s[4:7], s45 offen offset:2048 sc1 lds
    buffer_load_dwordx4 v13, s[4:7], s45 offen offset:3072 sc1 lds
    s_add_u32 m0, m0, 4096
    s_nop 0
    buffer_load_dwordx4 v13, s[4:7], s46 offen offset:0 sc1 lds
    buffer_load_dwordx4 v13, s[4:7], s46 offen offset:1024 sc1 lds
    s_getpc_b64 s[10:11]
L_pc1:
    s_add_u32 s10, s10, L_layer1-L_pc1
    s_addc_u32 s11, s11, -1
    s_min_u32 s9, s8, 2
    s_lshl_b32 s9, s9, 13
    v_lshlrev_b32 v8, 7, v0
    v_add_u32 v8, s9, v8
    global_load_dword v9, v8, s[10:11]
    s_waitcnt vmcnt(0)
    s_branch L_layer1
.section .rodata,"a"
.p2align 6
.amdhsa_kernel interleave_layers__softmax_full_mha__dense_activation_squared_relu__prompt_kernel
  .amdhsa_next_free_vgpr 512
  .amdhsa_next_free_sgpr 102
  .amdhsa_accum_offset 256
  .amdhsa_group_segment_fixed_size 0
  .amdhsa_kernarg_size 88
  .amdhsa_user_sgpr_count 2
  .amdhsa_user_sgpr_kernarg_segment_ptr 1
  .amdhsa_system_sgpr_workgroup_id_x 1
.end_amdhsa_kernel
```
